```python
import torch

def _softmax(x, axis=-1):
    return torch.softmax(x, dim=axis)
def _gelu(x):
    return torch.nn.functional.gelu(x, approximate="tanh")
def _silu(x):
    return torch.nn.functional.silu(x)
def _sigmoid(x):
    return torch.sigmoid(x)
def _layernorm(x, axis=-1, eps=1e-5):
    m = x.mean(dim=axis, keepdim=True)
    v = x.var(dim=axis, keepdim=True, unbiased=False)
    return (x - m) / torch.sqrt(v + eps)
def _scatter_add(tgt, idx, src, axis=0):
    return tgt.clone().index_add_(axis, idx, src)
def _segment_sum(src, seg, n):
    out = torch.zeros((n,) + src.shape[1:], dtype=src.dtype)
    return out.index_add_(0, seg, src)
def _pad(x, pw):
    flat = tuple(v for pair in reversed(pw) for v in pair)
    return torch.nn.functional.pad(x, flat)

kernel_name = 'parallel_sum__ssm_conv_h3__glu_gated_swiglu__prompt'

def setup_inputs():

    _w = (lambda a: (lambda t: t.to(torch.bfloat16) if t.is_floating_point() else t)(torch.as_tensor(a)))
    def _A_setup():
        B, S, D = 1, 2048, 576
        ks = 4
        return {
            "q": _w((lambda *s: torch.randn(*s, dtype=torch.bfloat16) * 0.05)(B, S, D)),
            "k": _w((lambda *s: torch.randn(*s, dtype=torch.bfloat16) * 0.2)(B, S, D)),
            "v": _w((lambda *s: torch.randn(*s, dtype=torch.bfloat16) * 0.2)(B, S, D)),
            "shift_k": _w((lambda *s: torch.randn(*s, dtype=torch.bfloat16) * 0.2)(D, ks) * 0.5),
            "ssm_k": _w((lambda *s: torch.randn(*s, dtype=torch.bfloat16) * 0.4)(D, S) * (1.0 / S ** 0.5)),
            "ssm_D": _w((lambda *s: torch.randn(*s, dtype=torch.bfloat16) * 0.2)(D)),
        }
    _A_in = _A_setup()

    def _B_setup():
        B, S, D, F = 1, 2048, 576, 4608
        return {
            "x": _w((lambda *s: torch.randn(*s, dtype=torch.bfloat16) * 0.05)(B, S, D)),
            "w1": _w((lambda *s: torch.randn(*s, dtype=torch.bfloat16) * 0.2)(D, F) * (2.0 / D) ** 0.5),
            "w3": _w((lambda *s: torch.randn(*s, dtype=torch.bfloat16) * 0.2)(D, F) * (2.0 / D) ** 0.5),
            "w2": _w((lambda *s: torch.randn(*s, dtype=torch.bfloat16) * 0.2)(F, D) * (2.0 / F) ** 0.5),
        }
    _B_in = _B_setup()

    return {
        "A_q": _A_in["q"],
        "A_k": _A_in["k"],
        "A_v": _A_in["v"],
        "A_shift_k": _A_in["shift_k"],
        "A_ssm_k": _A_in["ssm_k"],
        "A_ssm_D": _A_in["ssm_D"],
        "B_x": _B_in["x"],
        "B_w1": _B_in["w1"],
        "B_w3": _B_in["w3"],
        "B_w2": _B_in["w2"],
    }

def reference(A_q, A_k, A_v, A_shift_k, A_ssm_k, A_ssm_D, B_x, B_w1, B_w3, B_w2):
    def _A_ref(q, k, v, shift_k, ssm_k, ssm_D):
        B, S, D = q.shape
        ks = shift_k.shape[-1]
        k_pad = _pad(k, ((0, 0), (ks - 1, 0), (0, 0)))
        k_shift = torch.zeros_like(k)
        for t in range(ks):
            k_shift = k_shift + k_pad[:, t:t + S, :] * shift_k[:, ks - 1 - t][None, None, :]
        kv = k_shift * v
        L = 2 * S
        kv_pad = _pad(kv, ((0, 0), (0, S), (0, 0)))
        kf_pad = _pad(ssm_k, ((0, 0), (0, S)))
        kv_f = (lambda x, axes=(-2,-1): torch.fft.rfft2(x.float(), dim=axes))(kv_pad[:, None, :, :], axes=(1, 2))
        kf_f = (lambda x, axes=(-2,-1): torch.fft.rfft2(x.float(), dim=axes))(kf_pad[:, None, :], axes=(1, 2))
        kf_f = (lambda x, *d: x.permute(*d))(kf_f, 1, 2, 0)
        y_f = kv_f * kf_f[None, :, :, :]
        y = (lambda x, s, axes=(-2,-1): torch.fft.irfft2(x, s=s, dim=axes).to(torch.bfloat16))(y_f, (1, L), axes=(1, 2))[:, 0, :S, :]
        y = y + kv * ssm_D[None, None, :]
        return q * y

    def _B_ref(x, w1, w3, w2):
        gate = torch.einsum("bsd,df->bsf", x, w1)
        up = torch.einsum("bsd,df->bsf", x, w3)
        h = _silu(gate) * up
        out = torch.einsum("bsf,fd->bsd", h, w2)
        return out

    x = A_q
    xn = _layernorm(x, axis=-1)
    return x + _A_ref(xn, A_k, A_v, A_shift_k, A_ssm_k, A_ssm_D) + _B_ref(xn, B_w1, B_w3, B_w2)
```

```asm
; @launch kernel=parallel_sum__ssm_conv_h3__glu_gated_swiglu__prompt_kernel grid=(256,1,1) block=(512,1,1) lds=160768
.amdgcn_target "amdgcn-amd-amdhsa--gfx950"
.text
.globl parallel_sum__ssm_conv_h3__glu_gated_swiglu__prompt_kernel
.p2align 8
.type parallel_sum__ssm_conv_h3__glu_gated_swiglu__prompt_kernel,@function
parallel_sum__ssm_conv_h3__glu_gated_swiglu__prompt_kernel:
  s_cmp_ge_u32 s2, 256
  s_cbranch_scc1 k_end
  s_load_dwordx16 s[56:71], s[0:1], 0
  s_load_dwordx8 s[72:79], s[0:1], 64
  s_load_dwordx2 s[80:81], s[0:1], 96
  v_lshrrev_b32 v1, 6, v0
  v_and_b32 v2, 63, v0
  s_nop 0
  v_readfirstlane_b32 s3, v1
  s_and_b32 s22, s2, 7
  s_lshl_b32 s22, s22, 2
  s_lshr_b32 s23, s2, 3
  s_and_b32 s23, s23, 3
  s_add_u32 s22, s22, s23
  s_lshr_b32 s23, s2, 5
  s_mul_i32 s25, s22, 288
  s_and_b32 s24, s3, 3
  s_mul_i32 s24, s24, 288
  s_movk_i32 s26, 3641
  s_movk_i32 s27, 9216
  v_add_u32 v3, 0, v2
  v_add_u32 v3, s24, v3
  v_mul_lo_u32 v4, v3, s26
  v_lshrrev_b32 v4, 16, v4
  v_mul_u32_u24 v5, 18, v4
  v_sub_u32 v5, v3, v5
  v_mul_lo_u32 v4, v4, s27
  v_lshl_add_u32 v4, v5, 4, v4
  v_add_u32 v80, s25, v4
  v_add_u32 v3, 64, v2
  v_add_u32 v3, s24, v3
  v_mul_lo_u32 v4, v3, s26
  v_lshrrev_b32 v4, 16, v4
  v_mul_u32_u24 v5, 18, v4
  v_sub_u32 v5, v3, v5
  v_mul_lo_u32 v4, v4, s27
  v_lshl_add_u32 v4, v5, 4, v4
  v_add_u32 v81, s25, v4
  v_add_u32 v3, 128, v2
  v_add_u32 v3, s24, v3
  v_mul_lo_u32 v4, v3, s26
  v_lshrrev_b32 v4, 16, v4
  v_mul_u32_u24 v5, 18, v4
  v_sub_u32 v5, v3, v5
  v_mul_lo_u32 v4, v4, s27
  v_lshl_add_u32 v4, v5, 4, v4
  v_add_u32 v82, s25, v4
  v_add_u32 v3, 192, v2
  v_add_u32 v3, s24, v3
  v_mul_lo_u32 v4, v3, s26
  v_lshrrev_b32 v4, 16, v4
  v_mul_u32_u24 v5, 18, v4
  v_sub_u32 v5, v3, v5
  v_mul_lo_u32 v4, v4, s27
  v_lshl_add_u32 v4, v5, 4, v4
  v_add_u32 v83, s25, v4
  v_add_u32 v3, 256, v2
  v_add_u32 v3, s24, v3
  v_mul_lo_u32 v4, v3, s26
  v_lshrrev_b32 v4, 16, v4
  v_mul_u32_u24 v5, 18, v4
  v_sub_u32 v5, v3, v5
  v_mul_lo_u32 v4, v4, s27
  v_lshl_add_u32 v4, v5, 4, v4
  v_add_u32 v84, s25, v4
  s_mul_i32 s28, s3, 4608
  s_lshl_b32 s24, s23, 4
  s_lshl_b32 s25, s3, 1
  s_add_u32 s24, s24, s25
  s_mul_i32 s25, s24, 18432
  v_lshlrev_b32 v92, 4, v2
  v_add_u32 v85, s25, v92
  v_add_u32 v86, 18432, v85
  v_lshrrev_b32 v3, 2, v2
  v_mul_u32_u24 v3, 288, v3
  v_and_b32 v4, 3, v2
  v_lshl_add_u32 v3, v4, 3, v3
  v_add_u32 v88, 0, v3
  v_add_u32 v89, 36864, v3
  v_add_u32 v90, 73728, v3
  v_add_u32 v91, 110592, v3
  s_waitcnt lgkmcnt(0)
  s_cmp_ge_u32 s3, 4
  s_cselect_b32 s8, s72, s70
  s_cselect_b32 s9, s73, s71
  s_mov_b32 s10, 5308416
  s_mov_b32 s11, 0x00020000
  s_mov_b32 s12, s80
  s_mov_b32 s13, s81
  s_mov_b32 s14, 2359296
  s_mov_b32 s15, 0x00020000
  s_add_u32 s16, s80, 7372800
  s_addc_u32 s17, s81, 0
  s_mov_b32 s18, 18874368
  s_mov_b32 s19, 0x00020000
  s_mov_b32 s36, s78
  s_mov_b32 s37, s79
  s_mov_b32 s38, 256
  s_mov_b32 s39, 0x00020000
  s_add_u32 s32, s80, 45121536
  s_addc_u32 s33, s81, 0
  s_mov_b32 s34, 65536
  s_mov_b32 s35, 0x00020000
  s_cmp_lg_u32 s3, 0
  s_cbranch_scc1 p0_nononce
  s_memrealtime s[84:85]
  s_waitcnt lgkmcnt(0)
  s_or_b32 s84, s84, 1
  v_mov_b32 v94, s84
  v_mov_b32 v95, 0
  v_mov_b32 v93, 0
  s_mov_b64 exec, 1
  buffer_atomic_cmpswap v[94:95], v93, s[36:39], 0 offen sc0 sc1
  s_mov_b64 exec, -1
p0_nononce:
  s_cmp_ge_u32 s22, 16
  s_cbranch_scc1 p0_kv
  s_mov_b32 s82, 0
  s_mov_b32 s4, s56
  s_mov_b32 s5, s57
  s_mov_b32 s6, 2359296
  s_mov_b32 s7, 0x00020000
  v_lshrrev_b32 v3, 4, v2
  v_and_b32 v4, 15, v2
  s_lshl_b32 s40, s23, 4
  s_add_u32 s40, s40, s22
  s_lshl_b32 s41, s40, 4
  v_add_u32 v5, s41, v4
  s_movk_i32 s41, 1152
  v_mul_lo_u32 v5, v5, s41
  v_lshl_add_u32 v5, v3, 3, v5
  s_mul_i32 s41, s3, 192
  s_cmp_ge_u32 s3, 6
  s_cbranch_scc1 p0_ln_skipload
  buffer_load_dwordx2 v[8:9], v5, s[4:7], s41 offen offset:0
  buffer_load_dwordx2 v[10:11], v5, s[4:7], s41 offen offset:32
  buffer_load_dwordx2 v[12:13], v5, s[4:7], s41 offen offset:64
  buffer_load_dwordx2 v[14:15], v5, s[4:7], s41 offen offset:96
  buffer_load_dwordx2 v[16:17], v5, s[4:7], s41 offen offset:128
  buffer_load_dwordx2 v[18:19], v5, s[4:7], s41 offen offset:160
p0_ln_skipload:
  s_mov_b32 s29, 0
  s_add_u32 m0, s28, 0
  s_nop 0
  buffer_load_dwordx4 v80, s[8:11], s29 offen lds
  s_mov_b32 s29, 0
  s_add_u32 m0, s28, 1024
  s_nop 0
  buffer_load_dwordx4 v81, s[8:11], s29 offen lds
  s_mov_b32 s29, 0
  s_add_u32 m0, s28, 2048
  s_nop 0
  buffer_load_dwordx4 v82, s[8:11], s29 offen lds
  s_mov_b32 s29, 0
  s_add_u32 m0, s28, 3072
  s_nop 0
  buffer_load_dwordx4 v83, s[8:11], s29 offen lds
  s_mov_b32 s29, 0
  s_add_u32 m0, s28, 4096
  s_mov_b32 exec_hi, 0
  buffer_load_dwordx4 v84, s[8:11], s29 offen lds
  s_mov_b32 exec_hi, -1
  s_mov_b32 s29, 589824
  s_add_u32 m0, s28, 36864
  s_nop 0
  buffer_load_dwordx4 v80, s[8:11], s29 offen lds
  s_mov_b32 s29, 589824
  s_add_u32 m0, s28, 37888
  s_nop 0
  buffer_load_dwordx4 v81, s[8:11], s29 offen lds
  s_mov_b32 s29, 589824
  s_add_u32 m0, s28, 38912
  s_nop 0
  buffer_load_dwordx4 v82, s[8:11], s29 offen lds
  s_mov_b32 s29, 589824
  s_add_u32 m0, s28, 39936
  s_nop 0
  buffer_load_dwordx4 v83, s[8:11], s29 offen lds
  s_mov_b32 s29, 589824
  s_add_u32 m0, s28, 40960
  s_mov_b32 exec_hi, 0
  buffer_load_dwordx4 v84, s[8:11], s29 offen lds
  s_mov_b32 exec_hi, -1
  s_mov_b32 s29, 1179648
  s_add_u32 m0, s28, 73728
  s_nop 0
  buffer_load_dwordx4 v80, s[8:11], s29 offen lds
  s_mov_b32 s29, 1179648
  s_add_u32 m0, s28, 74752
  s_nop 0
  buffer_load_dwordx4 v81, s[8:11], s29 offen lds
  s_mov_b32 s29, 1179648
  s_add_u32 m0, s28, 75776
  s_nop 0
  buffer_load_dwordx4 v82, s[8:11], s29 offen lds
  s_mov_b32 s29, 1179648
  s_add_u32 m0, s28, 76800
  s_nop 0
  buffer_load_dwordx4 v83, s[8:11], s29 offen lds
  s_mov_b32 s29, 1179648
  s_add_u32 m0, s28, 77824
  s_mov_b32 exec_hi, 0
  buffer_load_dwordx4 v84, s[8:11], s29 offen lds
  s_mov_b32 exec_hi, -1
  s_cmp_lg_u32 s22, 0
  s_cbranch_scc1 p0_nozero
  s_cmp_lg_u32 s3, 7
  s_cbranch_scc1 p0_nozero
  v_mov_b32 v6, 0
  v_lshlrev_b32 v7, 8, v2
  s_lshl_b32 s41, s23, 12
  s_mov_b64 exec, 0xffff
  buffer_store_dword v6, v7, s[32:35], s41 offen sc0 sc1
  s_mov_b64 exec, -1
p0_nozero:
  v_xor_b32 v6, 16, v2
  v_lshlrev_b32 v6, 2, v6
  v_xor_b32 v7, 32, v2
  v_lshlrev_b32 v7, 2, v7
  s_lshl_b32 s41, s3, 6
  v_lshlrev_b32 v60, 2, v4
  v_add_u32 v61, s41, v60
  s_waitcnt vmcnt(15)
  v_lshlrev_b32 v24, 16, v8
  v_and_b32 v25, 0xffff0000, v8
  v_lshlrev_b32 v26, 16, v9
  v_and_b32 v27, 0xffff0000, v9
  v_lshlrev_b32 v28, 16, v10
  v_and_b32 v29, 0xffff0000, v10
  v_lshlrev_b32 v30, 16, v11
  v_and_b32 v31, 0xffff0000, v11
  v_lshlrev_b32 v32, 16, v12
  v_and_b32 v33, 0xffff0000, v12
  v_lshlrev_b32 v34, 16, v13
  v_and_b32 v35, 0xffff0000, v13
  v_lshlrev_b32 v36, 16, v14
  v_and_b32 v37, 0xffff0000, v14
  v_lshlrev_b32 v38, 16, v15
  v_and_b32 v39, 0xffff0000, v15
  v_lshlrev_b32 v40, 16, v16
  v_and_b32 v41, 0xffff0000, v16
  v_lshlrev_b32 v42, 16, v17
  v_and_b32 v43, 0xffff0000, v17
  v_lshlrev_b32 v44, 16, v18
  v_and_b32 v45, 0xffff0000, v18
  v_lshlrev_b32 v46, 16, v19
  v_and_b32 v47, 0xffff0000, v19
  v_add_f32 v48, v24, v25
  v_add_f32 v49, v26, v27
  v_add_f32 v48, v48, v28
  v_add_f32 v49, v49, v29
  v_add_f32 v48, v48, v30
  v_add_f32 v49, v49, v31
  v_add_f32 v48, v48, v32
  v_add_f32 v49, v49, v33
  v_add_f32 v48, v48, v34
  v_add_f32 v49, v49, v35
  v_add_f32 v48, v48, v36
  v_add_f32 v49, v49, v37
  v_add_f32 v48, v48, v38
  v_add_f32 v49, v49, v39
  v_add_f32 v48, v48, v40
  v_add_f32 v49, v49, v41
  v_add_f32 v48, v48, v42
  v_add_f32 v49, v49, v43
  v_add_f32 v48, v48, v44
  v_add_f32 v49, v49, v45
  v_add_f32 v48, v48, v46
  v_add_f32 v49, v49, v47
  v_add_f32 v48, v48, v49
  ds_bpermute_b32 v50, v6, v48
  s_waitcnt lgkmcnt(0)
  v_add_f32 v48, v48, v50
  ds_bpermute_b32 v50, v7, v48
  s_waitcnt lgkmcnt(0)
  v_add_f32 v48, v48, v50
  v_add_u32 v62, 147456, v61
  v_add_u32 v63, 147456, v60
  ds_write_b32 v62, v48
  s_waitcnt lgkmcnt(0)
  s_barrier
  ds_read_b32 v52, v63 offset:0
  ds_read_b32 v53, v63 offset:64
  ds_read_b32 v54, v63 offset:128
  ds_read_b32 v55, v63 offset:192
  ds_read_b32 v56, v63 offset:256
  ds_read_b32 v57, v63 offset:320
  s_waitcnt lgkmcnt(0)
  v_add_f32 v52, v52, v53
  v_add_f32 v54, v54, v55
  v_add_f32 v56, v56, v57
  v_add_f32 v52, v52, v54
  v_add_f32 v48, v52, v56
  v_mul_f32 v48, 0x3ae38e39, v48
  v_mov_b32 v49, 0
  v_mov_b32 v51, 0
  v_sub_f32 v58, v24, v48
  v_sub_f32 v59, v25, v48
  v_fma_f32 v49, v58, v58, v49
  v_fma_f32 v51, v59, v59, v51
  v_sub_f32 v58, v26, v48
  v_sub_f32 v59, v27, v48
  v_fma_f32 v49, v58, v58, v49
  v_fma_f32 v51, v59, v59, v51
  v_sub_f32 v58, v28, v48
  v_sub_f32 v59, v29, v48
  v_fma_f32 v49, v58, v58, v49
  v_fma_f32 v51, v59, v59, v51
  v_sub_f32 v58, v30, v48
  v_sub_f32 v59, v31, v48
  v_fma_f32 v49, v58, v58, v49
  v_fma_f32 v51, v59, v59, v51
  v_sub_f32 v58, v32, v48
  v_sub_f32 v59, v33, v48
  v_fma_f32 v49, v58, v58, v49
  v_fma_f32 v51, v59, v59, v51
  v_sub_f32 v58, v34, v48
  v_sub_f32 v59, v35, v48
  v_fma_f32 v49, v58, v58, v49
  v_fma_f32 v51, v59, v59, v51
  v_sub_f32 v58, v36, v48
  v_sub_f32 v59, v37, v48
  v_fma_f32 v49, v58, v58, v49
  v_fma_f32 v51, v59, v59, v51
  v_sub_f32 v58, v38, v48
  v_sub_f32 v59, v39, v48
  v_fma_f32 v49, v58, v58, v49
  v_fma_f32 v51, v59, v59, v51
  v_sub_f32 v58, v40, v48
  v_sub_f32 v59, v41, v48
  v_fma_f32 v49, v58, v58, v49
  v_fma_f32 v51, v59, v59, v51
  v_sub_f32 v58, v42, v48
  v_sub_f32 v59, v43, v48
  v_fma_f32 v49, v58, v58, v49
  v_fma_f32 v51, v59, v59, v51
  v_sub_f32 v58, v44, v48
  v_sub_f32 v59, v45, v48
  v_fma_f32 v49, v58, v58, v49
  v_fma_f32 v51, v59, v59, v51
  v_sub_f32 v58, v46, v48
  v_sub_f32 v59, v47, v48
  v_fma_f32 v49, v58, v58, v49
  v_fma_f32 v51, v59, v59, v51
  v_add_f32 v49, v49, v51
  ds_bpermute_b32 v50, v6, v49
  s_waitcnt lgkmcnt(0)
  v_add_f32 v49, v49, v50
  ds_bpermute_b32 v50, v7, v49
  s_waitcnt lgkmcnt(0)
  v_add_f32 v49, v49, v50
  v_add_u32 v62, 147968, v61
  v_add_u32 v63, 147968, v60
  ds_write_b32 v62, v49
  s_waitcnt lgkmcnt(0)
  s_barrier
  ds_read_b32 v52, v63 offset:0
  ds_read_b32 v53, v63 offset:64
  ds_read_b32 v54, v63 offset:128
  ds_read_b32 v55, v63 offset:192
  ds_read_b32 v56, v63 offset:256
  ds_read_b32 v57, v63 offset:320
  s_waitcnt lgkmcnt(0)
  v_add_f32 v52, v52, v53
  v_add_f32 v54, v54, v55
  v_add_f32 v56, v56, v57
  v_add_f32 v52, v52, v54
  v_add_f32 v49, v52, v56
  v_mul_f32 v49, 0x3ae38e39, v49
  v_cvt_pk_bf16_f32 v50, v49, v49
  v_lshlrev_b32 v49, 16, v50
  v_add_f32 v49, 0x3727c5ac, v49
  v_cvt_pk_bf16_f32 v50, v49, v49
  v_lshlrev_b32 v49, 16, v50
  v_sqrt_f32 v49, v49
  s_nop 0
  v_cvt_pk_bf16_f32 v50, v49, v49
  v_lshlrev_b32 v49, 16, v50
  v_rcp_f32 v49, v49
  v_cvt_pk_bf16_f32 v50, v48, v48
  v_lshlrev_b32 v48, 16, v50
  v_sub_f32 v24, v24, v48
  v_sub_f32 v25, v25, v48
  v_cvt_pk_bf16_f32 v50, v24, v25
  v_lshlrev_b32 v24, 16, v50
  v_and_b32 v25, 0xffff0000, v50
  v_mul_f32 v24, v24, v49
  v_mul_f32 v25, v25, v49
  v_cvt_pk_bf16_f32 v8, v24, v25
  v_sub_f32 v26, v26, v48
  v_sub_f32 v27, v27, v48
  v_cvt_pk_bf16_f32 v50, v26, v27
  v_lshlrev_b32 v26, 16, v50
  v_and_b32 v27, 0xffff0000, v50
  v_mul_f32 v26, v26, v49
  v_mul_f32 v27, v27, v49
  v_cvt_pk_bf16_f32 v9, v26, v27
  v_sub_f32 v28, v28, v48
  v_sub_f32 v29, v29, v48
  v_cvt_pk_bf16_f32 v50, v28, v29
  v_lshlrev_b32 v28, 16, v50
  v_and_b32 v29, 0xffff0000, v50
  v_mul_f32 v28, v28, v49
  v_mul_f32 v29, v29, v49
  v_cvt_pk_bf16_f32 v10, v28, v29
  v_sub_f32 v30, v30, v48
  v_sub_f32 v31, v31, v48
  v_cvt_pk_bf16_f32 v50, v30, v31
  v_lshlrev_b32 v30, 16, v50
  v_and_b32 v31, 0xffff0000, v50
  v_mul_f32 v30, v30, v49
  v_mul_f32 v31, v31, v49
  v_cvt_pk_bf16_f32 v11, v30, v31
  v_sub_f32 v32, v32, v48
  v_sub_f32 v33, v33, v48
  v_cvt_pk_bf16_f32 v50, v32, v33
  v_lshlrev_b32 v32, 16, v50
  v_and_b32 v33, 0xffff0000, v50
  v_mul_f32 v32, v32, v49
  v_mul_f32 v33, v33, v49
  v_cvt_pk_bf16_f32 v12, v32, v33
  v_sub_f32 v34, v34, v48
  v_sub_f32 v35, v35, v48
  v_cvt_pk_bf16_f32 v50, v34, v35
  v_lshlrev_b32 v34, 16, v50
  v_and_b32 v35, 0xffff0000, v50
  v_mul_f32 v34, v34, v49
  v_mul_f32 v35, v35, v49
  v_cvt_pk_bf16_f32 v13, v34, v35
  v_sub_f32 v36, v36, v48
  v_sub_f32 v37, v37, v48
  v_cvt_pk_bf16_f32 v50, v36, v37
  v_lshlrev_b32 v36, 16, v50
  v_and_b32 v37, 0xffff0000, v50
  v_mul_f32 v36, v36, v49
  v_mul_f32 v37, v37, v49
  v_cvt_pk_bf16_f32 v14, v36, v37
  v_sub_f32 v38, v38, v48
  v_sub_f32 v39, v39, v48
  v_cvt_pk_bf16_f32 v50, v38, v39
  v_lshlrev_b32 v38, 16, v50
  v_and_b32 v39, 0xffff0000, v50
  v_mul_f32 v38, v38, v49
  v_mul_f32 v39, v39, v49
  v_cvt_pk_bf16_f32 v15, v38, v39
  v_sub_f32 v40, v40, v48
  v_sub_f32 v41, v41, v48
  v_cvt_pk_bf16_f32 v50, v40, v41
  v_lshlrev_b32 v40, 16, v50
  v_and_b32 v41, 0xffff0000, v50
  v_mul_f32 v40, v40, v49
  v_mul_f32 v41, v41, v49
  v_cvt_pk_bf16_f32 v16, v40, v41
  v_sub_f32 v42, v42, v48
  v_sub_f32 v43, v43, v48
  v_cvt_pk_bf16_f32 v50, v42, v43
  v_lshlrev_b32 v42, 16, v50
  v_and_b32 v43, 0xffff0000, v50
  v_mul_f32 v42, v42, v49
  v_mul_f32 v43, v43, v49
  v_cvt_pk_bf16_f32 v17, v42, v43
  v_sub_f32 v44, v44, v48
  v_sub_f32 v45, v45, v48
  v_cvt_pk_bf16_f32 v50, v44, v45
  v_lshlrev_b32 v44, 16, v50
  v_and_b32 v45, 0xffff0000, v50
  v_mul_f32 v44, v44, v49
  v_mul_f32 v45, v45, v49
  v_cvt_pk_bf16_f32 v18, v44, v45
  v_sub_f32 v46, v46, v48
  v_sub_f32 v47, v47, v48
  v_cvt_pk_bf16_f32 v50, v46, v47
  v_lshlrev_b32 v46, 16, v50
  v_and_b32 v47, 0xffff0000, v50
  v_mul_f32 v46, v46, v49
  v_mul_f32 v47, v47, v49
  v_cvt_pk_bf16_f32 v19, v46, v47
  s_cmp_ge_u32 s3, 6
  s_cbranch_scc1 p0_ln_skipstore
  s_mul_i32 s41, s40, 18
  s_mul_i32 s42, s3, 3
  s_add_u32 s41, s41, s42
  s_lshl_b32 s41, s41, 10
  buffer_store_dwordx4 v[8:11], v92, s[12:15], s41 offen offset:0 sc0 sc1
  buffer_store_dwordx4 v[12:15], v92, s[12:15], s41 offen offset:1024 sc0 sc1
  buffer_store_dwordx4 v[16:19], v92, s[12:15], s41 offen offset:2048 sc0 sc1
p0_ln_skipstore:
  s_waitcnt vmcnt(0)
  s_barrier
  s_cmp_lg_u32 s3, 0
  s_cbranch_scc1 p0_wait
  v_readfirstlane_b32 s85, v94
  s_cmp_eq_u32 s85, 0
  s_cselect_b32 s85, s84, s85
  s_lshl_b32 s41, s23, 8
  s_lshl_b32 s42, s22, 2
  s_add_u32 s41, s41, s42
  s_add_u32 s41, s41, 32768
  v_mov_b32 v3, s85
  v_mov_b32 v4, s41
  s_mov_b64 exec, 1
  buffer_store_dword v3, v4, s[32:35], 0 offen sc0 sc1
  s_mov_b64 exec, -1
  s_branch p0_wait
p0_kv:
  s_mov_b32 s82, 0
  s_lshl_b32 s40, s23, 4
  s_add_u32 s40, s40, s22
  s_sub_u32 s40, s40, 16
  s_cmp_lt_u32 s40, 72
  s_cbranch_scc1 p0_kvjob
  s_mov_b32 s29, 0
  s_add_u32 m0, s28, 0
  s_nop 0
  buffer_load_dwordx4 v80, s[8:11], s29 offen lds
  s_mov_b32 s29, 0
  s_add_u32 m0, s28, 1024
  s_nop 0
  buffer_load_dwordx4 v81, s[8:11], s29 offen lds
  s_mov_b32 s29, 0
  s_add_u32 m0, s28, 2048
  s_nop 0
  buffer_load_dwordx4 v82, s[8:11], s29 offen lds
  s_mov_b32 s29, 0
  s_add_u32 m0, s28, 3072
  s_nop 0
  buffer_load_dwordx4 v83, s[8:11], s29 offen lds
  s_mov_b32 s29, 0
  s_add_u32 m0, s28, 4096
  s_mov_b32 exec_hi, 0
  buffer_load_dwordx4 v84, s[8:11], s29 offen lds
  s_mov_b32 exec_hi, -1
  s_mov_b32 s29, 589824
  s_add_u32 m0, s28, 36864
  s_nop 0
  buffer_load_dwordx4 v80, s[8:11], s29 offen lds
  s_mov_b32 s29, 589824
  s_add_u32 m0, s28, 37888
  s_nop 0
  buffer_load_dwordx4 v81, s[8:11], s29 offen lds
  s_mov_b32 s29, 589824
  s_add_u32 m0, s28, 38912
  s_nop 0
  buffer_load_dwordx4 v82, s[8:11], s29 offen lds
  s_mov_b32 s29, 589824
  s_add_u32 m0, s28, 39936
  s_nop 0
  buffer_load_dwordx4 v83, s[8:11], s29 offen lds
  s_mov_b32 s29, 589824
  s_add_u32 m0, s28, 40960
  s_mov_b32 exec_hi, 0
  buffer_load_dwordx4 v84, s[8:11], s29 offen lds
  s_mov_b32 exec_hi, -1
  s_mov_b32 s29, 1179648
  s_add_u32 m0, s28, 73728
  s_nop 0
  buffer_load_dwordx4 v80, s[8:11], s29 offen lds
  s_mov_b32 s29, 1179648
  s_add_u32 m0, s28, 74752
  s_nop 0
  buffer_load_dwordx4 v81, s[8:11], s29 offen lds
  s_mov_b32 s29, 1179648
  s_add_u32 m0, s28, 75776
  s_nop 0
  buffer_load_dwordx4 v82, s[8:11], s29 offen lds
  s_mov_b32 s29, 1179648
  s_add_u32 m0, s28, 76800
  s_nop 0
  buffer_load_dwordx4 v83, s[8:11], s29 offen lds
  s_mov_b32 s29, 1179648
  s_add_u32 m0, s28, 77824
  s_mov_b32 exec_hi, 0
  buffer_load_dwordx4 v84, s[8:11], s29 offen lds
  s_mov_b32 exec_hi, -1
  s_sub_u32 s40, s40, 72
  s_lshl_b32 s40, s40, 3
  s_add_u32 s40, s40, s3
  s_mul_i32 s40, s40, 12288
  s_mov_b32 s4, s74
  s_mov_b32 s5, s75
  s_mov_b32 s6, 5308416
  s_mov_b32 s7, 0x00020000
  v_lshlrev_b32 v3, 7, v2
  buffer_load_dword v96, v3, s[4:7], s40 offen
  s_add_u32 s40, s40, 8192
  s_mov_b32 exec_hi, 0
  buffer_load_dword v97, v3, s[4:7], s40 offen
  s_mov_b32 exec_hi, -1
  s_mov_b32 s82, 2
  s_waitcnt vmcnt(2)
  s_branch p0_wait
p0_kvjob:
  s_mov_b32 s82, 1
  s_lshl_b32 s40, s40, 3
  s_add_u32 s40, s40, s3
  s_mov_b32 s4, s58
  s_mov_b32 s5, s59
  s_mov_b32 s6, 2359296
  s_mov_b32 s7, 0x00020000
  s_mov_b32 s44, s60
  s_mov_b32 s45, s61
  s_mov_b32 s46, 2359296
  s_mov_b32 s47, 0x00020000
  s_mov_b32 s48, s62
  s_mov_b32 s49, s63
  s_mov_b32 s50, 4608
  s_mov_b32 s51, 0x00020000
  s_add_u32 s52, s80, 2359296
  s_addc_u32 s53, s81, 0
  s_mov_b32 s54, 2654208
  s_mov_b32 s55, 0x00020000
  s_mul_i32 s41, s40, 7282
  s_lshr_b32 s41, s41, 16
  s_mul_i32 s42, s41, 9
  s_sub_u32 s40, s40, s42
  v_lshrrev_b32 v3, 5, v2
  v_and_b32 v4, 31, v2
  s_lshl_b32 s42, s41, 5
  v_lshlrev_b32 v5, 4, v3
  v_add_u32 v5, s42, v5
  s_lshl_b32 s42, s40, 5
  v_add_u32 v6, s42, v4
  s_movk_i32 s42, 1152
  v_mul_lo_u32 v7, v5, s42
  v_lshl_add_u32 v7, v6, 2, v7
  v_add_u32 v120, 0, v7
  v_add_u32 v121, 3456, v7
  v_add_u32 v122, 6912, v7
  v_add_u32 v123, 10368, v7
  v_add_u32 v124, 13824, v7
  v_add_u32 v125, 17280, v7
  v_lshlrev_b32 v9, 4, v6
  buffer_load_dwordx4 v[60:63], v9, s[48:51], 0 offen
  v_subrev_u32 v9, 3456, v7
  buffer_load_dword v16, v9, s[4:7], 0 offen
  v_subrev_u32 v9, 2304, v7
  buffer_load_dword v17, v9, s[4:7], 0 offen
  v_subrev_u32 v9, 1152, v7
  buffer_load_dword v18, v9, s[4:7], 0 offen
  buffer_load_dword v19, v120, s[4:7], 0 offen offset:0
  buffer_load_dword v20, v120, s[4:7], 0 offen offset:1152
  buffer_load_dword v21, v120, s[4:7], 0 offen offset:2304
  buffer_load_dword v22, v121, s[4:7], 0 offen offset:0
  buffer_load_dword v23, v121, s[4:7], 0 offen offset:1152
  buffer_load_dword v24, v121, s[4:7], 0 offen offset:2304
  buffer_load_dword v25, v122, s[4:7], 0 offen offset:0
  buffer_load_dword v26, v122, s[4:7], 0 offen offset:1152
  buffer_load_dword v27, v122, s[4:7], 0 offen offset:2304
  buffer_load_dword v28, v123, s[4:7], 0 offen offset:0
  buffer_load_dword v29, v123, s[4:7], 0 offen offset:1152
  buffer_load_dword v30, v123, s[4:7], 0 offen offset:2304
  buffer_load_dword v31, v124, s[4:7], 0 offen offset:0
  buffer_load_dword v32, v124, s[4:7], 0 offen offset:1152
  buffer_load_dword v33, v124, s[4:7], 0 offen offset:2304
  buffer_load_dword v34, v125, s[4:7], 0 offen offset:0
  buffer_load_dword v40, v120, s[44:47], 0 offen offset:0
  buffer_load_dword v41, v120, s[44:47], 0 offen offset:1152
  buffer_load_dword v42, v120, s[44:47], 0 offen offset:2304
  buffer_load_dword v43, v121, s[44:47], 0 offen offset:0
  buffer_load_dword v44, v121, s[44:47], 0 offen offset:1152
  buffer_load_dword v45, v121, s[44:47], 0 offen offset:2304
  buffer_load_dword v46, v122, s[44:47], 0 offen offset:0
  buffer_load_dword v47, v122, s[44:47], 0 offen offset:1152
  buffer_load_dword v48, v122, s[44:47], 0 offen offset:2304
  buffer_load_dword v49, v123, s[44:47], 0 offen offset:0
  buffer_load_dword v50, v123, s[44:47], 0 offen offset:1152
  buffer_load_dword v51, v123, s[44:47], 0 offen offset:2304
  buffer_load_dword v52, v124, s[44:47], 0 offen offset:0
  buffer_load_dword v53, v124, s[44:47], 0 offen offset:1152
  buffer_load_dword v54, v124, s[44:47], 0 offen offset:2304
  buffer_load_dword v55, v125, s[44:47], 0 offen offset:0
  s_mov_b32 s29, 0
  s_add_u32 m0, s28, 0
  s_nop 0
  buffer_load_dwordx4 v80, s[8:11], s29 offen lds
  s_mov_b32 s29, 0
  s_add_u32 m0, s28, 1024
  s_nop 0
  buffer_load_dwordx4 v81, s[8:11], s29 offen lds
  s_mov_b32 s29, 0
  s_add_u32 m0, s28, 2048
  s_nop 0
  buffer_load_dwordx4 v82, s[8:11], s29 offen lds
  s_mov_b32 s29, 0
  s_add_u32 m0, s28, 3072
  s_nop 0
  buffer_load_dwordx4 v83, s[8:11], s29 offen lds
  s_mov_b32 s29, 0
  s_add_u32 m0, s28, 4096
  s_mov_b32 exec_hi, 0
  buffer_load_dwordx4 v84, s[8:11], s29 offen lds
  s_mov_b32 exec_hi, -1
  s_mov_b32 s29, 589824
  s_add_u32 m0, s28, 36864
  s_nop 0
  buffer_load_dwordx4 v80, s[8:11], s29 offen lds
  s_mov_b32 s29, 589824
  s_add_u32 m0, s28, 37888
  s_nop 0
  buffer_load_dwordx4 v81, s[8:11], s29 offen lds
  s_mov_b32 s29, 589824
  s_add_u32 m0, s28, 38912
  s_nop 0
  buffer_load_dwordx4 v82, s[8:11], s29 offen lds
  s_mov_b32 s29, 589824
  s_add_u32 m0, s28, 39936
  s_nop 0
  buffer_load_dwordx4 v83, s[8:11], s29 offen lds
  s_mov_b32 s29, 589824
  s_add_u32 m0, s28, 40960
  s_mov_b32 exec_hi, 0
  buffer_load_dwordx4 v84, s[8:11], s29 offen lds
  s_mov_b32 exec_hi, -1
  s_mov_b32 s29, 1179648
  s_add_u32 m0, s28, 73728
  s_nop 0
  buffer_load_dwordx4 v80, s[8:11], s29 offen lds
  s_mov_b32 s29, 1179648
  s_add_u32 m0, s28, 74752
  s_nop 0
  buffer_load_dwordx4 v81, s[8:11], s29 offen lds
  s_mov_b32 s29, 1179648
  s_add_u32 m0, s28, 75776
  s_nop 0
  buffer_load_dwordx4 v82, s[8:11], s29 offen lds
  s_mov_b32 s29, 1179648
  s_add_u32 m0, s28, 76800
  s_nop 0
  buffer_load_dwordx4 v83, s[8:11], s29 offen lds
  s_mov_b32 s29, 1179648
  s_add_u32 m0, s28, 77824
  s_mov_b32 exec_hi, 0
  buffer_load_dwordx4 v84, s[8:11], s29 offen lds
  s_mov_b32 exec_hi, -1
  s_lshl_b32 s42, s3, 12
  s_add_u32 s42, s42, 110592
  v_lshlrev_b32 v10, 7, v4
  v_sub_u32 v11, 1, v3
  v_lshl_add_u32 v10, v11, 3, v10
  v_add_u32 v10, s42, v10
  v_add_u32 v11, s42, v92
  v_lshrrev_b32 v12, 2, v2
  s_lshl_b32 s42, s40, 6
  v_add_u32 v12, s42, v12
  v_mul_u32_u24 v12, 4608, v12
  v_and_b32 v13, 3, v2
  v_lshl_add_u32 v12, v13, 4, v12
  s_sub_u32 s42, 63, s41
  s_lshr_b32 s43, s42, 1
  s_mul_i32 s43, s43, 144
  s_and_b32 s42, s42, 1
  s_lshl_b32 s42, s42, 6
  s_add_u32 s40, s42, s43
  s_mov_b32 s42, 0x05040100
  s_mov_b32 s43, 0x07060302
  s_waitcnt vmcnt(31)
  v_lshlrev_b32 v128, 16, v60
  v_and_b32 v130, 0xffff0000, v60
  v_lshlrev_b32 v132, 16, v61
  v_and_b32 v134, 0xffff0000, v61
  v_lshlrev_b32 v129, 16, v62
  v_and_b32 v131, 0xffff0000, v62
  v_lshlrev_b32 v133, 16, v63
  v_and_b32 v135, 0xffff0000, v63
  v_lshlrev_b32 v136, 16, v16
  v_and_b32 v137, 0xffff0000, v16
  v_lshlrev_b32 v138, 16, v17
  v_and_b32 v139, 0xffff0000, v17
  v_lshlrev_b32 v140, 16, v18
  v_and_b32 v141, 0xffff0000, v18
  v_lshlrev_b32 v142, 16, v19
  v_and_b32 v143, 0xffff0000, v19
  v_lshlrev_b32 v144, 16, v20
  v_and_b32 v145, 0xffff0000, v20
  v_lshlrev_b32 v146, 16, v21
  v_and_b32 v147, 0xffff0000, v21
  v_lshlrev_b32 v148, 16, v22
  v_and_b32 v149, 0xffff0000, v22
  v_lshlrev_b32 v150, 16, v23
  v_and_b32 v151, 0xffff0000, v23
  v_lshlrev_b32 v152, 16, v24
  v_and_b32 v153, 0xffff0000, v24
  v_lshlrev_b32 v154, 16, v25
  v_and_b32 v155, 0xffff0000, v25
  v_lshlrev_b32 v156, 16, v26
  v_and_b32 v157, 0xffff0000, v26
  v_lshlrev_b32 v158, 16, v27
  v_and_b32 v159, 0xffff0000, v27
  v_lshlrev_b32 v160, 16, v28
  v_and_b32 v161, 0xffff0000, v28
  v_lshlrev_b32 v162, 16, v29
  v_and_b32 v163, 0xffff0000, v29
  v_lshlrev_b32 v164, 16, v30
  v_and_b32 v165, 0xffff0000, v30
  v_lshlrev_b32 v166, 16, v31
  v_and_b32 v167, 0xffff0000, v31
  v_lshlrev_b32 v168, 16, v32
  v_and_b32 v169, 0xffff0000, v32
  v_lshlrev_b32 v170, 16, v33
  v_and_b32 v171, 0xffff0000, v33
  v_lshlrev_b32 v172, 16, v34
  v_and_b32 v173, 0xffff0000, v34
  s_waitcnt vmcnt(15)
  v_pk_mul_f32 v[176:177], v[136:137], v[134:135]
  v_pk_mul_f32 v[182:183], v[138:139], v[134:135]
  v_pk_mul_f32 v[188:189], v[140:141], v[134:135]
  v_pk_mul_f32 v[194:195], v[142:143], v[134:135]
  v_pk_fma_f32 v[176:177], v[138:139], v[132:133], v[176:177]
  v_pk_fma_f32 v[182:183], v[140:141], v[132:133], v[182:183]
  v_pk_fma_f32 v[188:189], v[142:143], v[132:133], v[188:189]
  v_pk_fma_f32 v[194:195], v[144:145], v[132:133], v[194:195]
  v_pk_fma_f32 v[176:177], v[140:141], v[130:131], v[176:177]
  v_pk_fma_f32 v[182:183], v[142:143], v[130:131], v[182:183]
  v_pk_fma_f32 v[188:189], v[144:145], v[130:131], v[188:189]
  v_pk_fma_f32 v[194:195], v[146:147], v[130:131], v[194:195]
  v_pk_fma_f32 v[176:177], v[142:143], v[128:129], v[176:177]
  v_pk_fma_f32 v[182:183], v[144:145], v[128:129], v[182:183]
  v_pk_fma_f32 v[188:189], v[146:147], v[128:129], v[188:189]
  v_pk_fma_f32 v[194:195], v[148:149], v[128:129], v[194:195]
  v_cvt_pk_bf16_f32 v180, v176, v177
  v_cvt_pk_bf16_f32 v186, v182, v183
  v_cvt_pk_bf16_f32 v192, v188, v189
  v_cvt_pk_bf16_f32 v198, v194, v195
  v_lshlrev_b32 v176, 16, v180
  v_and_b32 v177, 0xffff0000, v180
  v_lshlrev_b32 v178, 16, v40
  v_and_b32 v179, 0xffff0000, v40
  v_lshlrev_b32 v182, 16, v186
  v_and_b32 v183, 0xffff0000, v186
  v_lshlrev_b32 v184, 16, v41
  v_and_b32 v185, 0xffff0000, v41
  v_lshlrev_b32 v188, 16, v192
  v_and_b32 v189, 0xffff0000, v192
  v_lshlrev_b32 v190, 16, v42
  v_and_b32 v191, 0xffff0000, v42
  v_lshlrev_b32 v194, 16, v198
  v_and_b32 v195, 0xffff0000, v198
  v_lshlrev_b32 v196, 16, v43
  v_and_b32 v197, 0xffff0000, v43
  v_pk_mul_f32 v[176:177], v[176:177], v[178:179]
  v_pk_mul_f32 v[182:183], v[182:183], v[184:185]
  v_pk_mul_f32 v[188:189], v[188:189], v[190:191]
  v_pk_mul_f32 v[194:195], v[194:195], v[196:197]
  v_cvt_pk_bf16_f32 v40, v176, v177
  v_cvt_pk_bf16_f32 v41, v182, v183
  v_cvt_pk_bf16_f32 v42, v188, v189
  v_cvt_pk_bf16_f32 v43, v194, v195
  v_pk_mul_f32 v[176:177], v[144:145], v[134:135]
  v_pk_mul_f32 v[182:183], v[146:147], v[134:135]
  v_pk_mul_f32 v[188:189], v[148:149], v[134:135]
  v_pk_mul_f32 v[194:195], v[150:151], v[134:135]
  v_pk_fma_f32 v[176:177], v[146:147], v[132:133], v[176:177]
  v_pk_fma_f32 v[182:183], v[148:149], v[132:133], v[182:183]
  v_pk_fma_f32 v[188:189], v[150:151], v[132:133], v[188:189]
  v_pk_fma_f32 v[194:195], v[152:153], v[132:133], v[194:195]
  v_pk_fma_f32 v[176:177], v[148:149], v[130:131], v[176:177]
  v_pk_fma_f32 v[182:183], v[150:151], v[130:131], v[182:183]
  v_pk_fma_f32 v[188:189], v[152:153], v[130:131], v[188:189]
  v_pk_fma_f32 v[194:195], v[154:155], v[130:131], v[194:195]
  v_pk_fma_f32 v[176:177], v[150:151], v[128:129], v[176:177]
  v_pk_fma_f32 v[182:183], v[152:153], v[128:129], v[182:183]
  v_pk_fma_f32 v[188:189], v[154:155], v[128:129], v[188:189]
  v_pk_fma_f32 v[194:195], v[156:157], v[128:129], v[194:195]
  v_cvt_pk_bf16_f32 v180, v176, v177
  v_cvt_pk_bf16_f32 v186, v182, v183
  v_cvt_pk_bf16_f32 v192, v188, v189
  v_cvt_pk_bf16_f32 v198, v194, v195
  v_lshlrev_b32 v176, 16, v180
  v_and_b32 v177, 0xffff0000, v180
  v_lshlrev_b32 v178, 16, v44
  v_and_b32 v179, 0xffff0000, v44
  v_lshlrev_b32 v182, 16, v186
  v_and_b32 v183, 0xffff0000, v186
  v_lshlrev_b32 v184, 16, v45
  v_and_b32 v185, 0xffff0000, v45
  v_lshlrev_b32 v188, 16, v192
  v_and_b32 v189, 0xffff0000, v192
  v_lshlrev_b32 v190, 16, v46
  v_and_b32 v191, 0xffff0000, v46
  v_lshlrev_b32 v194, 16, v198
  v_and_b32 v195, 0xffff0000, v198
  v_lshlrev_b32 v196, 16, v47
  v_and_b32 v197, 0xffff0000, v47
  v_pk_mul_f32 v[176:177], v[176:177], v[178:179]
  v_pk_mul_f32 v[182:183], v[182:183], v[184:185]
  v_pk_mul_f32 v[188:189], v[188:189], v[190:191]
  v_pk_mul_f32 v[194:195], v[194:195], v[196:197]
  v_cvt_pk_bf16_f32 v44, v176, v177
  v_cvt_pk_bf16_f32 v45, v182, v183
  v_cvt_pk_bf16_f32 v46, v188, v189
  v_cvt_pk_bf16_f32 v47, v194, v195
  v_pk_mul_f32 v[176:177], v[152:153], v[134:135]
  v_pk_mul_f32 v[182:183], v[154:155], v[134:135]
  v_pk_mul_f32 v[188:189], v[156:157], v[134:135]
  v_pk_mul_f32 v[194:195], v[158:159], v[134:135]
  v_pk_fma_f32 v[176:177], v[154:155], v[132:133], v[176:177]
  v_pk_fma_f32 v[182:183], v[156:157], v[132:133], v[182:183]
  v_pk_fma_f32 v[188:189], v[158:159], v[132:133], v[188:189]
  v_pk_fma_f32 v[194:195], v[160:161], v[132:133], v[194:195]
  v_pk_fma_f32 v[176:177], v[156:157], v[130:131], v[176:177]
  v_pk_fma_f32 v[182:183], v[158:159], v[130:131], v[182:183]
  v_pk_fma_f32 v[188:189], v[160:161], v[130:131], v[188:189]
  v_pk_fma_f32 v[194:195], v[162:163], v[130:131], v[194:195]
  v_pk_fma_f32 v[176:177], v[158:159], v[128:129], v[176:177]
  v_pk_fma_f32 v[182:183], v[160:161], v[128:129], v[182:183]
  v_pk_fma_f32 v[188:189], v[162:163], v[128:129], v[188:189]
  v_pk_fma_f32 v[194:195], v[164:165], v[128:129], v[194:195]
  v_cvt_pk_bf16_f32 v180, v176, v177
  v_cvt_pk_bf16_f32 v186, v182, v183
  v_cvt_pk_bf16_f32 v192, v188, v189
  v_cvt_pk_bf16_f32 v198, v194, v195
  v_lshlrev_b32 v176, 16, v180
  v_and_b32 v177, 0xffff0000, v180
  v_lshlrev_b32 v178, 16, v48
  v_and_b32 v179, 0xffff0000, v48
  v_lshlrev_b32 v182, 16, v186
  v_and_b32 v183, 0xffff0000, v186
  v_lshlrev_b32 v184, 16, v49
  v_and_b32 v185, 0xffff0000, v49
  v_lshlrev_b32 v188, 16, v192
  v_and_b32 v189, 0xffff0000, v192
  v_lshlrev_b32 v190, 16, v50
  v_and_b32 v191, 0xffff0000, v50
  v_lshlrev_b32 v194, 16, v198
  v_and_b32 v195, 0xffff0000, v198
  v_lshlrev_b32 v196, 16, v51
  v_and_b32 v197, 0xffff0000, v51
  v_pk_mul_f32 v[176:177], v[176:177], v[178:179]
  v_pk_mul_f32 v[182:183], v[182:183], v[184:185]
  v_pk_mul_f32 v[188:189], v[188:189], v[190:191]
  v_pk_mul_f32 v[194:195], v[194:195], v[196:197]
  v_cvt_pk_bf16_f32 v48, v176, v177
  v_cvt_pk_bf16_f32 v49, v182, v183
  v_cvt_pk_bf16_f32 v50, v188, v189
  v_cvt_pk_bf16_f32 v51, v194, v195
  v_pk_mul_f32 v[176:177], v[160:161], v[134:135]
  v_pk_mul_f32 v[182:183], v[162:163], v[134:135]
  v_pk_mul_f32 v[188:189], v[164:165], v[134:135]
  v_pk_mul_f32 v[194:195], v[166:167], v[134:135]
  v_pk_fma_f32 v[176:177], v[162:163], v[132:133], v[176:177]
  v_pk_fma_f32 v[182:183], v[164:165], v[132:133], v[182:183]
  v_pk_fma_f32 v[188:189], v[166:167], v[132:133], v[188:189]
  v_pk_fma_f32 v[194:195], v[168:169], v[132:133], v[194:195]
  v_pk_fma_f32 v[176:177], v[164:165], v[130:131], v[176:177]
  v_pk_fma_f32 v[182:183], v[166:167], v[130:131], v[182:183]
  v_pk_fma_f32 v[188:189], v[168:169], v[130:131], v[188:189]
  v_pk_fma_f32 v[194:195], v[170:171], v[130:131], v[194:195]
  v_pk_fma_f32 v[176:177], v[166:167], v[128:129], v[176:177]
  v_pk_fma_f32 v[182:183], v[168:169], v[128:129], v[182:183]
  v_pk_fma_f32 v[188:189], v[170:171], v[128:129], v[188:189]
  v_pk_fma_f32 v[194:195], v[172:173], v[128:129], v[194:195]
  v_cvt_pk_bf16_f32 v180, v176, v177
  v_cvt_pk_bf16_f32 v186, v182, v183
  v_cvt_pk_bf16_f32 v192, v188, v189
  v_cvt_pk_bf16_f32 v198, v194, v195
  v_lshlrev_b32 v176, 16, v180
  v_and_b32 v177, 0xffff0000, v180
  v_lshlrev_b32 v178, 16, v52
  v_and_b32 v179, 0xffff0000, v52
  v_lshlrev_b32 v182, 16, v186
  v_and_b32 v183, 0xffff0000, v186
  v_lshlrev_b32 v184, 16, v53
  v_and_b32 v185, 0xffff0000, v53
  v_lshlrev_b32 v188, 16, v192
  v_and_b32 v189, 0xffff0000, v192
  v_lshlrev_b32 v190, 16, v54
  v_and_b32 v191, 0xffff0000, v54
  v_lshlrev_b32 v194, 16, v198
  v_and_b32 v195, 0xffff0000, v198
  v_lshlrev_b32 v196, 16, v55
  v_and_b32 v197, 0xffff0000, v55
  v_pk_mul_f32 v[176:177], v[176:177], v[178:179]
  v_pk_mul_f32 v[182:183], v[182:183], v[184:185]
  v_pk_mul_f32 v[188:189], v[188:189], v[190:191]
  v_pk_mul_f32 v[194:195], v[194:195], v[196:197]
  v_cvt_pk_bf16_f32 v52, v176, v177
  v_cvt_pk_bf16_f32 v53, v182, v183
  v_cvt_pk_bf16_f32 v54, v188, v189
  v_cvt_pk_bf16_f32 v55, v194, v195
  v_perm_b32 v136, v54, v55, s42
  v_perm_b32 v137, v52, v53, s42
  v_perm_b32 v138, v54, v55, s43
  v_perm_b32 v139, v52, v53, s43
  v_perm_b32 v140, v50, v51, s42
  v_perm_b32 v141, v48, v49, s42
  v_perm_b32 v142, v50, v51, s43
  v_perm_b32 v143, v48, v49, s43
  v_perm_b32 v144, v46, v47, s42
  v_perm_b32 v145, v44, v45, s42
  v_perm_b32 v146, v46, v47, s43
  v_perm_b32 v147, v44, v45, s43
  v_perm_b32 v148, v42, v43, s42
  v_perm_b32 v149, v40, v41, s42
  v_perm_b32 v150, v42, v43, s43
  v_perm_b32 v151, v40, v41, s43
  ds_write_b64 v10, v[136:137] offset:0
  ds_write_b64 v10, v[138:139] offset:64
  ds_write_b64 v10, v[140:141] offset:16
  ds_write_b64 v10, v[142:143] offset:80
  ds_write_b64 v10, v[144:145] offset:32
  ds_write_b64 v10, v[146:147] offset:96
  ds_write_b64 v10, v[148:149] offset:48
  ds_write_b64 v10, v[150:151] offset:112
  s_waitcnt lgkmcnt(0) vmcnt(0)
  ds_read_b128 v[96:99], v11 offset:0
  ds_read_b128 v[100:103], v11 offset:1024
  ds_read_b128 v[104:107], v11 offset:2048
  ds_read_b128 v[108:111], v11 offset:3072
  s_waitcnt lgkmcnt(3)
  buffer_store_dwordx4 v[96:99], v12, s[52:55], s40 offen sc0 sc1
  v_add_u32 v12, 73728, v12
  s_waitcnt lgkmcnt(2)
  buffer_store_dwordx4 v[100:103], v12, s[52:55], s40 offen sc0 sc1
  v_add_u32 v12, 73728, v12
  s_waitcnt lgkmcnt(1)
  buffer_store_dwordx4 v[104:107], v12, s[52:55], s40 offen sc0 sc1
  v_add_u32 v12, 73728, v12
  s_waitcnt lgkmcnt(0)
  buffer_store_dwordx4 v[108:111], v12, s[52:55], s40 offen sc0 sc1
p0_wait:
  s_cmp_lg_u32 s3, 0
  s_cbranch_scc1 p0_go
  s_waitcnt vmcnt(0)
  v_readfirstlane_b32 s85, v94
  s_cmp_eq_u32 s85, 0
  s_cselect_b32 s85, s84, s85
  v_and_b32 v4, 15, v2
  v_lshlrev_b32 v4, 2, v4
  s_lshl_b32 s41, s23, 8
  s_add_u32 s41, s41, 32768
  s_mov_b32 s43, 0
  v_mov_b32 v5, 148472
  v_mov_b32 v6, s85
  ds_write_b32 v5, v6
p0_poll:
  buffer_load_dword v3, v4, s[32:35], s41 offen sc0 sc1
  s_waitcnt vmcnt(0)
  v_cmp_ne_u32 vcc, s85, v3
  s_cmp_eq_u64 vcc, 0
  s_cbranch_scc1 p0_go
  s_add_u32 s43, s43, 1
  s_cmp_ge_u32 s43, 200000
  s_cbranch_scc1 p0_go
  s_sleep 2
  s_branch p0_poll
p0_go:
  s_cmp_lg_u32 s82, 0
  s_cbranch_scc1 p0_go2
  s_waitcnt vmcnt(0)
p0_go2:
  s_waitcnt lgkmcnt(0)
  s_barrier
  v_mov_b32 v5, 148472
  ds_read_b32 v6, v5
  s_waitcnt lgkmcnt(0)
  v_readfirstlane_b32 s85, v6
  s_movk_i32 s50, 0
  s_movk_i32 s51, 4096
  s_movk_i32 s52, 8192
  s_movk_i32 s53, 12288
  s_movk_i32 s54, 16384
  s_lshr_b32 s27, s3, 1
  s_and_b32 s46, s3, 1
  s_mul_i32 s47, s2, 3
  s_lshl_b32 s55, s2, 1
  s_add_u32 s55, s55, 64
  s_cmp_lt_u32 s2, 64
  s_cselect_b32 s47, s47, s55
  s_cselect_b32 s55, 3, 2
  s_add_u32 s47, s47, s27
  s_cmp_lt_u32 s27, s55
  s_cselect_b32 s83, 1, 0
  s_cselect_b32 s47, s47, 0
  s_mul_i32 s44, s27, 23920
  s_add_u32 s44, s44, 36864
  s_lshl_b32 s45, s47, 12
  s_add_u32 s4, s64, s45
  s_addc_u32 s5, s65, 0
  s_movk_i32 s6, 4096
  s_mov_b32 s7, 0x00020000
  s_mul_i32 s27, s47, 4608
  s_add_u32 s27, s27, 2359296
  s_add_u32 s40, s80, s27
  s_addc_u32 s41, s81, 0
  s_movk_i32 s42, 4608
  s_mov_b32 s43, 0x00020000
  s_lshl_b32 s25, s24, 5
  s_add_u32 s25, s25, s22
  s_mul_i32 s25, s25, 4608
  s_add_u32 s26, s25, 147456
  s_mov_b32 s30, 0xbfb8aa3b
  buffer_load_dwordx4 v[16:19], v85, s[12:15], s50 offen offset:0 sc1
  buffer_load_dwordx4 v[20:23], v86, s[12:15], s50 offen offset:0 sc1
  ds_read_b64_tr_b16 v[48:49], v88 offset:0
  ds_read_b64_tr_b16 v[50:51], v88 offset:4608
  ds_read_b64_tr_b16 v[52:53], v88 offset:18432
  ds_read_b64_tr_b16 v[54:55], v88 offset:23040
  ds_read_b64_tr_b16 v[56:57], v88 offset:32
  ds_read_b64_tr_b16 v[58:59], v88 offset:4640
  ds_read_b64_tr_b16 v[60:61], v88 offset:18464
  ds_read_b64_tr_b16 v[62:63], v88 offset:23072
  ds_read_b64_tr_b16 v[64:65], v88 offset:64
  ds_read_b64_tr_b16 v[66:67], v88 offset:4672
  ds_read_b64_tr_b16 v[68:69], v88 offset:18496
  ds_read_b64_tr_b16 v[70:71], v88 offset:23104
  s_waitcnt vmcnt(0)
  s_waitcnt lgkmcnt(8)
  v_mfma_f32_16x16x32_bf16 v[112:115], v[48:51], v[16:19], 0
  ds_read_b64_tr_b16 v[72:73], v88 offset:96
  v_mfma_f32_16x16x32_bf16 v[116:119], v[48:51], v[20:23], 0
  ds_read_b64_tr_b16 v[74:75], v88 offset:4704
  buffer_load_dwordx4 v[24:27], v85, s[12:15], s50 offen offset:1024 sc1
  buffer_load_dwordx4 v[28:31], v86, s[12:15], s50 offen offset:1024 sc1
  v_mfma_f32_16x16x32_bf16 v[184:187], v[52:55], v[16:19], 0
  ds_read_b64_tr_b16 v[76:77], v88 offset:18528
  v_mfma_f32_16x16x32_bf16 v[188:191], v[52:55], v[20:23], 0
  ds_read_b64_tr_b16 v[78:79], v88 offset:23136
  s_waitcnt lgkmcnt(8)
  v_mfma_f32_16x16x32_bf16 v[120:123], v[56:59], v[16:19], 0
  ds_read_b64_tr_b16 v[48:49], v88 offset:128
  v_mfma_f32_16x16x32_bf16 v[124:127], v[56:59], v[20:23], 0
  ds_read_b64_tr_b16 v[50:51], v88 offset:4736
  v_mfma_f32_16x16x32_bf16 v[192:195], v[60:63], v[16:19], 0
  ds_read_b64_tr_b16 v[52:53], v88 offset:18560
  v_mfma_f32_16x16x32_bf16 v[196:199], v[60:63], v[20:23], 0
  ds_read_b64_tr_b16 v[54:55], v88 offset:23168
  buffer_load_dwordx4 v[32:35], v85, s[12:15], s50 offen offset:2048 sc1
  buffer_load_dwordx4 v[36:39], v86, s[12:15], s50 offen offset:2048 sc1
  s_waitcnt lgkmcnt(8)
  v_mfma_f32_16x16x32_bf16 v[128:131], v[64:67], v[16:19], 0
  ds_read_b64_tr_b16 v[56:57], v88 offset:160
  v_mfma_f32_16x16x32_bf16 v[132:135], v[64:67], v[20:23], 0
  ds_read_b64_tr_b16 v[58:59], v88 offset:4768
  v_mfma_f32_16x16x32_bf16 v[200:203], v[68:71], v[16:19], 0
  ds_read_b64_tr_b16 v[60:61], v88 offset:18592
  v_mfma_f32_16x16x32_bf16 v[204:207], v[68:71], v[20:23], 0
  ds_read_b64_tr_b16 v[62:63], v88 offset:23200
  s_waitcnt lgkmcnt(8)
  v_mfma_f32_16x16x32_bf16 v[136:139], v[72:75], v[16:19], 0
  ds_read_b64_tr_b16 v[64:65], v88 offset:192
  v_mfma_f32_16x16x32_bf16 v[140:143], v[72:75], v[20:23], 0
  ds_read_b64_tr_b16 v[66:67], v88 offset:4800
  buffer_load_dwordx4 v[40:43], v85, s[12:15], s50 offen offset:3072 sc1
  buffer_load_dwordx4 v[44:47], v86, s[12:15], s50 offen offset:3072 sc1
  v_mfma_f32_16x16x32_bf16 v[208:211], v[76:79], v[16:19], 0
  ds_read_b64_tr_b16 v[68:69], v88 offset:18624
  v_mfma_f32_16x16x32_bf16 v[212:215], v[76:79], v[20:23], 0
  ds_read_b64_tr_b16 v[70:71], v88 offset:23232
  s_waitcnt lgkmcnt(8)
  v_mfma_f32_16x16x32_bf16 v[144:147], v[48:51], v[16:19], 0
  ds_read_b64_tr_b16 v[72:73], v88 offset:224
  v_mfma_f32_16x16x32_bf16 v[148:151], v[48:51], v[20:23], 0
  ds_read_b64_tr_b16 v[74:75], v88 offset:4832
  v_mfma_f32_16x16x32_bf16 v[216:219], v[52:55], v[16:19], 0
  ds_read_b64_tr_b16 v[76:77], v88 offset:18656
  v_mfma_f32_16x16x32_bf16 v[220:223], v[52:55], v[20:23], 0
  ds_read_b64_tr_b16 v[78:79], v88 offset:23264
  s_waitcnt lgkmcnt(8)
  v_mfma_f32_16x16x32_bf16 v[152:155], v[56:59], v[16:19], 0
  ds_read_b64_tr_b16 v[48:49], v88 offset:256
  v_mfma_f32_16x16x32_bf16 v[156:159], v[56:59], v[20:23], 0
  ds_read_b64_tr_b16 v[50:51], v88 offset:4864
  v_mfma_f32_16x16x32_bf16 v[224:227], v[60:63], v[16:19], 0
  ds_read_b64_tr_b16 v[52:53], v88 offset:18688
  v_mfma_f32_16x16x32_bf16 v[228:231], v[60:63], v[20:23], 0
  ds_read_b64_tr_b16 v[54:55], v88 offset:23296
  s_waitcnt lgkmcnt(8)
  v_mfma_f32_16x16x32_bf16 v[160:163], v[64:67], v[16:19], 0
  ds_read_b64_tr_b16 v[56:57], v88 offset:9216
  v_mfma_f32_16x16x32_bf16 v[164:167], v[64:67], v[20:23], 0
  ds_read_b64_tr_b16 v[58:59], v88 offset:13824
  v_mfma_f32_16x16x32_bf16 v[232:235], v[68:71], v[16:19], 0
  ds_read_b64_tr_b16 v[60:61], v88 offset:27648
  v_mfma_f32_16x16x32_bf16 v[236:239], v[68:71], v[20:23], 0
  ds_read_b64_tr_b16 v[62:63], v88 offset:32256
  s_waitcnt lgkmcnt(8)
  v_mfma_f32_16x16x32_bf16 v[168:171], v[72:75], v[16:19], 0
  ds_read_b64_tr_b16 v[64:65], v88 offset:9248
  v_mfma_f32_16x16x32_bf16 v[172:175], v[72:75], v[20:23], 0
  ds_read_b64_tr_b16 v[66:67], v88 offset:13856
  v_mfma_f32_16x16x32_bf16 v[240:243], v[76:79], v[16:19], 0
  ds_read_b64_tr_b16 v[68:69], v88 offset:27680
  v_mfma_f32_16x16x32_bf16 v[244:247], v[76:79], v[20:23], 0
  ds_read_b64_tr_b16 v[70:71], v88 offset:32288
  s_waitcnt lgkmcnt(8)
  v_mfma_f32_16x16x32_bf16 v[176:179], v[48:51], v[16:19], 0
  ds_read_b64_tr_b16 v[72:73], v88 offset:9280
  v_mfma_f32_16x16x32_bf16 v[180:183], v[48:51], v[20:23], 0
  ds_read_b64_tr_b16 v[74:75], v88 offset:13888
  v_mfma_f32_16x16x32_bf16 v[248:251], v[52:55], v[16:19], 0
  ds_read_b64_tr_b16 v[76:77], v88 offset:27712
  v_mfma_f32_16x16x32_bf16 v[252:255], v[52:55], v[20:23], 0
  ds_read_b64_tr_b16 v[78:79], v88 offset:32320
  buffer_load_dwordx4 v[16:19], v85, s[12:15], s51 offen offset:0 sc1
  buffer_load_dwordx4 v[20:23], v86, s[12:15], s51 offen offset:0 sc1
  s_barrier
  s_cmp_eq_u32 s3, 0
  s_cselect_b32 s27, s82, 0
  s_cmp_eq_u32 s27, 1
  s_cselect_b32 s27, 128, 0xfffffff0
  v_mov_b32 v3, 1
  v_mov_b32 v4, s27
  s_mov_b64 exec, 1
  buffer_atomic_add v3, v4, s[36:39], 0 offen sc1
  s_mov_b64 exec, -1
  s_waitcnt vmcnt(7)
  s_waitcnt lgkmcnt(8)
  v_mfma_f32_16x16x32_bf16 v[112:115], v[56:59], v[24:27], v[112:115]
  ds_read_b64_tr_b16 v[48:49], v88 offset:9312
  v_mfma_f32_16x16x32_bf16 v[116:119], v[56:59], v[28:31], v[116:119]
  ds_read_b64_tr_b16 v[50:51], v88 offset:13920
  s_mov_b32 s29, 1769472
  s_add_u32 m0, s28, 110592
  s_nop 0
  buffer_load_dwordx4 v80, s[8:11], s29 offen lds
  v_mfma_f32_16x16x32_bf16 v[184:187], v[60:63], v[24:27], v[184:187]
  ds_read_b64_tr_b16 v[52:53], v88 offset:27744
  v_mfma_f32_16x16x32_bf16 v[188:191], v[60:63], v[28:31], v[188:191]
  ds_read_b64_tr_b16 v[54:55], v88 offset:32352
  s_waitcnt lgkmcnt(8)
  v_mfma_f32_16x16x32_bf16 v[120:123], v[64:67], v[24:27], v[120:123]
  ds_read_b64_tr_b16 v[56:57], v88 offset:9344
  v_mfma_f32_16x16x32_bf16 v[124:127], v[64:67], v[28:31], v[124:127]
  ds_read_b64_tr_b16 v[58:59], v88 offset:13952
  v_mfma_f32_16x16x32_bf16 v[192:195], v[68:71], v[24:27], v[192:195]
  ds_read_b64_tr_b16 v[60:61], v88 offset:27776
  v_mfma_f32_16x16x32_bf16 v[196:199], v[68:71], v[28:31], v[196:199]
  ds_read_b64_tr_b16 v[62:63], v88 offset:32384
  s_mov_b32 s29, 1769472
  s_add_u32 m0, s28, 111616
  s_nop 0
  buffer_load_dwordx4 v81, s[8:11], s29 offen lds
  s_waitcnt lgkmcnt(8)
  v_mfma_f32_16x16x32_bf16 v[128:131], v[72:75], v[24:27], v[128:131]
  ds_read_b64_tr_b16 v[64:65], v88 offset:9376
  v_mfma_f32_16x16x32_bf16 v[132:135], v[72:75], v[28:31], v[132:135]
  ds_read_b64_tr_b16 v[66:67], v88 offset:13984
  v_mfma_f32_16x16x32_bf16 v[200:203], v[76:79], v[24:27], v[200:203]
  ds_read_b64_tr_b16 v[68:69], v88 offset:27808
  v_mfma_f32_16x16x32_bf16 v[204:207], v[76:79], v[28:31], v[204:207]
  ds_read_b64_tr_b16 v[70:71], v88 offset:32416
  s_waitcnt lgkmcnt(8)
  v_mfma_f32_16x16x32_bf16 v[136:139], v[48:51], v[24:27], v[136:139]
  ds_read_b64_tr_b16 v[72:73], v88 offset:9408
  v_mfma_f32_16x16x32_bf16 v[140:143], v[48:51], v[28:31], v[140:143]
  ds_read_b64_tr_b16 v[74:75], v88 offset:14016
  s_mov_b32 s29, 1769472
  s_add_u32 m0, s28, 112640
  s_nop 0
  buffer_load_dwordx4 v82, s[8:11], s29 offen lds
  v_mfma_f32_16x16x32_bf16 v[208:211], v[52:55], v[24:27], v[208:211]
  ds_read_b64_tr_b16 v[76:77], v88 offset:27840
  v_mfma_f32_16x16x32_bf16 v[212:215], v[52:55], v[28:31], v[212:215]
  ds_read_b64_tr_b16 v[78:79], v88 offset:32448
  s_waitcnt lgkmcnt(8)
  v_mfma_f32_16x16x32_bf16 v[144:147], v[56:59], v[24:27], v[144:147]
  ds_read_b64_tr_b16 v[48:49], v88 offset:9440
  v_mfma_f32_16x16x32_bf16 v[148:151], v[56:59], v[28:31], v[148:151]
  ds_read_b64_tr_b16 v[50:51], v88 offset:14048
  v_mfma_f32_16x16x32_bf16 v[216:219], v[60:63], v[24:27], v[216:219]
  ds_read_b64_tr_b16 v[52:53], v88 offset:27872
  v_mfma_f32_16x16x32_bf16 v[220:223], v[60:63], v[28:31], v[220:223]
  ds_read_b64_tr_b16 v[54:55], v88 offset:32480
  s_mov_b32 s29, 1769472
  s_add_u32 m0, s28, 113664
  s_nop 0
  buffer_load_dwordx4 v83, s[8:11], s29 offen lds
  s_waitcnt lgkmcnt(8)
  v_mfma_f32_16x16x32_bf16 v[152:155], v[64:67], v[24:27], v[152:155]
  ds_read_b64_tr_b16 v[56:57], v88 offset:9472
  v_mfma_f32_16x16x32_bf16 v[156:159], v[64:67], v[28:31], v[156:159]
  ds_read_b64_tr_b16 v[58:59], v88 offset:14080
  v_mfma_f32_16x16x32_bf16 v[224:227], v[68:71], v[24:27], v[224:227]
  ds_read_b64_tr_b16 v[60:61], v88 offset:27904
  v_mfma_f32_16x16x32_bf16 v[228:231], v[68:71], v[28:31], v[228:231]
  ds_read_b64_tr_b16 v[62:63], v88 offset:32512
  s_waitcnt lgkmcnt(8)
  v_mfma_f32_16x16x32_bf16 v[160:163], v[72:75], v[24:27], v[160:163]
  ds_read_b64_tr_b16 v[64:65], v89 offset:0
  v_mfma_f32_16x16x32_bf16 v[164:167], v[72:75], v[28:31], v[164:167]
  ds_read_b64_tr_b16 v[66:67], v89 offset:4608
  s_mov_b32 s29, 1769472
  s_add_u32 m0, s28, 114688
  s_mov_b32 exec_hi, 0
  buffer_load_dwordx4 v84, s[8:11], s29 offen lds
  s_mov_b32 exec_hi, -1
  v_mfma_f32_16x16x32_bf16 v[232:235], v[76:79], v[24:27], v[232:235]
  ds_read_b64_tr_b16 v[68:69], v89 offset:18432
  v_mfma_f32_16x16x32_bf16 v[236:239], v[76:79], v[28:31], v[236:239]
  ds_read_b64_tr_b16 v[70:71], v89 offset:23040
  s_waitcnt lgkmcnt(8)
  v_mfma_f32_16x16x32_bf16 v[168:171], v[48:51], v[24:27], v[168:171]
  ds_read_b64_tr_b16 v[72:73], v89 offset:32
  v_mfma_f32_16x16x32_bf16 v[172:175], v[48:51], v[28:31], v[172:175]
  ds_read_b64_tr_b16 v[74:75], v89 offset:4640
  v_mfma_f32_16x16x32_bf16 v[240:243], v[52:55], v[24:27], v[240:243]
  ds_read_b64_tr_b16 v[76:77], v89 offset:18464
  v_mfma_f32_16x16x32_bf16 v[244:247], v[52:55], v[28:31], v[244:247]
  ds_read_b64_tr_b16 v[78:79], v89 offset:23072
  s_waitcnt lgkmcnt(8)
  v_mfma_f32_16x16x32_bf16 v[176:179], v[56:59], v[24:27], v[176:179]
  ds_read_b64_tr_b16 v[48:49], v89 offset:64
  v_mfma_f32_16x16x32_bf16 v[180:183], v[56:59], v[28:31], v[180:183]
  ds_read_b64_tr_b16 v[50:51], v89 offset:4672
  v_mfma_f32_16x16x32_bf16 v[248:251], v[60:63], v[24:27], v[248:251]
  ds_read_b64_tr_b16 v[52:53], v89 offset:18496
  v_mfma_f32_16x16x32_bf16 v[252:255], v[60:63], v[28:31], v[252:255]
  ds_read_b64_tr_b16 v[54:55], v89 offset:23104
  buffer_load_dwordx4 v[24:27], v85, s[12:15], s51 offen offset:1024 sc1
  buffer_load_dwordx4 v[28:31], v86, s[12:15], s51 offen offset:1024 sc1
  s_waitcnt vmcnt(12)
  s_waitcnt lgkmcnt(8)
  v_mfma_f32_16x16x32_bf16 v[112:115], v[64:67], v[32:35], v[112:115]
  ds_read_b64_tr_b16 v[56:57], v89 offset:96
  v_mfma_f32_16x16x32_bf16 v[116:119], v[64:67], v[36:39], v[116:119]
  ds_read_b64_tr_b16 v[58:59], v89 offset:4704
  v_mfma_f32_16x16x32_bf16 v[184:187], v[68:71], v[32:35], v[184:187]
  ds_read_b64_tr_b16 v[60:61], v89 offset:18528
  v_mfma_f32_16x16x32_bf16 v[188:191], v[68:71], v[36:39], v[188:191]
  ds_read_b64_tr_b16 v[62:63], v89 offset:23136
  s_waitcnt lgkmcnt(8)
  v_mfma_f32_16x16x32_bf16 v[120:123], v[72:75], v[32:35], v[120:123]
  ds_read_b64_tr_b16 v[64:65], v89 offset:128
  v_mfma_f32_16x16x32_bf16 v[124:127], v[72:75], v[36:39], v[124:127]
  ds_read_b64_tr_b16 v[66:67], v89 offset:4736
  v_mfma_f32_16x16x32_bf16 v[192:195], v[76:79], v[32:35], v[192:195]
  ds_read_b64_tr_b16 v[68:69], v89 offset:18560
  v_mfma_f32_16x16x32_bf16 v[196:199], v[76:79], v[36:39], v[196:199]
  ds_read_b64_tr_b16 v[70:71], v89 offset:23168
  s_waitcnt lgkmcnt(8)
  v_mfma_f32_16x16x32_bf16 v[128:131], v[48:51], v[32:35], v[128:131]
  ds_read_b64_tr_b16 v[72:73], v89 offset:160
  v_mfma_f32_16x16x32_bf16 v[132:135], v[48:51], v[36:39], v[132:135]
  ds_read_b64_tr_b16 v[74:75], v89 offset:4768
  v_mfma_f32_16x16x32_bf16 v[200:203], v[52:55], v[32:35], v[200:203]
  ds_read_b64_tr_b16 v[76:77], v89 offset:18592
  v_mfma_f32_16x16x32_bf16 v[204:207], v[52:55], v[36:39], v[204:207]
  ds_read_b64_tr_b16 v[78:79], v89 offset:23200
  s_waitcnt lgkmcnt(8)
  v_mfma_f32_16x16x32_bf16 v[136:139], v[56:59], v[32:35], v[136:139]
  ds_read_b64_tr_b16 v[48:49], v89 offset:192
  v_mfma_f32_16x16x32_bf16 v[140:143], v[56:59], v[36:39], v[140:143]
  ds_read_b64_tr_b16 v[50:51], v89 offset:4800
  v_mfma_f32_16x16x32_bf16 v[208:211], v[60:63], v[32:35], v[208:211]
  ds_read_b64_tr_b16 v[52:53], v89 offset:18624
  v_mfma_f32_16x16x32_bf16 v[212:215], v[60:63], v[36:39], v[212:215]
  ds_read_b64_tr_b16 v[54:55], v89 offset:23232
  s_waitcnt lgkmcnt(8)
  v_mfma_f32_16x16x32_bf16 v[144:147], v[64:67], v[32:35], v[144:147]
  ds_read_b64_tr_b16 v[56:57], v89 offset:224
  v_mfma_f32_16x16x32_bf16 v[148:151], v[64:67], v[36:39], v[148:151]
  ds_read_b64_tr_b16 v[58:59], v89 offset:4832
  v_mfma_f32_16x16x32_bf16 v[216:219], v[68:71], v[32:35], v[216:219]
  ds_read_b64_tr_b16 v[60:61], v89 offset:18656
  v_mfma_f32_16x16x32_bf16 v[220:223], v[68:71], v[36:39], v[220:223]
  ds_read_b64_tr_b16 v[62:63], v89 offset:23264
  s_waitcnt lgkmcnt(8)
  v_mfma_f32_16x16x32_bf16 v[152:155], v[72:75], v[32:35], v[152:155]
  ds_read_b64_tr_b16 v[64:65], v89 offset:256
  v_mfma_f32_16x16x32_bf16 v[156:159], v[72:75], v[36:39], v[156:159]
  ds_read_b64_tr_b16 v[66:67], v89 offset:4864
  v_mfma_f32_16x16x32_bf16 v[224:227], v[76:79], v[32:35], v[224:227]
  ds_read_b64_tr_b16 v[68:69], v89 offset:18688
  v_mfma_f32_16x16x32_bf16 v[228:231], v[76:79], v[36:39], v[228:231]
  ds_read_b64_tr_b16 v[70:71], v89 offset:23296
  s_waitcnt lgkmcnt(8)
  v_mfma_f32_16x16x32_bf16 v[160:163], v[48:51], v[32:35], v[160:163]
  ds_read_b64_tr_b16 v[72:73], v89 offset:9216
  v_mfma_f32_16x16x32_bf16 v[164:167], v[48:51], v[36:39], v[164:167]
  ds_read_b64_tr_b16 v[74:75], v89 offset:13824
  v_mfma_f32_16x16x32_bf16 v[232:235], v[52:55], v[32:35], v[232:235]
  ds_read_b64_tr_b16 v[76:77], v89 offset:27648
  v_mfma_f32_16x16x32_bf16 v[236:239], v[52:55], v[36:39], v[236:239]
  ds_read_b64_tr_b16 v[78:79], v89 offset:32256
  s_waitcnt lgkmcnt(8)
  v_mfma_f32_16x16x32_bf16 v[168:171], v[56:59], v[32:35], v[168:171]
  ds_read_b64_tr_b16 v[48:49], v89 offset:9248
  v_mfma_f32_16x16x32_bf16 v[172:175], v[56:59], v[36:39], v[172:175]
  ds_read_b64_tr_b16 v[50:51], v89 offset:13856
  v_mfma_f32_16x16x32_bf16 v[240:243], v[60:63], v[32:35], v[240:243]
  ds_read_b64_tr_b16 v[52:53], v89 offset:27680
  v_mfma_f32_16x16x32_bf16 v[244:247], v[60:63], v[36:39], v[244:247]
  ds_read_b64_tr_b16 v[54:55], v89 offset:32288
  s_waitcnt lgkmcnt(8)
  v_mfma_f32_16x16x32_bf16 v[176:179], v[64:67], v[32:35], v[176:179]
  ds_read_b64_tr_b16 v[56:57], v89 offset:9280
  v_mfma_f32_16x16x32_bf16 v[180:183], v[64:67], v[36:39], v[180:183]
  ds_read_b64_tr_b16 v[58:59], v89 offset:13888
  v_mfma_f32_16x16x32_bf16 v[248:251], v[68:71], v[32:35], v[248:251]
  ds_read_b64_tr_b16 v[60:61], v89 offset:27712
  v_mfma_f32_16x16x32_bf16 v[252:255], v[68:71], v[36:39], v[252:255]
  ds_read_b64_tr_b16 v[62:63], v89 offset:32320
  buffer_load_dwordx4 v[32:35], v85, s[12:15], s51 offen offset:2048 sc1
  buffer_load_dwordx4 v[36:39], v86, s[12:15], s51 offen offset:2048 sc1
  s_barrier
  s_waitcnt vmcnt(12)
  s_waitcnt lgkmcnt(8)
  v_mfma_f32_16x16x32_bf16 v[112:115], v[72:75], v[40:43], v[112:115]
  ds_read_b64_tr_b16 v[64:65], v89 offset:9312
  v_mfma_f32_16x16x32_bf16 v[116:119], v[72:75], v[44:47], v[116:119]
  ds_read_b64_tr_b16 v[66:67], v89 offset:13920
  s_mov_b32 s29, 2359296
  s_add_u32 m0, s28, 0
  s_nop 0
  buffer_load_dwordx4 v80, s[8:11], s29 offen lds
  v_mfma_f32_16x16x32_bf16 v[184:187], v[76:79], v[40:43], v[184:187]
  ds_read_b64_tr_b16 v[68:69], v89 offset:27744
  v_mfma_f32_16x16x32_bf16 v[188:191], v[76:79], v[44:47], v[188:191]
  ds_read_b64_tr_b16 v[70:71], v89 offset:32352
  s_waitcnt lgkmcnt(8)
  v_mfma_f32_16x16x32_bf16 v[120:123], v[48:51], v[40:43], v[120:123]
  ds_read_b64_tr_b16 v[72:73], v89 offset:9344
  v_mfma_f32_16x16x32_bf16 v[124:127], v[48:51], v[44:47], v[124:127]
  ds_read_b64_tr_b16 v[74:75], v89 offset:13952
  v_mfma_f32_16x16x32_bf16 v[192:195], v[52:55], v[40:43], v[192:195]
  ds_read_b64_tr_b16 v[76:77], v89 offset:27776
  v_mfma_f32_16x16x32_bf16 v[196:199], v[52:55], v[44:47], v[196:199]
  ds_read_b64_tr_b16 v[78:79], v89 offset:32384
  s_mov_b32 s29, 2359296
  s_add_u32 m0, s28, 1024
  s_nop 0
  buffer_load_dwordx4 v81, s[8:11], s29 offen lds
  s_waitcnt lgkmcnt(8)
  v_mfma_f32_16x16x32_bf16 v[128:131], v[56:59], v[40:43], v[128:131]
  ds_read_b64_tr_b16 v[48:49], v89 offset:9376
  v_mfma_f32_16x16x32_bf16 v[132:135], v[56:59], v[44:47], v[132:135]
  ds_read_b64_tr_b16 v[50:51], v89 offset:13984
  v_mfma_f32_16x16x32_bf16 v[200:203], v[60:63], v[40:43], v[200:203]
  ds_read_b64_tr_b16 v[52:53], v89 offset:27808
  v_mfma_f32_16x16x32_bf16 v[204:207], v[60:63], v[44:47], v[204:207]
  ds_read_b64_tr_b16 v[54:55], v89 offset:32416
  s_waitcnt lgkmcnt(8)
  v_mfma_f32_16x16x32_bf16 v[136:139], v[64:67], v[40:43], v[136:139]
  ds_read_b64_tr_b16 v[56:57], v89 offset:9408
  v_mfma_f32_16x16x32_bf16 v[140:143], v[64:67], v[44:47], v[140:143]
  ds_read_b64_tr_b16 v[58:59], v89 offset:14016
  s_mov_b32 s29, 2359296
  s_add_u32 m0, s28, 2048
  s_nop 0
  buffer_load_dwordx4 v82, s[8:11], s29 offen lds
  v_mfma_f32_16x16x32_bf16 v[208:211], v[68:71], v[40:43], v[208:211]
  ds_read_b64_tr_b16 v[60:61], v89 offset:27840
  v_mfma_f32_16x16x32_bf16 v[212:215], v[68:71], v[44:47], v[212:215]
  ds_read_b64_tr_b16 v[62:63], v89 offset:32448
  s_waitcnt lgkmcnt(8)
  v_mfma_f32_16x16x32_bf16 v[144:147], v[72:75], v[40:43], v[144:147]
  ds_read_b64_tr_b16 v[64:65], v89 offset:9440
  v_mfma_f32_16x16x32_bf16 v[148:151], v[72:75], v[44:47], v[148:151]
  ds_read_b64_tr_b16 v[66:67], v89 offset:14048
  v_mfma_f32_16x16x32_bf16 v[216:219], v[76:79], v[40:43], v[216:219]
  ds_read_b64_tr_b16 v[68:69], v89 offset:27872
  v_mfma_f32_16x16x32_bf16 v[220:223], v[76:79], v[44:47], v[220:223]
  ds_read_b64_tr_b16 v[70:71], v89 offset:32480
  s_mov_b32 s29, 2359296
  s_add_u32 m0, s28, 3072
  s_nop 0
  buffer_load_dwordx4 v83, s[8:11], s29 offen lds
  s_waitcnt lgkmcnt(8)
  v_mfma_f32_16x16x32_bf16 v[152:155], v[48:51], v[40:43], v[152:155]
  ds_read_b64_tr_b16 v[72:73], v89 offset:9472
  v_mfma_f32_16x16x32_bf16 v[156:159], v[48:51], v[44:47], v[156:159]
  ds_read_b64_tr_b16 v[74:75], v89 offset:14080
  v_mfma_f32_16x16x32_bf16 v[224:227], v[52:55], v[40:43], v[224:227]
  ds_read_b64_tr_b16 v[76:77], v89 offset:27904
  v_mfma_f32_16x16x32_bf16 v[228:231], v[52:55], v[44:47], v[228:231]
  ds_read_b64_tr_b16 v[78:79], v89 offset:32512
  s_waitcnt lgkmcnt(8)
  v_mfma_f32_16x16x32_bf16 v[160:163], v[56:59], v[40:43], v[160:163]
  ds_read_b64_tr_b16 v[48:49], v90 offset:0
  v_mfma_f32_16x16x32_bf16 v[164:167], v[56:59], v[44:47], v[164:167]
  ds_read_b64_tr_b16 v[50:51], v90 offset:4608
  s_mov_b32 s29, 2359296
  s_add_u32 m0, s28, 4096
  s_mov_b32 exec_hi, 0
  buffer_load_dwordx4 v84, s[8:11], s29 offen lds
  s_mov_b32 exec_hi, -1
  v_mfma_f32_16x16x32_bf16 v[232:235], v[60:63], v[40:43], v[232:235]
  ds_read_b64_tr_b16 v[52:53], v90 offset:18432
  v_mfma_f32_16x16x32_bf16 v[236:239], v[60:63], v[44:47], v[236:239]
  ds_read_b64_tr_b16 v[54:55], v90 offset:23040
  s_waitcnt lgkmcnt(8)
  v_mfma_f32_16x16x32_bf16 v[168:171], v[64:67], v[40:43], v[168:171]
  ds_read_b64_tr_b16 v[56:57], v90 offset:32
  v_mfma_f32_16x16x32_bf16 v[172:175], v[64:67], v[44:47], v[172:175]
  ds_read_b64_tr_b16 v[58:59], v90 offset:4640
  v_mfma_f32_16x16x32_bf16 v[240:243], v[68:71], v[40:43], v[240:243]
  ds_read_b64_tr_b16 v[60:61], v90 offset:18464
  v_mfma_f32_16x16x32_bf16 v[244:247], v[68:71], v[44:47], v[244:247]
  ds_read_b64_tr_b16 v[62:63], v90 offset:23072
  s_waitcnt lgkmcnt(8)
  v_mfma_f32_16x16x32_bf16 v[176:179], v[72:75], v[40:43], v[176:179]
  ds_read_b64_tr_b16 v[64:65], v90 offset:64
  v_mfma_f32_16x16x32_bf16 v[180:183], v[72:75], v[44:47], v[180:183]
  ds_read_b64_tr_b16 v[66:67], v90 offset:4672
  v_mfma_f32_16x16x32_bf16 v[248:251], v[76:79], v[40:43], v[248:251]
  ds_read_b64_tr_b16 v[68:69], v90 offset:18496
  v_mfma_f32_16x16x32_bf16 v[252:255], v[76:79], v[44:47], v[252:255]
  ds_read_b64_tr_b16 v[70:71], v90 offset:23104
  buffer_load_dwordx4 v[40:43], v85, s[12:15], s51 offen offset:3072 sc1
  buffer_load_dwordx4 v[44:47], v86, s[12:15], s51 offen offset:3072 sc1
  s_waitcnt vmcnt(17)
  s_waitcnt lgkmcnt(8)
  v_mfma_f32_16x16x32_bf16 v[112:115], v[48:51], v[16:19], v[112:115]
  ds_read_b64_tr_b16 v[72:73], v90 offset:96
  v_mfma_f32_16x16x32_bf16 v[116:119], v[48:51], v[20:23], v[116:119]
  ds_read_b64_tr_b16 v[74:75], v90 offset:4704
  v_mfma_f32_16x16x32_bf16 v[184:187], v[52:55], v[16:19], v[184:187]
  ds_read_b64_tr_b16 v[76:77], v90 offset:18528
  v_mfma_f32_16x16x32_bf16 v[188:191], v[52:55], v[20:23], v[188:191]
  ds_read_b64_tr_b16 v[78:79], v90 offset:23136
  s_waitcnt lgkmcnt(8)
  v_mfma_f32_16x16x32_bf16 v[120:123], v[56:59], v[16:19], v[120:123]
  ds_read_b64_tr_b16 v[48:49], v90 offset:128
  v_mfma_f32_16x16x32_bf16 v[124:127], v[56:59], v[20:23], v[124:127]
  ds_read_b64_tr_b16 v[50:51], v90 offset:4736
  v_mfma_f32_16x16x32_bf16 v[192:195], v[60:63], v[16:19], v[192:195]
  ds_read_b64_tr_b16 v[52:53], v90 offset:18560
  v_mfma_f32_16x16x32_bf16 v[196:199], v[60:63], v[20:23], v[196:199]
  ds_read_b64_tr_b16 v[54:55], v90 offset:23168
  s_waitcnt lgkmcnt(8)
  v_mfma_f32_16x16x32_bf16 v[128:131], v[64:67], v[16:19], v[128:131]
  ds_read_b64_tr_b16 v[56:57], v90 offset:160
  v_mfma_f32_16x16x32_bf16 v[132:135], v[64:67], v[20:23], v[132:135]
  ds_read_b64_tr_b16 v[58:59], v90 offset:4768
  v_mfma_f32_16x16x32_bf16 v[200:203], v[68:71], v[16:19], v[200:203]
  ds_read_b64_tr_b16 v[60:61], v90 offset:18592
  v_mfma_f32_16x16x32_bf16 v[204:207], v[68:71], v[20:23], v[204:207]
  ds_read_b64_tr_b16 v[62:63], v90 offset:23200
  s_waitcnt lgkmcnt(8)
  v_mfma_f32_16x16x32_bf16 v[136:139], v[72:75], v[16:19], v[136:139]
  ds_read_b64_tr_b16 v[64:65], v90 offset:192
  v_mfma_f32_16x16x32_bf16 v[140:143], v[72:75], v[20:23], v[140:143]
  ds_read_b64_tr_b16 v[66:67], v90 offset:4800
  v_mfma_f32_16x16x32_bf16 v[208:211], v[76:79], v[16:19], v[208:211]
  ds_read_b64_tr_b16 v[68:69], v90 offset:18624
  v_mfma_f32_16x16x32_bf16 v[212:215], v[76:79], v[20:23], v[212:215]
  ds_read_b64_tr_b16 v[70:71], v90 offset:23232
  s_waitcnt lgkmcnt(8)
  v_mfma_f32_16x16x32_bf16 v[144:147], v[48:51], v[16:19], v[144:147]
  ds_read_b64_tr_b16 v[72:73], v90 offset:224
  v_mfma_f32_16x16x32_bf16 v[148:151], v[48:51], v[20:23], v[148:151]
  ds_read_b64_tr_b16 v[74:75], v90 offset:4832
  v_mfma_f32_16x16x32_bf16 v[216:219], v[52:55], v[16:19], v[216:219]
  ds_read_b64_tr_b16 v[76:77], v90 offset:18656
  v_mfma_f32_16x16x32_bf16 v[220:223], v[52:55], v[20:23], v[220:223]
  ds_read_b64_tr_b16 v[78:79], v90 offset:23264
  s_waitcnt lgkmcnt(8)
  v_mfma_f32_16x16x32_bf16 v[152:155], v[56:59], v[16:19], v[152:155]
  ds_read_b64_tr_b16 v[48:49], v90 offset:256
  v_mfma_f32_16x16x32_bf16 v[156:159], v[56:59], v[20:23], v[156:159]
  ds_read_b64_tr_b16 v[50:51], v90 offset:4864
  v_mfma_f32_16x16x32_bf16 v[224:227], v[60:63], v[16:19], v[224:227]
  ds_read_b64_tr_b16 v[52:53], v90 offset:18688
  v_mfma_f32_16x16x32_bf16 v[228:231], v[60:63], v[20:23], v[228:231]
  ds_read_b64_tr_b16 v[54:55], v90 offset:23296
  s_waitcnt lgkmcnt(8)
  v_mfma_f32_16x16x32_bf16 v[160:163], v[64:67], v[16:19], v[160:163]
  ds_read_b64_tr_b16 v[56:57], v90 offset:9216
  v_mfma_f32_16x16x32_bf16 v[164:167], v[64:67], v[20:23], v[164:167]
  ds_read_b64_tr_b16 v[58:59], v90 offset:13824
  v_mfma_f32_16x16x32_bf16 v[232:235], v[68:71], v[16:19], v[232:235]
  ds_read_b64_tr_b16 v[60:61], v90 offset:27648
  v_mfma_f32_16x16x32_bf16 v[236:239], v[68:71], v[20:23], v[236:239]
  ds_read_b64_tr_b16 v[62:63], v90 offset:32256
  s_waitcnt lgkmcnt(8)
  v_mfma_f32_16x16x32_bf16 v[168:171], v[72:75], v[16:19], v[168:171]
  ds_read_b64_tr_b16 v[64:65], v90 offset:9248
  v_mfma_f32_16x16x32_bf16 v[172:175], v[72:75], v[20:23], v[172:175]
  ds_read_b64_tr_b16 v[66:67], v90 offset:13856
  v_mfma_f32_16x16x32_bf16 v[240:243], v[76:79], v[16:19], v[240:243]
  ds_read_b64_tr_b16 v[68:69], v90 offset:27680
  v_mfma_f32_16x16x32_bf16 v[244:247], v[76:79], v[20:23], v[244:247]
  ds_read_b64_tr_b16 v[70:71], v90 offset:32288
  s_waitcnt lgkmcnt(8)
  v_mfma_f32_16x16x32_bf16 v[176:179], v[48:51], v[16:19], v[176:179]
  ds_read_b64_tr_b16 v[72:73], v90 offset:9280
  v_mfma_f32_16x16x32_bf16 v[180:183], v[48:51], v[20:23], v[180:183]
  ds_read_b64_tr_b16 v[74:75], v90 offset:13888
  v_mfma_f32_16x16x32_bf16 v[248:251], v[52:55], v[16:19], v[248:251]
  ds_read_b64_tr_b16 v[76:77], v90 offset:27712
  v_mfma_f32_16x16x32_bf16 v[252:255], v[52:55], v[20:23], v[252:255]
  ds_read_b64_tr_b16 v[78:79], v90 offset:32320
  buffer_load_dwordx4 v[16:19], v85, s[12:15], s52 offen offset:0 sc1
  buffer_load_dwordx4 v[20:23], v86, s[12:15], s52 offen offset:0 sc1
  s_waitcnt vmcnt(13)
  s_barrier
  s_waitcnt vmcnt(11)
  s_waitcnt lgkmcnt(8)
  v_mfma_f32_16x16x32_bf16 v[112:115], v[56:59], v[24:27], v[112:115]
  ds_read_b64_tr_b16 v[48:49], v90 offset:9312
  v_mfma_f32_16x16x32_bf16 v[116:119], v[56:59], v[28:31], v[116:119]
  ds_read_b64_tr_b16 v[50:51], v90 offset:13920
  s_mov_b32 s29, 2949120
  s_add_u32 m0, s28, 36864
  s_nop 0
  buffer_load_dwordx4 v80, s[8:11], s29 offen lds
  v_mfma_f32_16x16x32_bf16 v[184:187], v[60:63], v[24:27], v[184:187]
  ds_read_b64_tr_b16 v[52:53], v90 offset:27744
  v_mfma_f32_16x16x32_bf16 v[188:191], v[60:63], v[28:31], v[188:191]
  ds_read_b64_tr_b16 v[54:55], v90 offset:32352
  s_waitcnt lgkmcnt(8)
  v_mfma_f32_16x16x32_bf16 v[120:123], v[64:67], v[24:27], v[120:123]
  ds_read_b64_tr_b16 v[56:57], v90 offset:9344
  v_mfma_f32_16x16x32_bf16 v[124:127], v[64:67], v[28:31], v[124:127]
  ds_read_b64_tr_b16 v[58:59], v90 offset:13952
  v_mfma_f32_16x16x32_bf16 v[192:195], v[68:71], v[24:27], v[192:195]
  ds_read_b64_tr_b16 v[60:61], v90 offset:27776
  v_mfma_f32_16x16x32_bf16 v[196:199], v[68:71], v[28:31], v[196:199]
  ds_read_b64_tr_b16 v[62:63], v90 offset:32384
  s_mov_b32 s29, 2949120
  s_add_u32 m0, s28, 37888
  s_nop 0
  buffer_load_dwordx4 v81, s[8:11], s29 offen lds
  s_waitcnt lgkmcnt(8)
  v_mfma_f32_16x16x32_bf16 v[128:131], v[72:75], v[24:27], v[128:131]
  ds_read_b64_tr_b16 v[64:65], v90 offset:9376
  v_mfma_f32_16x16x32_bf16 v[132:135], v[72:75], v[28:31], v[132:135]
  ds_read_b64_tr_b16 v[66:67], v90 offset:13984
  v_mfma_f32_16x16x32_bf16 v[200:203], v[76:79], v[24:27], v[200:203]
  ds_read_b64_tr_b16 v[68:69], v90 offset:27808
  v_mfma_f32_16x16x32_bf16 v[204:207], v[76:79], v[28:31], v[204:207]
  ds_read_b64_tr_b16 v[70:71], v90 offset:32416
  s_waitcnt lgkmcnt(8)
  v_mfma_f32_16x16x32_bf16 v[136:139], v[48:51], v[24:27], v[136:139]
  ds_read_b64_tr_b16 v[72:73], v90 offset:9408
  v_mfma_f32_16x16x32_bf16 v[140:143], v[48:51], v[28:31], v[140:143]
  ds_read_b64_tr_b16 v[74:75], v90 offset:14016
  s_mov_b32 s29, 2949120
  s_add_u32 m0, s28, 38912
  s_nop 0
  buffer_load_dwordx4 v82, s[8:11], s29 offen lds
  v_mfma_f32_16x16x32_bf16 v[208:211], v[52:55], v[24:27], v[208:211]
  ds_read_b64_tr_b16 v[76:77], v90 offset:27840
  v_mfma_f32_16x16x32_bf16 v[212:215], v[52:55], v[28:31], v[212:215]
  ds_read_b64_tr_b16 v[78:79], v90 offset:32448
  s_waitcnt lgkmcnt(8)
  v_mfma_f32_16x16x32_bf16 v[144:147], v[56:59], v[24:27], v[144:147]
  ds_read_b64_tr_b16 v[48:49], v90 offset:9440
  v_mfma_f32_16x16x32_bf16 v[148:151], v[56:59], v[28:31], v[148:151]
  ds_read_b64_tr_b16 v[50:51], v90 offset:14048
  v_mfma_f32_16x16x32_bf16 v[216:219], v[60:63], v[24:27], v[216:219]
  ds_read_b64_tr_b16 v[52:53], v90 offset:27872
  v_mfma_f32_16x16x32_bf16 v[220:223], v[60:63], v[28:31], v[220:223]
  ds_read_b64_tr_b16 v[54:55], v90 offset:32480
  s_mov_b32 s29, 2949120
  s_add_u32 m0, s28, 39936
  s_nop 0
  buffer_load_dwordx4 v83, s[8:11], s29 offen lds
  s_waitcnt lgkmcnt(8)
  v_mfma_f32_16x16x32_bf16 v[152:155], v[64:67], v[24:27], v[152:155]
  ds_read_b64_tr_b16 v[56:57], v90 offset:9472
  v_mfma_f32_16x16x32_bf16 v[156:159], v[64:67], v[28:31], v[156:159]
  ds_read_b64_tr_b16 v[58:59], v90 offset:14080
  v_mfma_f32_16x16x32_bf16 v[224:227], v[68:71], v[24:27], v[224:227]
  ds_read_b64_tr_b16 v[60:61], v90 offset:27904
  v_mfma_f32_16x16x32_bf16 v[228:231], v[68:71], v[28:31], v[228:231]
  ds_read_b64_tr_b16 v[62:63], v90 offset:32512
  s_waitcnt lgkmcnt(8)
  v_mfma_f32_16x16x32_bf16 v[160:163], v[72:75], v[24:27], v[160:163]
  ds_read_b64_tr_b16 v[64:65], v91 offset:0
  v_mfma_f32_16x16x32_bf16 v[164:167], v[72:75], v[28:31], v[164:167]
  ds_read_b64_tr_b16 v[66:67], v91 offset:4608
  s_mov_b32 s29, 2949120
  s_add_u32 m0, s28, 40960
  s_mov_b32 exec_hi, 0
  buffer_load_dwordx4 v84, s[8:11], s29 offen lds
  s_mov_b32 exec_hi, -1
  v_mfma_f32_16x16x32_bf16 v[232:235], v[76:79], v[24:27], v[232:235]
  ds_read_b64_tr_b16 v[68:69], v91 offset:18432
  v_mfma_f32_16x16x32_bf16 v[236:239], v[76:79], v[28:31], v[236:239]
  ds_read_b64_tr_b16 v[70:71], v91 offset:23040
  s_waitcnt lgkmcnt(8)
  v_mfma_f32_16x16x32_bf16 v[168:171], v[48:51], v[24:27], v[168:171]
  ds_read_b64_tr_b16 v[72:73], v91 offset:32
  v_mfma_f32_16x16x32_bf16 v[172:175], v[48:51], v[28:31], v[172:175]
  ds_read_b64_tr_b16 v[74:75], v91 offset:4640
  v_mfma_f32_16x16x32_bf16 v[240:243], v[52:55], v[24:27], v[240:243]
  ds_read_b64_tr_b16 v[76:77], v91 offset:18464
  v_mfma_f32_16x16x32_bf16 v[244:247], v[52:55], v[28:31], v[244:247]
  ds_read_b64_tr_b16 v[78:79], v91 offset:23072
  s_waitcnt lgkmcnt(8)
  v_mfma_f32_16x16x32_bf16 v[176:179], v[56:59], v[24:27], v[176:179]
  ds_read_b64_tr_b16 v[48:49], v91 offset:64
  v_mfma_f32_16x16x32_bf16 v[180:183], v[56:59], v[28:31], v[180:183]
  ds_read_b64_tr_b16 v[50:51], v91 offset:4672
  v_mfma_f32_16x16x32_bf16 v[248:251], v[60:63], v[24:27], v[248:251]
  ds_read_b64_tr_b16 v[52:53], v91 offset:18496
  v_mfma_f32_16x16x32_bf16 v[252:255], v[60:63], v[28:31], v[252:255]
  ds_read_b64_tr_b16 v[54:55], v91 offset:23104
  buffer_load_dwordx4 v[24:27], v85, s[12:15], s52 offen offset:1024 sc1
  buffer_load_dwordx4 v[28:31], v86, s[12:15], s52 offen offset:1024 sc1
  s_waitcnt vmcnt(16)
  s_waitcnt lgkmcnt(8)
  v_mfma_f32_16x16x32_bf16 v[112:115], v[64:67], v[32:35], v[112:115]
  ds_read_b64_tr_b16 v[56:57], v91 offset:96
  v_mfma_f32_16x16x32_bf16 v[116:119], v[64:67], v[36:39], v[116:119]
  ds_read_b64_tr_b16 v[58:59], v91 offset:4704
  v_mfma_f32_16x16x32_bf16 v[184:187], v[68:71], v[32:35], v[184:187]
  ds_read_b64_tr_b16 v[60:61], v91 offset:18528
  v_mfma_f32_16x16x32_bf16 v[188:191], v[68:71], v[36:39], v[188:191]
  ds_read_b64_tr_b16 v[62:63], v91 offset:23136
  s_waitcnt lgkmcnt(8)
  v_mfma_f32_16x16x32_bf16 v[120:123], v[72:75], v[32:35], v[120:123]
  ds_read_b64_tr_b16 v[64:65], v91 offset:128
  v_mfma_f32_16x16x32_bf16 v[124:127], v[72:75], v[36:39], v[124:127]
  ds_read_b64_tr_b16 v[66:67], v91 offset:4736
  v_mfma_f32_16x16x32_bf16 v[192:195], v[76:79], v[32:35], v[192:195]
  ds_read_b64_tr_b16 v[68:69], v91 offset:18560
  v_mfma_f32_16x16x32_bf16 v[196:199], v[76:79], v[36:39], v[196:199]
  ds_read_b64_tr_b16 v[70:71], v91 offset:23168
  s_waitcnt lgkmcnt(8)
  v_mfma_f32_16x16x32_bf16 v[128:131], v[48:51], v[32:35], v[128:131]
  ds_read_b64_tr_b16 v[72:73], v91 offset:160
  v_mfma_f32_16x16x32_bf16 v[132:135], v[48:51], v[36:39], v[132:135]
  ds_read_b64_tr_b16 v[74:75], v91 offset:4768
  v_mfma_f32_16x16x32_bf16 v[200:203], v[52:55], v[32:35], v[200:203]
  ds_read_b64_tr_b16 v[76:77], v91 offset:18592
  v_mfma_f32_16x16x32_bf16 v[204:207], v[52:55], v[36:39], v[204:207]
  ds_read_b64_tr_b16 v[78:79], v91 offset:23200
  s_waitcnt lgkmcnt(8)
  v_mfma_f32_16x16x32_bf16 v[136:139], v[56:59], v[32:35], v[136:139]
  ds_read_b64_tr_b16 v[48:49], v91 offset:192
  v_mfma_f32_16x16x32_bf16 v[140:143], v[56:59], v[36:39], v[140:143]
  ds_read_b64_tr_b16 v[50:51], v91 offset:4800
  v_mfma_f32_16x16x32_bf16 v[208:211], v[60:63], v[32:35], v[208:211]
  ds_read_b64_tr_b16 v[52:53], v91 offset:18624
  v_mfma_f32_16x16x32_bf16 v[212:215], v[60:63], v[36:39], v[212:215]
  ds_read_b64_tr_b16 v[54:55], v91 offset:23232
  s_waitcnt lgkmcnt(8)
  v_mfma_f32_16x16x32_bf16 v[144:147], v[64:67], v[32:35], v[144:147]
  ds_read_b64_tr_b16 v[56:57], v91 offset:224
  v_mfma_f32_16x16x32_bf16 v[148:151], v[64:67], v[36:39], v[148:151]
  ds_read_b64_tr_b16 v[58:59], v91 offset:4832
  v_mfma_f32_16x16x32_bf16 v[216:219], v[68:71], v[32:35], v[216:219]
  ds_read_b64_tr_b16 v[60:61], v91 offset:18656
  v_mfma_f32_16x16x32_bf16 v[220:223], v[68:71], v[36:39], v[220:223]
  ds_read_b64_tr_b16 v[62:63], v91 offset:23264
  s_waitcnt lgkmcnt(8)
  v_mfma_f32_16x16x32_bf16 v[152:155], v[72:75], v[32:35], v[152:155]
  ds_read_b64_tr_b16 v[64:65], v91 offset:256
  v_mfma_f32_16x16x32_bf16 v[156:159], v[72:75], v[36:39], v[156:159]
  ds_read_b64_tr_b16 v[66:67], v91 offset:4864
  v_mfma_f32_16x16x32_bf16 v[224:227], v[76:79], v[32:35], v[224:227]
  ds_read_b64_tr_b16 v[68:69], v91 offset:18688
  v_mfma_f32_16x16x32_bf16 v[228:231], v[76:79], v[36:39], v[228:231]
  ds_read_b64_tr_b16 v[70:71], v91 offset:23296
  s_waitcnt lgkmcnt(8)
  v_mfma_f32_16x16x32_bf16 v[160:163], v[48:51], v[32:35], v[160:163]
  ds_read_b64_tr_b16 v[72:73], v91 offset:9216
  v_mfma_f32_16x16x32_bf16 v[164:167], v[48:51], v[36:39], v[164:167]
  ds_read_b64_tr_b16 v[74:75], v91 offset:13824
  v_mfma_f32_16x16x32_bf16 v[232:235], v[52:55], v[32:35], v[232:235]
  ds_read_b64_tr_b16 v[76:77], v91 offset:27648
  v_mfma_f32_16x16x32_bf16 v[236:239], v[52:55], v[36:39], v[236:239]
  ds_read_b64_tr_b16 v[78:79], v91 offset:32256
  s_waitcnt lgkmcnt(8)
  v_mfma_f32_16x16x32_bf16 v[168:171], v[56:59], v[32:35], v[168:171]
  ds_read_b64_tr_b16 v[48:49], v91 offset:9248
  v_mfma_f32_16x16x32_bf16 v[172:175], v[56:59], v[36:39], v[172:175]
  ds_read_b64_tr_b16 v[50:51], v91 offset:13856
  v_mfma_f32_16x16x32_bf16 v[240:243], v[60:63], v[32:35], v[240:243]
  ds_read_b64_tr_b16 v[52:53], v91 offset:27680
  v_mfma_f32_16x16x32_bf16 v[244:247], v[60:63], v[36:39], v[244:247]
  ds_read_b64_tr_b16 v[54:55], v91 offset:32288
  s_waitcnt lgkmcnt(8)
  v_mfma_f32_16x16x32_bf16 v[176:179], v[64:67], v[32:35], v[176:179]
  ds_read_b64_tr_b16 v[56:57], v91 offset:9280
  v_mfma_f32_16x16x32_bf16 v[180:183], v[64:67], v[36:39], v[180:183]
  ds_read_b64_tr_b16 v[58:59], v91 offset:13888
  v_mfma_f32_16x16x32_bf16 v[248:251], v[68:71], v[32:35], v[248:251]
  ds_read_b64_tr_b16 v[60:61], v91 offset:27712
  v_mfma_f32_16x16x32_bf16 v[252:255], v[68:71], v[36:39], v[252:255]
  ds_read_b64_tr_b16 v[62:63], v91 offset:32320
  buffer_load_dwordx4 v[32:35], v85, s[12:15], s52 offen offset:2048 sc1
  buffer_load_dwordx4 v[36:39], v86, s[12:15], s52 offen offset:2048 sc1
  s_waitcnt vmcnt(13)
  s_barrier
  s_waitcnt vmcnt(11)
  s_waitcnt lgkmcnt(8)
  v_mfma_f32_16x16x32_bf16 v[112:115], v[72:75], v[40:43], v[112:115]
  ds_read_b64_tr_b16 v[64:65], v91 offset:9312
  v_mfma_f32_16x16x32_bf16 v[116:119], v[72:75], v[44:47], v[116:119]
  ds_read_b64_tr_b16 v[66:67], v91 offset:13920
  s_mov_b32 s29, 3538944
  s_add_u32 m0, s28, 73728
  s_nop 0
  buffer_load_dwordx4 v80, s[8:11], s29 offen lds
  v_mfma_f32_16x16x32_bf16 v[184:187], v[76:79], v[40:43], v[184:187]
  ds_read_b64_tr_b16 v[68:69], v91 offset:27744
  v_mfma_f32_16x16x32_bf16 v[188:191], v[76:79], v[44:47], v[188:191]
  ds_read_b64_tr_b16 v[70:71], v91 offset:32352
  s_waitcnt lgkmcnt(8)
  v_mfma_f32_16x16x32_bf16 v[120:123], v[48:51], v[40:43], v[120:123]
  ds_read_b64_tr_b16 v[72:73], v91 offset:9344
  v_mfma_f32_16x16x32_bf16 v[124:127], v[48:51], v[44:47], v[124:127]
  ds_read_b64_tr_b16 v[74:75], v91 offset:13952
  v_mfma_f32_16x16x32_bf16 v[192:195], v[52:55], v[40:43], v[192:195]
  ds_read_b64_tr_b16 v[76:77], v91 offset:27776
  v_mfma_f32_16x16x32_bf16 v[196:199], v[52:55], v[44:47], v[196:199]
  ds_read_b64_tr_b16 v[78:79], v91 offset:32384
  s_mov_b32 s29, 3538944
  s_add_u32 m0, s28, 74752
  s_nop 0
  buffer_load_dwordx4 v81, s[8:11], s29 offen lds
  s_waitcnt lgkmcnt(8)
  v_mfma_f32_16x16x32_bf16 v[128:131], v[56:59], v[40:43], v[128:131]
  ds_read_b64_tr_b16 v[48:49], v91 offset:9376
  v_mfma_f32_16x16x32_bf16 v[132:135], v[56:59], v[44:47], v[132:135]
  ds_read_b64_tr_b16 v[50:51], v91 offset:13984
  v_mfma_f32_16x16x32_bf16 v[200:203], v[60:63], v[40:43], v[200:203]
  ds_read_b64_tr_b16 v[52:53], v91 offset:27808
  v_mfma_f32_16x16x32_bf16 v[204:207], v[60:63], v[44:47], v[204:207]
  ds_read_b64_tr_b16 v[54:55], v91 offset:32416
  s_waitcnt lgkmcnt(8)
  v_mfma_f32_16x16x32_bf16 v[136:139], v[64:67], v[40:43], v[136:139]
  ds_read_b64_tr_b16 v[56:57], v91 offset:9408
  v_mfma_f32_16x16x32_bf16 v[140:143], v[64:67], v[44:47], v[140:143]
  ds_read_b64_tr_b16 v[58:59], v91 offset:14016
  s_mov_b32 s29, 3538944
  s_add_u32 m0, s28, 75776
  s_nop 0
  buffer_load_dwordx4 v82, s[8:11], s29 offen lds
  v_mfma_f32_16x16x32_bf16 v[208:211], v[68:71], v[40:43], v[208:211]
  ds_read_b64_tr_b16 v[60:61], v91 offset:27840
  v_mfma_f32_16x16x32_bf16 v[212:215], v[68:71], v[44:47], v[212:215]
  ds_read_b64_tr_b16 v[62:63], v91 offset:32448
  s_waitcnt lgkmcnt(8)
  v_mfma_f32_16x16x32_bf16 v[144:147], v[72:75], v[40:43], v[144:147]
  ds_read_b64_tr_b16 v[64:65], v91 offset:9440
  v_mfma_f32_16x16x32_bf16 v[148:151], v[72:75], v[44:47], v[148:151]
  ds_read_b64_tr_b16 v[66:67], v91 offset:14048
  v_mfma_f32_16x16x32_bf16 v[216:219], v[76:79], v[40:43], v[216:219]
  ds_read_b64_tr_b16 v[68:69], v91 offset:27872
  v_mfma_f32_16x16x32_bf16 v[220:223], v[76:79], v[44:47], v[220:223]
  ds_read_b64_tr_b16 v[70:71], v91 offset:32480
  s_mov_b32 s29, 3538944
  s_add_u32 m0, s28, 76800
  s_nop 0
  buffer_load_dwordx4 v83, s[8:11], s29 offen lds
  s_waitcnt lgkmcnt(8)
  v_mfma_f32_16x16x32_bf16 v[152:155], v[48:51], v[40:43], v[152:155]
  ds_read_b64_tr_b16 v[72:73], v91 offset:9472
  v_mfma_f32_16x16x32_bf16 v[156:159], v[48:51], v[44:47], v[156:159]
  ds_read_b64_tr_b16 v[74:75], v91 offset:14080
  v_mfma_f32_16x16x32_bf16 v[224:227], v[52:55], v[40:43], v[224:227]
  ds_read_b64_tr_b16 v[76:77], v91 offset:27904
  v_mfma_f32_16x16x32_bf16 v[228:231], v[52:55], v[44:47], v[228:231]
  ds_read_b64_tr_b16 v[78:79], v91 offset:32512
  s_waitcnt lgkmcnt(8)
  v_mfma_f32_16x16x32_bf16 v[160:163], v[56:59], v[40:43], v[160:163]
  ds_read_b64_tr_b16 v[48:49], v88 offset:0
  v_mfma_f32_16x16x32_bf16 v[164:167], v[56:59], v[44:47], v[164:167]
  ds_read_b64_tr_b16 v[50:51], v88 offset:4608
  s_mov_b32 s29, 3538944
  s_add_u32 m0, s28, 77824
  s_mov_b32 exec_hi, 0
  buffer_load_dwordx4 v84, s[8:11], s29 offen lds
  s_mov_b32 exec_hi, -1
  v_mfma_f32_16x16x32_bf16 v[232:235], v[60:63], v[40:43], v[232:235]
  ds_read_b64_tr_b16 v[52:53], v88 offset:18432
  v_mfma_f32_16x16x32_bf16 v[236:239], v[60:63], v[44:47], v[236:239]
  ds_read_b64_tr_b16 v[54:55], v88 offset:23040
  s_waitcnt lgkmcnt(8)
  v_mfma_f32_16x16x32_bf16 v[168:171], v[64:67], v[40:43], v[168:171]
  ds_read_b64_tr_b16 v[56:57], v88 offset:32
  v_mfma_f32_16x16x32_bf16 v[172:175], v[64:67], v[44:47], v[172:175]
  ds_read_b64_tr_b16 v[58:59], v88 offset:4640
  v_mfma_f32_16x16x32_bf16 v[240:243], v[68:71], v[40:43], v[240:243]
  ds_read_b64_tr_b16 v[60:61], v88 offset:18464
  v_mfma_f32_16x16x32_bf16 v[244:247], v[68:71], v[44:47], v[244:247]
  ds_read_b64_tr_b16 v[62:63], v88 offset:23072
  s_waitcnt lgkmcnt(8)
  v_mfma_f32_16x16x32_bf16 v[176:179], v[72:75], v[40:43], v[176:179]
  ds_read_b64_tr_b16 v[64:65], v88 offset:64
  v_mfma_f32_16x16x32_bf16 v[180:183], v[72:75], v[44:47], v[180:183]
  ds_read_b64_tr_b16 v[66:67], v88 offset:4672
  v_mfma_f32_16x16x32_bf16 v[248:251], v[76:79], v[40:43], v[248:251]
  ds_read_b64_tr_b16 v[68:69], v88 offset:18496
  v_mfma_f32_16x16x32_bf16 v[252:255], v[76:79], v[44:47], v[252:255]
  ds_read_b64_tr_b16 v[70:71], v88 offset:23104
  buffer_load_dwordx4 v[40:43], v85, s[12:15], s52 offen offset:3072 sc1
  buffer_load_dwordx4 v[44:47], v86, s[12:15], s52 offen offset:3072 sc1
  s_waitcnt vmcnt(16)
  s_waitcnt lgkmcnt(8)
  v_mfma_f32_16x16x32_bf16 v[112:115], v[48:51], v[16:19], v[112:115]
  ds_read_b64_tr_b16 v[72:73], v88 offset:96
  v_mfma_f32_16x16x32_bf16 v[116:119], v[48:51], v[20:23], v[116:119]
  ds_read_b64_tr_b16 v[74:75], v88 offset:4704
  v_mfma_f32_16x16x32_bf16 v[184:187], v[52:55], v[16:19], v[184:187]
  ds_read_b64_tr_b16 v[76:77], v88 offset:18528
  v_mfma_f32_16x16x32_bf16 v[188:191], v[52:55], v[20:23], v[188:191]
  ds_read_b64_tr_b16 v[78:79], v88 offset:23136
  s_waitcnt lgkmcnt(8)
  v_mfma_f32_16x16x32_bf16 v[120:123], v[56:59], v[16:19], v[120:123]
  ds_read_b64_tr_b16 v[48:49], v88 offset:128
  v_mfma_f32_16x16x32_bf16 v[124:127], v[56:59], v[20:23], v[124:127]
  ds_read_b64_tr_b16 v[50:51], v88 offset:4736
  v_mfma_f32_16x16x32_bf16 v[192:195], v[60:63], v[16:19], v[192:195]
  ds_read_b64_tr_b16 v[52:53], v88 offset:18560
  v_mfma_f32_16x16x32_bf16 v[196:199], v[60:63], v[20:23], v[196:199]
  ds_read_b64_tr_b16 v[54:55], v88 offset:23168
  s_waitcnt lgkmcnt(8)
  v_mfma_f32_16x16x32_bf16 v[128:131], v[64:67], v[16:19], v[128:131]
  ds_read_b64_tr_b16 v[56:57], v88 offset:160
  v_mfma_f32_16x16x32_bf16 v[132:135], v[64:67], v[20:23], v[132:135]
  ds_read_b64_tr_b16 v[58:59], v88 offset:4768
  v_mfma_f32_16x16x32_bf16 v[200:203], v[68:71], v[16:19], v[200:203]
  ds_read_b64_tr_b16 v[60:61], v88 offset:18592
  v_mfma_f32_16x16x32_bf16 v[204:207], v[68:71], v[20:23], v[204:207]
  ds_read_b64_tr_b16 v[62:63], v88 offset:23200
  s_waitcnt lgkmcnt(8)
  v_mfma_f32_16x16x32_bf16 v[136:139], v[72:75], v[16:19], v[136:139]
  ds_read_b64_tr_b16 v[64:65], v88 offset:192
  v_mfma_f32_16x16x32_bf16 v[140:143], v[72:75], v[20:23], v[140:143]
  ds_read_b64_tr_b16 v[66:67], v88 offset:4800
  v_mfma_f32_16x16x32_bf16 v[208:211], v[76:79], v[16:19], v[208:211]
  ds_read_b64_tr_b16 v[68:69], v88 offset:18624
  v_mfma_f32_16x16x32_bf16 v[212:215], v[76:79], v[20:23], v[212:215]
  ds_read_b64_tr_b16 v[70:71], v88 offset:23232
  s_waitcnt lgkmcnt(8)
  v_mfma_f32_16x16x32_bf16 v[144:147], v[48:51], v[16:19], v[144:147]
  ds_read_b64_tr_b16 v[72:73], v88 offset:224
  v_mfma_f32_16x16x32_bf16 v[148:151], v[48:51], v[20:23], v[148:151]
  ds_read_b64_tr_b16 v[74:75], v88 offset:4832
  v_mfma_f32_16x16x32_bf16 v[216:219], v[52:55], v[16:19], v[216:219]
  ds_read_b64_tr_b16 v[76:77], v88 offset:18656
  v_mfma_f32_16x16x32_bf16 v[220:223], v[52:55], v[20:23], v[220:223]
  ds_read_b64_tr_b16 v[78:79], v88 offset:23264
  s_waitcnt lgkmcnt(8)
  v_mfma_f32_16x16x32_bf16 v[152:155], v[56:59], v[16:19], v[152:155]
  ds_read_b64_tr_b16 v[48:49], v88 offset:256
  v_mfma_f32_16x16x32_bf16 v[156:159], v[56:59], v[20:23], v[156:159]
  ds_read_b64_tr_b16 v[50:51], v88 offset:4864
  v_mfma_f32_16x16x32_bf16 v[224:227], v[60:63], v[16:19], v[224:227]
  ds_read_b64_tr_b16 v[52:53], v88 offset:18688
  v_mfma_f32_16x16x32_bf16 v[228:231], v[60:63], v[20:23], v[228:231]
  ds_read_b64_tr_b16 v[54:55], v88 offset:23296
  s_waitcnt lgkmcnt(8)
  v_mfma_f32_16x16x32_bf16 v[160:163], v[64:67], v[16:19], v[160:163]
  ds_read_b64_tr_b16 v[56:57], v88 offset:9216
  v_mfma_f32_16x16x32_bf16 v[164:167], v[64:67], v[20:23], v[164:167]
  ds_read_b64_tr_b16 v[58:59], v88 offset:13824
  v_mfma_f32_16x16x32_bf16 v[232:235], v[68:71], v[16:19], v[232:235]
  ds_read_b64_tr_b16 v[60:61], v88 offset:27648
  v_mfma_f32_16x16x32_bf16 v[236:239], v[68:71], v[20:23], v[236:239]
  ds_read_b64_tr_b16 v[62:63], v88 offset:32256
  s_waitcnt lgkmcnt(8)
  v_mfma_f32_16x16x32_bf16 v[168:171], v[72:75], v[16:19], v[168:171]
  ds_read_b64_tr_b16 v[64:65], v88 offset:9248
  v_mfma_f32_16x16x32_bf16 v[172:175], v[72:75], v[20:23], v[172:175]
  ds_read_b64_tr_b16 v[66:67], v88 offset:13856
  v_mfma_f32_16x16x32_bf16 v[240:243], v[76:79], v[16:19], v[240:243]
  ds_read_b64_tr_b16 v[68:69], v88 offset:27680
  v_mfma_f32_16x16x32_bf16 v[244:247], v[76:79], v[20:23], v[244:247]
  ds_read_b64_tr_b16 v[70:71], v88 offset:32288
  s_waitcnt lgkmcnt(8)
  v_mfma_f32_16x16x32_bf16 v[176:179], v[48:51], v[16:19], v[176:179]
  ds_read_b64_tr_b16 v[72:73], v88 offset:9280
  v_mfma_f32_16x16x32_bf16 v[180:183], v[48:51], v[20:23], v[180:183]
  ds_read_b64_tr_b16 v[74:75], v88 offset:13888
  v_mfma_f32_16x16x32_bf16 v[248:251], v[52:55], v[16:19], v[248:251]
  ds_read_b64_tr_b16 v[76:77], v88 offset:27712
  v_mfma_f32_16x16x32_bf16 v[252:255], v[52:55], v[20:23], v[252:255]
  ds_read_b64_tr_b16 v[78:79], v88 offset:32320
  buffer_load_dwordx4 v[16:19], v85, s[12:15], s53 offen offset:0 sc1
  buffer_load_dwordx4 v[20:23], v86, s[12:15], s53 offen offset:0 sc1
  s_waitcnt vmcnt(13)
  s_barrier
  s_waitcnt vmcnt(11)
  s_waitcnt lgkmcnt(8)
  v_mfma_f32_16x16x32_bf16 v[112:115], v[56:59], v[24:27], v[112:115]
  ds_read_b64_tr_b16 v[48:49], v88 offset:9312
  v_mfma_f32_16x16x32_bf16 v[116:119], v[56:59], v[28:31], v[116:119]
  ds_read_b64_tr_b16 v[50:51], v88 offset:13920
  s_mov_b32 s29, 4128768
  s_add_u32 m0, s28, 110592
  s_nop 0
  buffer_load_dwordx4 v80, s[8:11], s29 offen lds
  v_mfma_f32_16x16x32_bf16 v[184:187], v[60:63], v[24:27], v[184:187]
  ds_read_b64_tr_b16 v[52:53], v88 offset:27744
  v_mfma_f32_16x16x32_bf16 v[188:191], v[60:63], v[28:31], v[188:191]
  ds_read_b64_tr_b16 v[54:55], v88 offset:32352
  s_waitcnt lgkmcnt(8)
  v_mfma_f32_16x16x32_bf16 v[120:123], v[64:67], v[24:27], v[120:123]
  ds_read_b64_tr_b16 v[56:57], v88 offset:9344
  v_mfma_f32_16x16x32_bf16 v[124:127], v[64:67], v[28:31], v[124:127]
  ds_read_b64_tr_b16 v[58:59], v88 offset:13952
  v_mfma_f32_16x16x32_bf16 v[192:195], v[68:71], v[24:27], v[192:195]
  ds_read_b64_tr_b16 v[60:61], v88 offset:27776
  v_mfma_f32_16x16x32_bf16 v[196:199], v[68:71], v[28:31], v[196:199]
  ds_read_b64_tr_b16 v[62:63], v88 offset:32384
  s_mov_b32 s29, 4128768
  s_add_u32 m0, s28, 111616
  s_nop 0
  buffer_load_dwordx4 v81, s[8:11], s29 offen lds
  s_waitcnt lgkmcnt(8)
  v_mfma_f32_16x16x32_bf16 v[128:131], v[72:75], v[24:27], v[128:131]
  ds_read_b64_tr_b16 v[64:65], v88 offset:9376
  v_mfma_f32_16x16x32_bf16 v[132:135], v[72:75], v[28:31], v[132:135]
  ds_read_b64_tr_b16 v[66:67], v88 offset:13984
  v_mfma_f32_16x16x32_bf16 v[200:203], v[76:79], v[24:27], v[200:203]
  ds_read_b64_tr_b16 v[68:69], v88 offset:27808
  v_mfma_f32_16x16x32_bf16 v[204:207], v[76:79], v[28:31], v[204:207]
  ds_read_b64_tr_b16 v[70:71], v88 offset:32416
  s_waitcnt lgkmcnt(8)
  v_mfma_f32_16x16x32_bf16 v[136:139], v[48:51], v[24:27], v[136:139]
  ds_read_b64_tr_b16 v[72:73], v88 offset:9408
  v_mfma_f32_16x16x32_bf16 v[140:143], v[48:51], v[28:31], v[140:143]
  ds_read_b64_tr_b16 v[74:75], v88 offset:14016
  s_mov_b32 s29, 4128768
  s_add_u32 m0, s28, 112640
  s_nop 0
  buffer_load_dwordx4 v82, s[8:11], s29 offen lds
  v_mfma_f32_16x16x32_bf16 v[208:211], v[52:55], v[24:27], v[208:211]
  ds_read_b64_tr_b16 v[76:77], v88 offset:27840
  v_mfma_f32_16x16x32_bf16 v[212:215], v[52:55], v[28:31], v[212:215]
  ds_read_b64_tr_b16 v[78:79], v88 offset:32448
  s_waitcnt lgkmcnt(8)
  v_mfma_f32_16x16x32_bf16 v[144:147], v[56:59], v[24:27], v[144:147]
  ds_read_b64_tr_b16 v[48:49], v88 offset:9440
  v_mfma_f32_16x16x32_bf16 v[148:151], v[56:59], v[28:31], v[148:151]
  ds_read_b64_tr_b16 v[50:51], v88 offset:14048
  v_mfma_f32_16x16x32_bf16 v[216:219], v[60:63], v[24:27], v[216:219]
  ds_read_b64_tr_b16 v[52:53], v88 offset:27872
  v_mfma_f32_16x16x32_bf16 v[220:223], v[60:63], v[28:31], v[220:223]
  ds_read_b64_tr_b16 v[54:55], v88 offset:32480
  s_mov_b32 s29, 4128768
  s_add_u32 m0, s28, 113664
  s_nop 0
  buffer_load_dwordx4 v83, s[8:11], s29 offen lds
  s_waitcnt lgkmcnt(8)
  v_mfma_f32_16x16x32_bf16 v[152:155], v[64:67], v[24:27], v[152:155]
  ds_read_b64_tr_b16 v[56:57], v88 offset:9472
  v_mfma_f32_16x16x32_bf16 v[156:159], v[64:67], v[28:31], v[156:159]
  ds_read_b64_tr_b16 v[58:59], v88 offset:14080
  v_mfma_f32_16x16x32_bf16 v[224:227], v[68:71], v[24:27], v[224:227]
  ds_read_b64_tr_b16 v[60:61], v88 offset:27904
  v_mfma_f32_16x16x32_bf16 v[228:231], v[68:71], v[28:31], v[228:231]
  ds_read_b64_tr_b16 v[62:63], v88 offset:32512
  s_waitcnt lgkmcnt(8)
  v_mfma_f32_16x16x32_bf16 v[160:163], v[72:75], v[24:27], v[160:163]
  ds_read_b64_tr_b16 v[64:65], v89 offset:0
  v_mfma_f32_16x16x32_bf16 v[164:167], v[72:75], v[28:31], v[164:167]
  ds_read_b64_tr_b16 v[66:67], v89 offset:4608
  s_mov_b32 s29, 4128768
  s_add_u32 m0, s28, 114688
  s_mov_b32 exec_hi, 0
  buffer_load_dwordx4 v84, s[8:11], s29 offen lds
  s_mov_b32 exec_hi, -1
  v_mfma_f32_16x16x32_bf16 v[232:235], v[76:79], v[24:27], v[232:235]
  ds_read_b64_tr_b16 v[68:69], v89 offset:18432
  v_mfma_f32_16x16x32_bf16 v[236:239], v[76:79], v[28:31], v[236:239]
  ds_read_b64_tr_b16 v[70:71], v89 offset:23040
  s_waitcnt lgkmcnt(8)
  v_mfma_f32_16x16x32_bf16 v[168:171], v[48:51], v[24:27], v[168:171]
  ds_read_b64_tr_b16 v[72:73], v89 offset:32
  v_mfma_f32_16x16x32_bf16 v[172:175], v[48:51], v[28:31], v[172:175]
  ds_read_b64_tr_b16 v[74:75], v89 offset:4640
  v_mfma_f32_16x16x32_bf16 v[240:243], v[52:55], v[24:27], v[240:243]
  ds_read_b64_tr_b16 v[76:77], v89 offset:18464
  v_mfma_f32_16x16x32_bf16 v[244:247], v[52:55], v[28:31], v[244:247]
  ds_read_b64_tr_b16 v[78:79], v89 offset:23072
  s_waitcnt lgkmcnt(8)
  v_mfma_f32_16x16x32_bf16 v[176:179], v[56:59], v[24:27], v[176:179]
  ds_read_b64_tr_b16 v[48:49], v89 offset:64
  v_mfma_f32_16x16x32_bf16 v[180:183], v[56:59], v[28:31], v[180:183]
  ds_read_b64_tr_b16 v[50:51], v89 offset:4672
  v_mfma_f32_16x16x32_bf16 v[248:251], v[60:63], v[24:27], v[248:251]
  ds_read_b64_tr_b16 v[52:53], v89 offset:18496
  v_mfma_f32_16x16x32_bf16 v[252:255], v[60:63], v[28:31], v[252:255]
  ds_read_b64_tr_b16 v[54:55], v89 offset:23104
  buffer_load_dwordx4 v[24:27], v85, s[12:15], s53 offen offset:1024 sc1
  buffer_load_dwordx4 v[28:31], v86, s[12:15], s53 offen offset:1024 sc1
  s_waitcnt vmcnt(16)
  s_waitcnt lgkmcnt(8)
  v_mfma_f32_16x16x32_bf16 v[112:115], v[64:67], v[32:35], v[112:115]
  ds_read_b64_tr_b16 v[56:57], v89 offset:96
  v_mfma_f32_16x16x32_bf16 v[116:119], v[64:67], v[36:39], v[116:119]
  ds_read_b64_tr_b16 v[58:59], v89 offset:4704
  v_mfma_f32_16x16x32_bf16 v[184:187], v[68:71], v[32:35], v[184:187]
  ds_read_b64_tr_b16 v[60:61], v89 offset:18528
  v_mfma_f32_16x16x32_bf16 v[188:191], v[68:71], v[36:39], v[188:191]
  ds_read_b64_tr_b16 v[62:63], v89 offset:23136
  s_waitcnt lgkmcnt(8)
  v_mfma_f32_16x16x32_bf16 v[120:123], v[72:75], v[32:35], v[120:123]
  ds_read_b64_tr_b16 v[64:65], v89 offset:128
  v_mfma_f32_16x16x32_bf16 v[124:127], v[72:75], v[36:39], v[124:127]
  ds_read_b64_tr_b16 v[66:67], v89 offset:4736
  v_mfma_f32_16x16x32_bf16 v[192:195], v[76:79], v[32:35], v[192:195]
  ds_read_b64_tr_b16 v[68:69], v89 offset:18560
  v_mfma_f32_16x16x32_bf16 v[196:199], v[76:79], v[36:39], v[196:199]
  ds_read_b64_tr_b16 v[70:71], v89 offset:23168
  s_waitcnt lgkmcnt(8)
  v_mfma_f32_16x16x32_bf16 v[128:131], v[48:51], v[32:35], v[128:131]
  ds_read_b64_tr_b16 v[72:73], v89 offset:160
  v_mfma_f32_16x16x32_bf16 v[132:135], v[48:51], v[36:39], v[132:135]
  ds_read_b64_tr_b16 v[74:75], v89 offset:4768
  v_mfma_f32_16x16x32_bf16 v[200:203], v[52:55], v[32:35], v[200:203]
  ds_read_b64_tr_b16 v[76:77], v89 offset:18592
  v_mfma_f32_16x16x32_bf16 v[204:207], v[52:55], v[36:39], v[204:207]
  ds_read_b64_tr_b16 v[78:79], v89 offset:23200
  s_waitcnt lgkmcnt(8)
  v_mfma_f32_16x16x32_bf16 v[136:139], v[56:59], v[32:35], v[136:139]
  ds_read_b64_tr_b16 v[48:49], v89 offset:192
  v_mfma_f32_16x16x32_bf16 v[140:143], v[56:59], v[36:39], v[140:143]
  ds_read_b64_tr_b16 v[50:51], v89 offset:4800
  v_mfma_f32_16x16x32_bf16 v[208:211], v[60:63], v[32:35], v[208:211]
  ds_read_b64_tr_b16 v[52:53], v89 offset:18624
  v_mfma_f32_16x16x32_bf16 v[212:215], v[60:63], v[36:39], v[212:215]
  ds_read_b64_tr_b16 v[54:55], v89 offset:23232
  s_waitcnt lgkmcnt(8)
  v_mfma_f32_16x16x32_bf16 v[144:147], v[64:67], v[32:35], v[144:147]
  ds_read_b64_tr_b16 v[56:57], v89 offset:224
  v_mfma_f32_16x16x32_bf16 v[148:151], v[64:67], v[36:39], v[148:151]
  ds_read_b64_tr_b16 v[58:59], v89 offset:4832
  v_mfma_f32_16x16x32_bf16 v[216:219], v[68:71], v[32:35], v[216:219]
  ds_read_b64_tr_b16 v[60:61], v89 offset:18656
  v_mfma_f32_16x16x32_bf16 v[220:223], v[68:71], v[36:39], v[220:223]
  ds_read_b64_tr_b16 v[62:63], v89 offset:23264
  s_waitcnt lgkmcnt(8)
  v_mfma_f32_16x16x32_bf16 v[152:155], v[72:75], v[32:35], v[152:155]
  ds_read_b64_tr_b16 v[64:65], v89 offset:256
  v_mfma_f32_16x16x32_bf16 v[156:159], v[72:75], v[36:39], v[156:159]
  ds_read_b64_tr_b16 v[66:67], v89 offset:4864
  v_mfma_f32_16x16x32_bf16 v[224:227], v[76:79], v[32:35], v[224:227]
  ds_read_b64_tr_b16 v[68:69], v89 offset:18688
  v_mfma_f32_16x16x32_bf16 v[228:231], v[76:79], v[36:39], v[228:231]
  ds_read_b64_tr_b16 v[70:71], v89 offset:23296
  s_waitcnt lgkmcnt(8)
  v_mfma_f32_16x16x32_bf16 v[160:163], v[48:51], v[32:35], v[160:163]
  ds_read_b64_tr_b16 v[72:73], v89 offset:9216
  v_mfma_f32_16x16x32_bf16 v[164:167], v[48:51], v[36:39], v[164:167]
  ds_read_b64_tr_b16 v[74:75], v89 offset:13824
  v_mfma_f32_16x16x32_bf16 v[232:235], v[52:55], v[32:35], v[232:235]
  ds_read_b64_tr_b16 v[76:77], v89 offset:27648
  v_mfma_f32_16x16x32_bf16 v[236:239], v[52:55], v[36:39], v[236:239]
  ds_read_b64_tr_b16 v[78:79], v89 offset:32256
  s_waitcnt lgkmcnt(8)
  v_mfma_f32_16x16x32_bf16 v[168:171], v[56:59], v[32:35], v[168:171]
  ds_read_b64_tr_b16 v[48:49], v89 offset:9248
  v_mfma_f32_16x16x32_bf16 v[172:175], v[56:59], v[36:39], v[172:175]
  ds_read_b64_tr_b16 v[50:51], v89 offset:13856
  v_mfma_f32_16x16x32_bf16 v[240:243], v[60:63], v[32:35], v[240:243]
  ds_read_b64_tr_b16 v[52:53], v89 offset:27680
  v_mfma_f32_16x16x32_bf16 v[244:247], v[60:63], v[36:39], v[244:247]
  ds_read_b64_tr_b16 v[54:55], v89 offset:32288
  s_waitcnt lgkmcnt(8)
  v_mfma_f32_16x16x32_bf16 v[176:179], v[64:67], v[32:35], v[176:179]
  ds_read_b64_tr_b16 v[56:57], v89 offset:9280
  v_mfma_f32_16x16x32_bf16 v[180:183], v[64:67], v[36:39], v[180:183]
  ds_read_b64_tr_b16 v[58:59], v89 offset:13888
  v_mfma_f32_16x16x32_bf16 v[248:251], v[68:71], v[32:35], v[248:251]
  ds_read_b64_tr_b16 v[60:61], v89 offset:27712
  v_mfma_f32_16x16x32_bf16 v[252:255], v[68:71], v[36:39], v[252:255]
  ds_read_b64_tr_b16 v[62:63], v89 offset:32320
  buffer_load_dwordx4 v[32:35], v85, s[12:15], s53 offen offset:2048 sc1
  buffer_load_dwordx4 v[36:39], v86, s[12:15], s53 offen offset:2048 sc1
  s_waitcnt vmcnt(13)
  s_barrier
  s_waitcnt vmcnt(11)
  s_waitcnt lgkmcnt(8)
  v_mfma_f32_16x16x32_bf16 v[112:115], v[72:75], v[40:43], v[112:115]
  ds_read_b64_tr_b16 v[64:65], v89 offset:9312
  v_mfma_f32_16x16x32_bf16 v[116:119], v[72:75], v[44:47], v[116:119]
  ds_read_b64_tr_b16 v[66:67], v89 offset:13920
  s_mov_b32 s29, 4718592
  s_add_u32 m0, s28, 0
  s_nop 0
  buffer_load_dwordx4 v80, s[8:11], s29 offen lds
  v_mfma_f32_16x16x32_bf16 v[184:187], v[76:79], v[40:43], v[184:187]
  ds_read_b64_tr_b16 v[68:69], v89 offset:27744
  v_mfma_f32_16x16x32_bf16 v[188:191], v[76:79], v[44:47], v[188:191]
  ds_read_b64_tr_b16 v[70:71], v89 offset:32352
  s_waitcnt lgkmcnt(8)
  v_mfma_f32_16x16x32_bf16 v[120:123], v[48:51], v[40:43], v[120:123]
  ds_read_b64_tr_b16 v[72:73], v89 offset:9344
  v_mfma_f32_16x16x32_bf16 v[124:127], v[48:51], v[44:47], v[124:127]
  ds_read_b64_tr_b16 v[74:75], v89 offset:13952
  v_mfma_f32_16x16x32_bf16 v[192:195], v[52:55], v[40:43], v[192:195]
  ds_read_b64_tr_b16 v[76:77], v89 offset:27776
  v_mfma_f32_16x16x32_bf16 v[196:199], v[52:55], v[44:47], v[196:199]
  ds_read_b64_tr_b16 v[78:79], v89 offset:32384
  s_mov_b32 s29, 4718592
  s_add_u32 m0, s28, 1024
  s_nop 0
  buffer_load_dwordx4 v81, s[8:11], s29 offen lds
  s_waitcnt lgkmcnt(8)
  v_mfma_f32_16x16x32_bf16 v[128:131], v[56:59], v[40:43], v[128:131]
  ds_read_b64_tr_b16 v[48:49], v89 offset:9376
  v_mfma_f32_16x16x32_bf16 v[132:135], v[56:59], v[44:47], v[132:135]
  ds_read_b64_tr_b16 v[50:51], v89 offset:13984
  v_mfma_f32_16x16x32_bf16 v[200:203], v[60:63], v[40:43], v[200:203]
  ds_read_b64_tr_b16 v[52:53], v89 offset:27808
  v_mfma_f32_16x16x32_bf16 v[204:207], v[60:63], v[44:47], v[204:207]
  ds_read_b64_tr_b16 v[54:55], v89 offset:32416
  s_waitcnt lgkmcnt(8)
  v_mfma_f32_16x16x32_bf16 v[136:139], v[64:67], v[40:43], v[136:139]
  ds_read_b64_tr_b16 v[56:57], v89 offset:9408
  v_mfma_f32_16x16x32_bf16 v[140:143], v[64:67], v[44:47], v[140:143]
  ds_read_b64_tr_b16 v[58:59], v89 offset:14016
  s_mov_b32 s29, 4718592
  s_add_u32 m0, s28, 2048
  s_nop 0
  buffer_load_dwordx4 v82, s[8:11], s29 offen lds
  v_mfma_f32_16x16x32_bf16 v[208:211], v[68:71], v[40:43], v[208:211]
  ds_read_b64_tr_b16 v[60:61], v89 offset:27840
  v_mfma_f32_16x16x32_bf16 v[212:215], v[68:71], v[44:47], v[212:215]
  ds_read_b64_tr_b16 v[62:63], v89 offset:32448
  s_waitcnt lgkmcnt(8)
  v_mfma_f32_16x16x32_bf16 v[144:147], v[72:75], v[40:43], v[144:147]
  ds_read_b64_tr_b16 v[64:65], v89 offset:9440
  v_mfma_f32_16x16x32_bf16 v[148:151], v[72:75], v[44:47], v[148:151]
  ds_read_b64_tr_b16 v[66:67], v89 offset:14048
  v_mfma_f32_16x16x32_bf16 v[216:219], v[76:79], v[40:43], v[216:219]
  ds_read_b64_tr_b16 v[68:69], v89 offset:27872
  v_mfma_f32_16x16x32_bf16 v[220:223], v[76:79], v[44:47], v[220:223]
  ds_read_b64_tr_b16 v[70:71], v89 offset:32480
  s_mov_b32 s29, 4718592
  s_add_u32 m0, s28, 3072
  s_nop 0
  buffer_load_dwordx4 v83, s[8:11], s29 offen lds
  s_waitcnt lgkmcnt(8)
  v_mfma_f32_16x16x32_bf16 v[152:155], v[48:51], v[40:43], v[152:155]
  ds_read_b64_tr_b16 v[72:73], v89 offset:9472
  v_mfma_f32_16x16x32_bf16 v[156:159], v[48:51], v[44:47], v[156:159]
  ds_read_b64_tr_b16 v[74:75], v89 offset:14080
  v_mfma_f32_16x16x32_bf16 v[224:227], v[52:55], v[40:43], v[224:227]
  ds_read_b64_tr_b16 v[76:77], v89 offset:27904
  v_mfma_f32_16x16x32_bf16 v[228:231], v[52:55], v[44:47], v[228:231]
  ds_read_b64_tr_b16 v[78:79], v89 offset:32512
  s_waitcnt lgkmcnt(8)
  v_mfma_f32_16x16x32_bf16 v[160:163], v[56:59], v[40:43], v[160:163]
  ds_read_b64_tr_b16 v[48:49], v90 offset:0
  v_mfma_f32_16x16x32_bf16 v[164:167], v[56:59], v[44:47], v[164:167]
  ds_read_b64_tr_b16 v[50:51], v90 offset:4608
  s_mov_b32 s29, 4718592
  s_add_u32 m0, s28, 4096
  s_mov_b32 exec_hi, 0
  buffer_load_dwordx4 v84, s[8:11], s29 offen lds
  s_mov_b32 exec_hi, -1
  v_mfma_f32_16x16x32_bf16 v[232:235], v[60:63], v[40:43], v[232:235]
  ds_read_b64_tr_b16 v[52:53], v90 offset:18432
  v_mfma_f32_16x16x32_bf16 v[236:239], v[60:63], v[44:47], v[236:239]
  ds_read_b64_tr_b16 v[54:55], v90 offset:23040
  s_waitcnt lgkmcnt(8)
  v_mfma_f32_16x16x32_bf16 v[168:171], v[64:67], v[40:43], v[168:171]
  ds_read_b64_tr_b16 v[56:57], v90 offset:32
  v_mfma_f32_16x16x32_bf16 v[172:175], v[64:67], v[44:47], v[172:175]
  ds_read_b64_tr_b16 v[58:59], v90 offset:4640
  v_mfma_f32_16x16x32_bf16 v[240:243], v[68:71], v[40:43], v[240:243]
  ds_read_b64_tr_b16 v[60:61], v90 offset:18464
  v_mfma_f32_16x16x32_bf16 v[244:247], v[68:71], v[44:47], v[244:247]
  ds_read_b64_tr_b16 v[62:63], v90 offset:23072
  s_waitcnt lgkmcnt(8)
  v_mfma_f32_16x16x32_bf16 v[176:179], v[72:75], v[40:43], v[176:179]
  ds_read_b64_tr_b16 v[64:65], v90 offset:64
  v_mfma_f32_16x16x32_bf16 v[180:183], v[72:75], v[44:47], v[180:183]
  ds_read_b64_tr_b16 v[66:67], v90 offset:4672
  v_mfma_f32_16x16x32_bf16 v[248:251], v[76:79], v[40:43], v[248:251]
  ds_read_b64_tr_b16 v[68:69], v90 offset:18496
  v_mfma_f32_16x16x32_bf16 v[252:255], v[76:79], v[44:47], v[252:255]
  ds_read_b64_tr_b16 v[70:71], v90 offset:23104
  buffer_load_dwordx4 v[40:43], v85, s[12:15], s53 offen offset:3072 sc1
  buffer_load_dwordx4 v[44:47], v86, s[12:15], s53 offen offset:3072 sc1
  v_mov_b32 v14, 0
  s_movk_i32 s27, 128
  buffer_load_dword v13, v14, s[36:39], s27 offen sc0 sc1
  s_waitcnt vmcnt(17)
  s_waitcnt lgkmcnt(8)
  v_mfma_f32_16x16x32_bf16 v[112:115], v[48:51], v[16:19], v[112:115]
  ds_read_b64_tr_b16 v[72:73], v90 offset:96
  v_mfma_f32_16x16x32_bf16 v[116:119], v[48:51], v[20:23], v[116:119]
  ds_read_b64_tr_b16 v[74:75], v90 offset:4704
  v_mfma_f32_16x16x32_bf16 v[184:187], v[52:55], v[16:19], v[184:187]
  ds_read_b64_tr_b16 v[76:77], v90 offset:18528
  v_mfma_f32_16x16x32_bf16 v[188:191], v[52:55], v[20:23], v[188:191]
  ds_read_b64_tr_b16 v[78:79], v90 offset:23136
  s_waitcnt lgkmcnt(8)
  v_mfma_f32_16x16x32_bf16 v[120:123], v[56:59], v[16:19], v[120:123]
  ds_read_b64_tr_b16 v[48:49], v90 offset:128
  v_mfma_f32_16x16x32_bf16 v[124:127], v[56:59], v[20:23], v[124:127]
  ds_read_b64_tr_b16 v[50:51], v90 offset:4736
  v_mfma_f32_16x16x32_bf16 v[192:195], v[60:63], v[16:19], v[192:195]
  ds_read_b64_tr_b16 v[52:53], v90 offset:18560
  v_mfma_f32_16x16x32_bf16 v[196:199], v[60:63], v[20:23], v[196:199]
  ds_read_b64_tr_b16 v[54:55], v90 offset:23168
  s_waitcnt lgkmcnt(8)
  v_mfma_f32_16x16x32_bf16 v[128:131], v[64:67], v[16:19], v[128:131]
  ds_read_b64_tr_b16 v[56:57], v90 offset:160
  v_mfma_f32_16x16x32_bf16 v[132:135], v[64:67], v[20:23], v[132:135]
  ds_read_b64_tr_b16 v[58:59], v90 offset:4768
  v_mfma_f32_16x16x32_bf16 v[200:203], v[68:71], v[16:19], v[200:203]
  ds_read_b64_tr_b16 v[60:61], v90 offset:18592
  v_mfma_f32_16x16x32_bf16 v[204:207], v[68:71], v[20:23], v[204:207]
  ds_read_b64_tr_b16 v[62:63], v90 offset:23200
  s_waitcnt lgkmcnt(8)
  v_mfma_f32_16x16x32_bf16 v[136:139], v[72:75], v[16:19], v[136:139]
  ds_read_b64_tr_b16 v[64:65], v90 offset:192
  v_mfma_f32_16x16x32_bf16 v[140:143], v[72:75], v[20:23], v[140:143]
  ds_read_b64_tr_b16 v[66:67], v90 offset:4800
  v_mfma_f32_16x16x32_bf16 v[208:211], v[76:79], v[16:19], v[208:211]
  ds_read_b64_tr_b16 v[68:69], v90 offset:18624
  v_mfma_f32_16x16x32_bf16 v[212:215], v[76:79], v[20:23], v[212:215]
  ds_read_b64_tr_b16 v[70:71], v90 offset:23232
  s_waitcnt lgkmcnt(8)
  v_mfma_f32_16x16x32_bf16 v[144:147], v[48:51], v[16:19], v[144:147]
  ds_read_b64_tr_b16 v[72:73], v90 offset:224
  v_mfma_f32_16x16x32_bf16 v[148:151], v[48:51], v[20:23], v[148:151]
  ds_read_b64_tr_b16 v[74:75], v90 offset:4832
  v_mfma_f32_16x16x32_bf16 v[216:219], v[52:55], v[16:19], v[216:219]
  ds_read_b64_tr_b16 v[76:77], v90 offset:18656
  v_mfma_f32_16x16x32_bf16 v[220:223], v[52:55], v[20:23], v[220:223]
  ds_read_b64_tr_b16 v[78:79], v90 offset:23264
  s_waitcnt lgkmcnt(8)
  v_mfma_f32_16x16x32_bf16 v[152:155], v[56:59], v[16:19], v[152:155]
  ds_read_b64_tr_b16 v[48:49], v90 offset:256
  v_mfma_f32_16x16x32_bf16 v[156:159], v[56:59], v[20:23], v[156:159]
  ds_read_b64_tr_b16 v[50:51], v90 offset:4864
  v_mfma_f32_16x16x32_bf16 v[224:227], v[60:63], v[16:19], v[224:227]
  ds_read_b64_tr_b16 v[52:53], v90 offset:18688
  v_mfma_f32_16x16x32_bf16 v[228:231], v[60:63], v[20:23], v[228:231]
  ds_read_b64_tr_b16 v[54:55], v90 offset:23296
  s_waitcnt lgkmcnt(8)
  v_mfma_f32_16x16x32_bf16 v[160:163], v[64:67], v[16:19], v[160:163]
  ds_read_b64_tr_b16 v[56:57], v90 offset:9216
  v_mfma_f32_16x16x32_bf16 v[164:167], v[64:67], v[20:23], v[164:167]
  ds_read_b64_tr_b16 v[58:59], v90 offset:13824
  v_mfma_f32_16x16x32_bf16 v[232:235], v[68:71], v[16:19], v[232:235]
  ds_read_b64_tr_b16 v[60:61], v90 offset:27648
  v_mfma_f32_16x16x32_bf16 v[236:239], v[68:71], v[20:23], v[236:239]
  ds_read_b64_tr_b16 v[62:63], v90 offset:32256
  s_waitcnt lgkmcnt(8)
  v_mfma_f32_16x16x32_bf16 v[168:171], v[72:75], v[16:19], v[168:171]
  ds_read_b64_tr_b16 v[64:65], v90 offset:9248
  v_mfma_f32_16x16x32_bf16 v[172:175], v[72:75], v[20:23], v[172:175]
  ds_read_b64_tr_b16 v[66:67], v90 offset:13856
  v_mfma_f32_16x16x32_bf16 v[240:243], v[76:79], v[16:19], v[240:243]
  ds_read_b64_tr_b16 v[68:69], v90 offset:27680
  v_mfma_f32_16x16x32_bf16 v[244:247], v[76:79], v[20:23], v[244:247]
  ds_read_b64_tr_b16 v[70:71], v90 offset:32288
  s_waitcnt lgkmcnt(8)
  v_mfma_f32_16x16x32_bf16 v[176:179], v[48:51], v[16:19], v[176:179]
  ds_read_b64_tr_b16 v[72:73], v90 offset:9280
  v_mfma_f32_16x16x32_bf16 v[180:183], v[48:51], v[20:23], v[180:183]
  ds_read_b64_tr_b16 v[74:75], v90 offset:13888
  v_mfma_f32_16x16x32_bf16 v[248:251], v[52:55], v[16:19], v[248:251]
  ds_read_b64_tr_b16 v[76:77], v90 offset:27712
  v_mfma_f32_16x16x32_bf16 v[252:255], v[52:55], v[20:23], v[252:255]
  ds_read_b64_tr_b16 v[78:79], v90 offset:32320
  buffer_load_dwordx4 v[16:19], v85, s[12:15], s54 offen offset:0 sc1
  buffer_load_dwordx4 v[20:23], v86, s[12:15], s54 offen offset:0 sc1
  s_waitcnt vmcnt(14)
  s_waitcnt vmcnt(5)
  s_barrier
  s_waitcnt lgkmcnt(8)
  v_mfma_f32_16x16x32_bf16 v[112:115], v[56:59], v[24:27], v[112:115]
  ds_read_b64_tr_b16 v[48:49], v90 offset:9312
  v_mfma_f32_16x16x32_bf16 v[116:119], v[56:59], v[28:31], v[116:119]
  ds_read_b64_tr_b16 v[50:51], v90 offset:13920
  v_mfma_f32_16x16x32_bf16 v[184:187], v[60:63], v[24:27], v[184:187]
  ds_read_b64_tr_b16 v[52:53], v90 offset:27744
  v_mfma_f32_16x16x32_bf16 v[188:191], v[60:63], v[28:31], v[188:191]
  ds_read_b64_tr_b16 v[54:55], v90 offset:32352
  s_waitcnt lgkmcnt(8)
  v_mfma_f32_16x16x32_bf16 v[120:123], v[64:67], v[24:27], v[120:123]
  ds_read_b64_tr_b16 v[56:57], v90 offset:9344
  v_mfma_f32_16x16x32_bf16 v[124:127], v[64:67], v[28:31], v[124:127]
  ds_read_b64_tr_b16 v[58:59], v90 offset:13952
  v_mfma_f32_16x16x32_bf16 v[192:195], v[68:71], v[24:27], v[192:195]
  ds_read_b64_tr_b16 v[60:61], v90 offset:27776
  v_mfma_f32_16x16x32_bf16 v[196:199], v[68:71], v[28:31], v[196:199]
  ds_read_b64_tr_b16 v[62:63], v90 offset:32384
  s_waitcnt lgkmcnt(8)
  v_mfma_f32_16x16x32_bf16 v[128:131], v[72:75], v[24:27], v[128:131]
  ds_read_b64_tr_b16 v[64:65], v90 offset:9376
  v_mfma_f32_16x16x32_bf16 v[132:135], v[72:75], v[28:31], v[132:135]
  ds_read_b64_tr_b16 v[66:67], v90 offset:13984
  v_mfma_f32_16x16x32_bf16 v[200:203], v[76:79], v[24:27], v[200:203]
  ds_read_b64_tr_b16 v[68:69], v90 offset:27808
  v_mfma_f32_16x16x32_bf16 v[204:207], v[76:79], v[28:31], v[204:207]
  ds_read_b64_tr_b16 v[70:71], v90 offset:32416
  s_waitcnt lgkmcnt(8)
  v_mfma_f32_16x16x32_bf16 v[136:139], v[48:51], v[24:27], v[136:139]
  ds_read_b64_tr_b16 v[72:73], v90 offset:9408
  v_mfma_f32_16x16x32_bf16 v[140:143], v[48:51], v[28:31], v[140:143]
  ds_read_b64_tr_b16 v[74:75], v90 offset:14016
  v_mfma_f32_16x16x32_bf16 v[208:211], v[52:55], v[24:27], v[208:211]
  ds_read_b64_tr_b16 v[76:77], v90 offset:27840
  v_mfma_f32_16x16x32_bf16 v[212:215], v[52:55], v[28:31], v[212:215]
  ds_read_b64_tr_b16 v[78:79], v90 offset:32448
  s_waitcnt lgkmcnt(8)
  v_mfma_f32_16x16x32_bf16 v[144:147], v[56:59], v[24:27], v[144:147]
  ds_read_b64_tr_b16 v[48:49], v90 offset:9440
  v_mfma_f32_16x16x32_bf16 v[148:151], v[56:59], v[28:31], v[148:151]
  ds_read_b64_tr_b16 v[50:51], v90 offset:14048
  v_mfma_f32_16x16x32_bf16 v[216:219], v[60:63], v[24:27], v[216:219]
  ds_read_b64_tr_b16 v[52:53], v90 offset:27872
  v_mfma_f32_16x16x32_bf16 v[220:223], v[60:63], v[28:31], v[220:223]
  ds_read_b64_tr_b16 v[54:55], v90 offset:32480
  s_waitcnt lgkmcnt(8)
  v_mfma_f32_16x16x32_bf16 v[152:155], v[64:67], v[24:27], v[152:155]
  ds_read_b64_tr_b16 v[56:57], v90 offset:9472
  v_mfma_f32_16x16x32_bf16 v[156:159], v[64:67], v[28:31], v[156:159]
  ds_read_b64_tr_b16 v[58:59], v90 offset:14080
  v_mfma_f32_16x16x32_bf16 v[224:227], v[68:71], v[24:27], v[224:227]
  ds_read_b64_tr_b16 v[60:61], v90 offset:27904
  v_mfma_f32_16x16x32_bf16 v[228:231], v[68:71], v[28:31], v[228:231]
  ds_read_b64_tr_b16 v[62:63], v90 offset:32512
  s_waitcnt lgkmcnt(8)
  v_mfma_f32_16x16x32_bf16 v[160:163], v[72:75], v[24:27], v[160:163]
  ds_read_b64_tr_b16 v[64:65], v91 offset:0
  v_mfma_f32_16x16x32_bf16 v[164:167], v[72:75], v[28:31], v[164:167]
  ds_read_b64_tr_b16 v[66:67], v91 offset:4608
  v_mfma_f32_16x16x32_bf16 v[232:235], v[76:79], v[24:27], v[232:235]
  ds_read_b64_tr_b16 v[68:69], v91 offset:18432
  v_mfma_f32_16x16x32_bf16 v[236:239], v[76:79], v[28:31], v[236:239]
  ds_read_b64_tr_b16 v[70:71], v91 offset:23040
  s_waitcnt lgkmcnt(8)
  v_mfma_f32_16x16x32_bf16 v[168:171], v[48:51], v[24:27], v[168:171]
  ds_read_b64_tr_b16 v[72:73], v91 offset:9216
  v_mfma_f32_16x16x32_bf16 v[172:175], v[48:51], v[28:31], v[172:175]
  ds_read_b64_tr_b16 v[74:75], v91 offset:13824
  v_mfma_f32_16x16x32_bf16 v[240:243], v[52:55], v[24:27], v[240:243]
  ds_read_b64_tr_b16 v[76:77], v91 offset:27648
  v_mfma_f32_16x16x32_bf16 v[244:247], v[52:55], v[28:31], v[244:247]
  ds_read_b64_tr_b16 v[78:79], v91 offset:32256
  s_waitcnt lgkmcnt(8)
  v_mfma_f32_16x16x32_bf16 v[176:179], v[56:59], v[24:27], v[176:179]
  ds_read_b64_tr_b16 v[48:49], v88 offset:0
  v_mfma_f32_16x16x32_bf16 v[180:183], v[56:59], v[28:31], v[180:183]
  ds_read_b64_tr_b16 v[50:51], v88 offset:4608
  v_mfma_f32_16x16x32_bf16 v[248:251], v[60:63], v[24:27], v[248:251]
  ds_read_b64_tr_b16 v[52:53], v88 offset:18432
  v_mfma_f32_16x16x32_bf16 v[252:255], v[60:63], v[28:31], v[252:255]
  ds_read_b64_tr_b16 v[54:55], v88 offset:23040
  buffer_load_dwordx4 v[24:27], v85, s[12:15], s54 offen offset:1024 sc1
  buffer_load_dwordx4 v[28:31], v86, s[12:15], s54 offen offset:1024 sc1
  v_lshlrev_b32 v85, 3, v2
  v_add_u32 v85, 4096, v85
  s_waitcnt lgkmcnt(8)
  v_mfma_f32_16x16x32_bf16 v[112:115], v[64:67], v[32:35], v[112:115]
  ds_read_b64_tr_b16 v[56:57], v88 offset:9216
  v_mfma_f32_16x16x32_bf16 v[116:119], v[64:67], v[36:39], v[116:119]
  ds_read_b64_tr_b16 v[58:59], v88 offset:13824
  v_mfma_f32_16x16x32_bf16 v[184:187], v[68:71], v[32:35], v[184:187]
  ds_read_b64_tr_b16 v[60:61], v88 offset:27648
  v_mfma_f32_16x16x32_bf16 v[188:191], v[68:71], v[36:39], v[188:191]
  ds_read_b64_tr_b16 v[62:63], v88 offset:32256
  s_waitcnt vmcnt(5)
  s_waitcnt lgkmcnt(8)
  v_mfma_f32_16x16x32_bf16 v[112:115], v[72:75], v[40:43], v[112:115]
  ds_read_b64_tr_b16 v[64:65], v91 offset:32
  v_mfma_f32_16x16x32_bf16 v[116:119], v[72:75], v[44:47], v[116:119]
  ds_read_b64_tr_b16 v[66:67], v91 offset:4640
  v_mfma_f32_16x16x32_bf16 v[184:187], v[76:79], v[40:43], v[184:187]
  ds_read_b64_tr_b16 v[68:69], v91 offset:18464
  v_mfma_f32_16x16x32_bf16 v[188:191], v[76:79], v[44:47], v[188:191]
  ds_read_b64_tr_b16 v[70:71], v91 offset:23072
  s_waitcnt vmcnt(2)
  s_waitcnt lgkmcnt(8)
  v_mfma_f32_16x16x32_bf16 v[112:115], v[48:51], v[16:19], v[112:115]
  ds_read_b64_tr_b16 v[72:73], v91 offset:9248
  v_mfma_f32_16x16x32_bf16 v[116:119], v[48:51], v[20:23], v[116:119]
  ds_read_b64_tr_b16 v[74:75], v91 offset:13856
  v_mfma_f32_16x16x32_bf16 v[184:187], v[52:55], v[16:19], v[184:187]
  ds_read_b64_tr_b16 v[76:77], v91 offset:27680
  v_mfma_f32_16x16x32_bf16 v[188:191], v[52:55], v[20:23], v[188:191]
  ds_read_b64_tr_b16 v[78:79], v91 offset:32288
  s_waitcnt vmcnt(0)
  s_waitcnt lgkmcnt(8)
  v_mfma_f32_16x16x32_bf16 v[112:115], v[56:59], v[24:27], v[112:115]
  ds_read_b64_tr_b16 v[48:49], v88 offset:32
  v_mfma_f32_16x16x32_bf16 v[116:119], v[56:59], v[28:31], v[116:119]
  ds_read_b64_tr_b16 v[50:51], v88 offset:4640
  v_mfma_f32_16x16x32_bf16 v[184:187], v[60:63], v[24:27], v[184:187]
  ds_read_b64_tr_b16 v[52:53], v88 offset:18464
  v_mfma_f32_16x16x32_bf16 v[188:191], v[60:63], v[28:31], v[188:191]
  ds_read_b64_tr_b16 v[54:55], v88 offset:23072
  s_waitcnt lgkmcnt(8)
  v_mfma_f32_16x16x32_bf16 v[120:123], v[64:67], v[32:35], v[120:123]
  ds_read_b64_tr_b16 v[56:57], v88 offset:9248
  v_mfma_f32_16x16x32_bf16 v[124:127], v[64:67], v[36:39], v[124:127]
  ds_read_b64_tr_b16 v[58:59], v88 offset:13856
  v_mfma_f32_16x16x32_bf16 v[192:195], v[68:71], v[32:35], v[192:195]
  ds_read_b64_tr_b16 v[60:61], v88 offset:27680
  v_mfma_f32_16x16x32_bf16 v[196:199], v[68:71], v[36:39], v[196:199]
  ds_read_b64_tr_b16 v[62:63], v88 offset:32288
  v_readfirstlane_b32 s27, v13
  s_cmp_ge_u32 s27, 72
  s_cbranch_scc1 kv_ok
  s_movk_i32 s27, 128
  s_mov_b32 s55, 0
kv_poll:
  buffer_load_dword v13, v14, s[36:39], s27 offen sc0 sc1
  s_waitcnt vmcnt(0)
  v_readfirstlane_b32 s29, v13
  s_cmp_ge_u32 s29, 72
  s_cselect_b32 s29, 1, 0
  s_cmp_lg_u32 s29, 0
  s_cbranch_scc1 kv_poll_done
  s_add_u32 s55, s55, 1
  s_cmp_ge_u32 s55, 200000
  s_cbranch_scc1 kv_poll_done
  s_sleep 4
  s_branch kv_poll
kv_poll_done:
kv_ok:
  s_barrier
  s_cmp_eq_u32 s83, 0
  s_cbranch_scc1 cvs_end
  s_cmp_eq_u32 s46, 0
  s_cbranch_scc0 cvs_h1
  s_add_u32 m0, s44, 17152
  v_add_u32 v4, 4096, v92
  buffer_load_dwordx4 v92, s[40:43], 0 offen offset:0 sc1 lds
  buffer_load_dwordx4 v92, s[40:43], 0 offen offset:1024 sc1 lds
  buffer_load_dwordx4 v92, s[40:43], 0 offen offset:2048 sc1 lds
  buffer_load_dwordx4 v92, s[40:43], 0 offen offset:3072 sc1 lds
  s_add_u32 m0, s44, 21248
  s_nop 0
  buffer_load_dwordx4 v4, s[40:43], 0 offen offset:0 sc1 lds
  buffer_load_dwordx4 v4, s[40:43], 0 offen offset:1024 sc1 lds
  s_mov_b32 exec_hi, 0x7f
  buffer_load_dwordx4 v4, s[40:43], 0 offen offset:2048 sc1 lds
  s_mov_b32 exec_hi, -1
  v_add_u32 v3, -128, v92
  v_add_u32 v4, 896, v92
  s_add_u32 m0, s44, 0
  s_nop 0
  buffer_load_dwordx4 v3, s[4:7], 0 offen lds
  s_add_u32 m0, s44, 1024
  s_nop 0
  buffer_load_dwordx4 v4, s[4:7], 0 offen offset:0 lds
  buffer_load_dwordx4 v4, s[4:7], 0 offen offset:1024 lds
  buffer_load_dwordx4 v4, s[4:7], 0 offen offset:2048 lds
  s_mov_b64 exec, 0x3ff
  buffer_load_dwordx4 v4, s[4:7], 0 offen offset:3072 lds
  s_mov_b64 exec, -1
  s_branch cvs_end
cvs_h1:
  v_add_u32 v3, -126, v92
  v_add_u32 v4, 898, v92
  s_add_u32 m0, s44, 4288
  s_nop 0
  buffer_load_dwordx4 v3, s[4:7], 0 offen lds
  s_add_u32 m0, s44, 5312
  s_nop 0
  buffer_load_dwordx4 v4, s[4:7], 0 offen offset:0 lds
  buffer_load_dwordx4 v4, s[4:7], 0 offen offset:1024 lds
  buffer_load_dwordx4 v4, s[4:7], 0 offen offset:2048 lds
  s_mov_b64 exec, 0x3ff
  buffer_load_dwordx4 v4, s[4:7], 0 offen offset:3072 lds
  s_mov_b64 exec, -1
  v_add_u32 v3, -124, v92
  v_add_u32 v4, 900, v92
  s_add_u32 m0, s44, 8576
  s_nop 0
  buffer_load_dwordx4 v3, s[4:7], 0 offen lds
  s_add_u32 m0, s44, 9600
  s_nop 0
  buffer_load_dwordx4 v4, s[4:7], 0 offen offset:0 lds
  buffer_load_dwordx4 v4, s[4:7], 0 offen offset:1024 lds
  buffer_load_dwordx4 v4, s[4:7], 0 offen offset:2048 lds
  s_mov_b64 exec, 0x3ff
  buffer_load_dwordx4 v4, s[4:7], 0 offen offset:3072 lds
  s_mov_b64 exec, -1
  v_add_u32 v3, -122, v92
  v_add_u32 v4, 902, v92
  s_add_u32 m0, s44, 12864
  s_nop 0
  buffer_load_dwordx4 v3, s[4:7], 0 offen lds
  s_add_u32 m0, s44, 13888
  s_nop 0
  buffer_load_dwordx4 v4, s[4:7], 0 offen offset:0 lds
  buffer_load_dwordx4 v4, s[4:7], 0 offen offset:1024 lds
  buffer_load_dwordx4 v4, s[4:7], 0 offen offset:2048 lds
  s_mov_b64 exec, 0x3ff
  buffer_load_dwordx4 v4, s[4:7], 0 offen offset:3072 lds
  s_mov_b64 exec, -1
  v_mov_b32 v5, 1
  v_mov_b32 v6, 0
  v_cmp_le_u32 vcc, 1, v2
  s_nop 1
  v_cndmask_b32 v5, v5, 2, vcc
  v_cndmask_b32 v6, v6, 1, vcc
  v_cmp_le_u32 vcc, 3, v2
  s_nop 1
  v_cndmask_b32 v5, v5, 3, vcc
  v_cndmask_b32 v6, v6, 3, vcc
  v_sub_u32 v6, v2, v6
  v_mov_b32 v9, 2047
  v_cmp_le_u32 vcc, 6, v2
  s_nop 1
  v_cndmask_b32 v6, v6, v9, vcc
  v_cmp_eq_u32 vcc, 6, v2
  s_nop 1
  v_cndmask_b32 v5, v5, 1, vcc
  v_lshlrev_b32 v7, 1, v6
  buffer_load_ushort v8, v7, s[4:7], 0 offen
  v_mul_u32_u24 v7, 4286, v5
  v_lshl_add_u32 v7, v6, 1, v7
  v_add_u32 v7, 128, v7
  v_add_u32 v7, s44, v7
cvs_end:
  s_waitcnt lgkmcnt(8)
  v_mfma_f32_16x16x32_bf16 v[120:123], v[72:75], v[40:43], v[120:123]
  ds_read_b64_tr_b16 v[64:65], v91 offset:64
  v_mul_f32 v96, s30, v112
  v_mul_f32 v97, s30, v113
  v_mul_f32 v98, s30, v114
  v_mul_f32 v99, s30, v115
  v_mfma_f32_16x16x32_bf16 v[124:127], v[72:75], v[44:47], v[124:127]
  ds_read_b64_tr_b16 v[66:67], v91 offset:4672
  v_exp_f32 v96, v96
  v_exp_f32 v97, v97
  v_exp_f32 v98, v98
  v_exp_f32 v99, v99
  v_mfma_f32_16x16x32_bf16 v[192:195], v[76:79], v[40:43], v[192:195]
  ds_read_b64_tr_b16 v[68:69], v91 offset:18496
  v_mul_f32 v112, v112, v184
  v_mul_f32 v113, v113, v185
  v_mul_f32 v114, v114, v186
  v_mul_f32 v115, v115, v187
  v_mfma_f32_16x16x32_bf16 v[196:199], v[76:79], v[44:47], v[196:199]
  ds_read_b64_tr_b16 v[70:71], v91 offset:23104
  v_add_f32 v96, 1.0, v96
  v_add_f32 v97, 1.0, v97
  v_add_f32 v98, 1.0, v98
  v_add_f32 v99, 1.0, v99
  s_waitcnt lgkmcnt(8)
  v_mfma_f32_16x16x32_bf16 v[120:123], v[48:51], v[16:19], v[120:123]
  ds_read_b64_tr_b16 v[72:73], v91 offset:9280
  v_rcp_f32 v96, v96
  v_rcp_f32 v97, v97
  v_rcp_f32 v98, v98
  v_rcp_f32 v99, v99
  v_mfma_f32_16x16x32_bf16 v[124:127], v[48:51], v[20:23], v[124:127]
  ds_read_b64_tr_b16 v[74:75], v91 offset:13888
  s_nop 0
  v_mul_f32 v112, v112, v96
  v_mul_f32 v113, v113, v97
  v_mul_f32 v114, v114, v98
  v_mfma_f32_16x16x32_bf16 v[192:195], v[52:55], v[16:19], v[192:195]
  ds_read_b64_tr_b16 v[76:77], v91 offset:27712
  v_mul_f32 v115, v115, v99
  v_cvt_pk_bf16_f32 v100, v112, v113
  v_cvt_pk_bf16_f32 v101, v114, v115
  v_mul_f32 v104, s30, v116
  v_mfma_f32_16x16x32_bf16 v[196:199], v[52:55], v[20:23], v[196:199]
  ds_read_b64_tr_b16 v[78:79], v91 offset:32320
  v_mul_f32 v105, s30, v117
  v_mul_f32 v106, s30, v118
  v_mul_f32 v107, s30, v119
  v_exp_f32 v104, v104
  s_waitcnt lgkmcnt(8)
  v_mfma_f32_16x16x32_bf16 v[120:123], v[56:59], v[24:27], v[120:123]
  ds_read_b64_tr_b16 v[48:49], v88 offset:64
  v_exp_f32 v105, v105
  v_exp_f32 v106, v106
  v_exp_f32 v107, v107
  v_mul_f32 v116, v116, v188
  v_mfma_f32_16x16x32_bf16 v[124:127], v[56:59], v[28:31], v[124:127]
  ds_read_b64_tr_b16 v[50:51], v88 offset:4672
  v_mul_f32 v117, v117, v189
  v_mul_f32 v118, v118, v190
  v_mul_f32 v119, v119, v191
  v_add_f32 v104, 1.0, v104
  v_mfma_f32_16x16x32_bf16 v[192:195], v[60:63], v[24:27], v[192:195]
  ds_read_b64_tr_b16 v[52:53], v88 offset:18496
  v_add_f32 v105, 1.0, v105
  v_add_f32 v106, 1.0, v106
  v_add_f32 v107, 1.0, v107
  v_rcp_f32 v104, v104
  v_mfma_f32_16x16x32_bf16 v[196:199], v[60:63], v[28:31], v[196:199]
  ds_read_b64_tr_b16 v[54:55], v88 offset:23104
  v_rcp_f32 v105, v105
  v_rcp_f32 v106, v106
  v_rcp_f32 v107, v107
  s_nop 0
  s_waitcnt lgkmcnt(8)
  v_mfma_f32_16x16x32_bf16 v[128:131], v[64:67], v[32:35], v[128:131]
  ds_read_b64_tr_b16 v[56:57], v88 offset:9280
  v_mul_f32 v116, v116, v104
  v_mul_f32 v117, v117, v105
  v_mul_f32 v118, v118, v106
  v_mul_f32 v119, v119, v107
  v_mfma_f32_16x16x32_bf16 v[132:135], v[64:67], v[36:39], v[132:135]
  ds_read_b64_tr_b16 v[58:59], v88 offset:13888
  v_cvt_pk_bf16_f32 v108, v116, v117
  v_cvt_pk_bf16_f32 v109, v118, v119
  v_mfma_f32_16x16x32_bf16 v[200:203], v[68:71], v[32:35], v[200:203]
  ds_read_b64_tr_b16 v[60:61], v88 offset:27712
  v_mfma_f32_16x16x32_bf16 v[204:207], v[68:71], v[36:39], v[204:207]
  ds_read_b64_tr_b16 v[62:63], v88 offset:32320
  s_waitcnt lgkmcnt(8)
  v_mfma_f32_16x16x32_bf16 v[128:131], v[72:75], v[40:43], v[128:131]
  ds_read_b64_tr_b16 v[64:65], v91 offset:96
  v_mul_f32 v96, s30, v120
  v_mul_f32 v97, s30, v121
  v_mul_f32 v98, s30, v122
  v_mul_f32 v99, s30, v123
  v_mfma_f32_16x16x32_bf16 v[132:135], v[72:75], v[44:47], v[132:135]
  ds_read_b64_tr_b16 v[66:67], v91 offset:4704
  v_exp_f32 v96, v96
  v_exp_f32 v97, v97
  v_exp_f32 v98, v98
  v_exp_f32 v99, v99
  v_mfma_f32_16x16x32_bf16 v[200:203], v[76:79], v[40:43], v[200:203]
  ds_read_b64_tr_b16 v[68:69], v91 offset:18528
  v_mul_f32 v120, v120, v192
  v_mul_f32 v121, v121, v193
  v_mul_f32 v122, v122, v194
  v_mul_f32 v123, v123, v195
  v_mfma_f32_16x16x32_bf16 v[204:207], v[76:79], v[44:47], v[204:207]
  ds_read_b64_tr_b16 v[70:71], v91 offset:23136
  v_add_f32 v96, 1.0, v96
  v_add_f32 v97, 1.0, v97
  v_add_f32 v98, 1.0, v98
  v_add_f32 v99, 1.0, v99
  s_waitcnt lgkmcnt(8)
  v_mfma_f32_16x16x32_bf16 v[128:131], v[48:51], v[16:19], v[128:131]
  ds_read_b64_tr_b16 v[72:73], v91 offset:9312
  v_rcp_f32 v96, v96
  v_rcp_f32 v97, v97
  v_rcp_f32 v98, v98
  v_rcp_f32 v99, v99
  v_mfma_f32_16x16x32_bf16 v[132:135], v[48:51], v[20:23], v[132:135]
  ds_read_b64_tr_b16 v[74:75], v91 offset:13920
  s_nop 0
  v_mul_f32 v120, v120, v96
  v_mul_f32 v121, v121, v97
  v_mul_f32 v122, v122, v98
  v_mfma_f32_16x16x32_bf16 v[200:203], v[52:55], v[16:19], v[200:203]
  ds_read_b64_tr_b16 v[76:77], v91 offset:27744
  v_mul_f32 v123, v123, v99
  v_cvt_pk_bf16_f32 v102, v120, v121
  v_cvt_pk_bf16_f32 v103, v122, v123
  buffer_store_dwordx4 v[100:103], v92, s[16:19], s25 offen offset:0 sc0 sc1
  v_mfma_f32_16x16x32_bf16 v[204:207], v[52:55], v[20:23], v[204:207]
  ds_read_b64_tr_b16 v[78:79], v91 offset:32352
  v_mul_f32 v104, s30, v124
  v_mul_f32 v105, s30, v125
  v_mul_f32 v106, s30, v126
  v_mul_f32 v107, s30, v127
  s_waitcnt lgkmcnt(8)
  v_mfma_f32_16x16x32_bf16 v[128:131], v[56:59], v[24:27], v[128:131]
  ds_read_b64_tr_b16 v[48:49], v88 offset:96
  v_exp_f32 v104, v104
  v_exp_f32 v105, v105
  v_exp_f32 v106, v106
  v_exp_f32 v107, v107
  v_mfma_f32_16x16x32_bf16 v[132:135], v[56:59], v[28:31], v[132:135]
  ds_read_b64_tr_b16 v[50:51], v88 offset:4704
  v_mul_f32 v124, v124, v196
  v_mul_f32 v125, v125, v197
  v_mul_f32 v126, v126, v198
  v_mul_f32 v127, v127, v199
  v_mfma_f32_16x16x32_bf16 v[200:203], v[60:63], v[24:27], v[200:203]
  ds_read_b64_tr_b16 v[52:53], v88 offset:18528
  v_add_f32 v104, 1.0, v104
  v_add_f32 v105, 1.0, v105
  v_add_f32 v106, 1.0, v106
  v_add_f32 v107, 1.0, v107
  v_mfma_f32_16x16x32_bf16 v[204:207], v[60:63], v[28:31], v[204:207]
  ds_read_b64_tr_b16 v[54:55], v88 offset:23136
  v_rcp_f32 v104, v104
  v_rcp_f32 v105, v105
  v_rcp_f32 v106, v106
  v_rcp_f32 v107, v107
  s_waitcnt lgkmcnt(8)
  v_mfma_f32_16x16x32_bf16 v[136:139], v[64:67], v[32:35], v[136:139]
  ds_read_b64_tr_b16 v[56:57], v88 offset:9312
  s_nop 0
  v_mul_f32 v124, v124, v104
  v_mul_f32 v125, v125, v105
  v_mul_f32 v126, v126, v106
  v_mfma_f32_16x16x32_bf16 v[140:143], v[64:67], v[36:39], v[140:143]
  ds_read_b64_tr_b16 v[58:59], v88 offset:13920
  v_mul_f32 v127, v127, v107
  v_cvt_pk_bf16_f32 v110, v124, v125
  v_cvt_pk_bf16_f32 v111, v126, v127
  buffer_store_dwordx4 v[108:111], v92, s[16:19], s26 offen offset:0 sc0 sc1
  v_mfma_f32_16x16x32_bf16 v[208:211], v[68:71], v[32:35], v[208:211]
  ds_read_b64_tr_b16 v[60:61], v88 offset:27744
  v_mfma_f32_16x16x32_bf16 v[212:215], v[68:71], v[36:39], v[212:215]
  ds_read_b64_tr_b16 v[62:63], v88 offset:32352
  s_waitcnt lgkmcnt(8)
  v_mfma_f32_16x16x32_bf16 v[136:139], v[72:75], v[40:43], v[136:139]
  ds_read_b64_tr_b16 v[64:65], v91 offset:128
  v_mul_f32 v96, s30, v128
  v_mul_f32 v97, s30, v129
  v_mul_f32 v98, s30, v130
  v_mul_f32 v99, s30, v131
  v_mfma_f32_16x16x32_bf16 v[140:143], v[72:75], v[44:47], v[140:143]
  ds_read_b64_tr_b16 v[66:67], v91 offset:4736
  v_exp_f32 v96, v96
  v_exp_f32 v97, v97
  v_exp_f32 v98, v98
  v_exp_f32 v99, v99
  v_mfma_f32_16x16x32_bf16 v[208:211], v[76:79], v[40:43], v[208:211]
  ds_read_b64_tr_b16 v[68:69], v91 offset:18560
  v_mul_f32 v128, v128, v200
  v_mul_f32 v129, v129, v201
  v_mul_f32 v130, v130, v202
  v_mul_f32 v131, v131, v203
  v_mfma_f32_16x16x32_bf16 v[212:215], v[76:79], v[44:47], v[212:215]
  ds_read_b64_tr_b16 v[70:71], v91 offset:23168
  v_add_f32 v96, 1.0, v96
  v_add_f32 v97, 1.0, v97
  v_add_f32 v98, 1.0, v98
  v_add_f32 v99, 1.0, v99
  s_waitcnt lgkmcnt(8)
  v_mfma_f32_16x16x32_bf16 v[136:139], v[48:51], v[16:19], v[136:139]
  ds_read_b64_tr_b16 v[72:73], v91 offset:9344
  v_rcp_f32 v96, v96
  v_rcp_f32 v97, v97
  v_rcp_f32 v98, v98
  v_rcp_f32 v99, v99
  v_mfma_f32_16x16x32_bf16 v[140:143], v[48:51], v[20:23], v[140:143]
  ds_read_b64_tr_b16 v[74:75], v91 offset:13952
  s_nop 0
  v_mul_f32 v128, v128, v96
  v_mul_f32 v129, v129, v97
  v_mul_f32 v130, v130, v98
  v_mfma_f32_16x16x32_bf16 v[208:211], v[52:55], v[16:19], v[208:211]
  ds_read_b64_tr_b16 v[76:77], v91 offset:27776
  v_mul_f32 v131, v131, v99
  v_cvt_pk_bf16_f32 v100, v128, v129
  v_cvt_pk_bf16_f32 v101, v130, v131
  v_mul_f32 v104, s30, v132
  v_mfma_f32_16x16x32_bf16 v[212:215], v[52:55], v[20:23], v[212:215]
  ds_read_b64_tr_b16 v[78:79], v91 offset:32384
  v_mul_f32 v105, s30, v133
  v_mul_f32 v106, s30, v134
  v_mul_f32 v107, s30, v135
  v_exp_f32 v104, v104
  s_waitcnt lgkmcnt(8)
  v_mfma_f32_16x16x32_bf16 v[136:139], v[56:59], v[24:27], v[136:139]
  ds_read_b64_tr_b16 v[48:49], v88 offset:128
  v_exp_f32 v105, v105
  v_exp_f32 v106, v106
  v_exp_f32 v107, v107
  v_mul_f32 v132, v132, v204
  v_mfma_f32_16x16x32_bf16 v[140:143], v[56:59], v[28:31], v[140:143]
  ds_read_b64_tr_b16 v[50:51], v88 offset:4736
  v_mul_f32 v133, v133, v205
  v_mul_f32 v134, v134, v206
  v_mul_f32 v135, v135, v207
  v_add_f32 v104, 1.0, v104
  v_mfma_f32_16x16x32_bf16 v[208:211], v[60:63], v[24:27], v[208:211]
  ds_read_b64_tr_b16 v[52:53], v88 offset:18560
  v_add_f32 v105, 1.0, v105
  v_add_f32 v106, 1.0, v106
  v_add_f32 v107, 1.0, v107
  v_rcp_f32 v104, v104
  v_mfma_f32_16x16x32_bf16 v[212:215], v[60:63], v[28:31], v[212:215]
  ds_read_b64_tr_b16 v[54:55], v88 offset:23168
  v_rcp_f32 v105, v105
  v_rcp_f32 v106, v106
  v_rcp_f32 v107, v107
  s_nop 0
  s_waitcnt lgkmcnt(8)
  v_mfma_f32_16x16x32_bf16 v[144:147], v[64:67], v[32:35], v[144:147]
  ds_read_b64_tr_b16 v[56:57], v88 offset:9344
  v_mul_f32 v132, v132, v104
  v_mul_f32 v133, v133, v105
  v_mul_f32 v134, v134, v106
  v_mul_f32 v135, v135, v107
  v_mfma_f32_16x16x32_bf16 v[148:151], v[64:67], v[36:39], v[148:151]
  ds_read_b64_tr_b16 v[58:59], v88 offset:13952
  v_cvt_pk_bf16_f32 v108, v132, v133
  v_cvt_pk_bf16_f32 v109, v134, v135
  v_mfma_f32_16x16x32_bf16 v[216:219], v[68:71], v[32:35], v[216:219]
  ds_read_b64_tr_b16 v[60:61], v88 offset:27776
  v_mfma_f32_16x16x32_bf16 v[220:223], v[68:71], v[36:39], v[220:223]
  ds_read_b64_tr_b16 v[62:63], v88 offset:32384
  s_waitcnt lgkmcnt(8)
  v_mfma_f32_16x16x32_bf16 v[144:147], v[72:75], v[40:43], v[144:147]
  ds_read_b64_tr_b16 v[64:65], v91 offset:160
  v_mul_f32 v96, s30, v136
  v_mul_f32 v97, s30, v137
  v_mul_f32 v98, s30, v138
  v_mul_f32 v99, s30, v139
  v_mfma_f32_16x16x32_bf16 v[148:151], v[72:75], v[44:47], v[148:151]
  ds_read_b64_tr_b16 v[66:67], v91 offset:4768
  v_exp_f32 v96, v96
  v_exp_f32 v97, v97
  v_exp_f32 v98, v98
  v_exp_f32 v99, v99
  v_mfma_f32_16x16x32_bf16 v[216:219], v[76:79], v[40:43], v[216:219]
  ds_read_b64_tr_b16 v[68:69], v91 offset:18592
  v_mul_f32 v136, v136, v208
  v_mul_f32 v137, v137, v209
  v_mul_f32 v138, v138, v210
  v_mul_f32 v139, v139, v211
  v_mfma_f32_16x16x32_bf16 v[220:223], v[76:79], v[44:47], v[220:223]
  ds_read_b64_tr_b16 v[70:71], v91 offset:23200
  v_add_f32 v96, 1.0, v96
  v_add_f32 v97, 1.0, v97
  v_add_f32 v98, 1.0, v98
  v_add_f32 v99, 1.0, v99
  s_waitcnt lgkmcnt(8)
  v_mfma_f32_16x16x32_bf16 v[144:147], v[48:51], v[16:19], v[144:147]
  ds_read_b64_tr_b16 v[72:73], v91 offset:9376
  v_rcp_f32 v96, v96
  v_rcp_f32 v97, v97
  v_rcp_f32 v98, v98
  v_rcp_f32 v99, v99
  v_mfma_f32_16x16x32_bf16 v[148:151], v[48:51], v[20:23], v[148:151]
  ds_read_b64_tr_b16 v[74:75], v91 offset:13984
  s_nop 0
  v_mul_f32 v136, v136, v96
  v_mul_f32 v137, v137, v97
  v_mul_f32 v138, v138, v98
  v_mfma_f32_16x16x32_bf16 v[216:219], v[52:55], v[16:19], v[216:219]
  ds_read_b64_tr_b16 v[76:77], v91 offset:27808
  v_mul_f32 v139, v139, v99
  v_cvt_pk_bf16_f32 v102, v136, v137
  v_cvt_pk_bf16_f32 v103, v138, v139
  buffer_store_dwordx4 v[100:103], v92, s[16:19], s25 offen offset:1024 sc0 sc1
  v_mfma_f32_16x16x32_bf16 v[220:223], v[52:55], v[20:23], v[220:223]
  ds_read_b64_tr_b16 v[78:79], v91 offset:32416
  v_mul_f32 v104, s30, v140
  v_mul_f32 v105, s30, v141
  v_mul_f32 v106, s30, v142
  v_mul_f32 v107, s30, v143
  s_waitcnt lgkmcnt(8)
  v_mfma_f32_16x16x32_bf16 v[144:147], v[56:59], v[24:27], v[144:147]
  ds_read_b64_tr_b16 v[48:49], v88 offset:160
  v_exp_f32 v104, v104
  v_exp_f32 v105, v105
  v_exp_f32 v106, v106
  v_exp_f32 v107, v107
  v_mfma_f32_16x16x32_bf16 v[148:151], v[56:59], v[28:31], v[148:151]
  ds_read_b64_tr_b16 v[50:51], v88 offset:4768
  v_mul_f32 v140, v140, v212
  v_mul_f32 v141, v141, v213
  v_mul_f32 v142, v142, v214
  v_mul_f32 v143, v143, v215
  v_mfma_f32_16x16x32_bf16 v[216:219], v[60:63], v[24:27], v[216:219]
  ds_read_b64_tr_b16 v[52:53], v88 offset:18592
  v_add_f32 v104, 1.0, v104
  v_add_f32 v105, 1.0, v105
  v_add_f32 v106, 1.0, v106
  v_add_f32 v107, 1.0, v107
  v_mfma_f32_16x16x32_bf16 v[220:223], v[60:63], v[28:31], v[220:223]
  ds_read_b64_tr_b16 v[54:55], v88 offset:23200
  v_rcp_f32 v104, v104
  v_rcp_f32 v105, v105
  v_rcp_f32 v106, v106
  v_rcp_f32 v107, v107
  s_waitcnt lgkmcnt(8)
  v_mfma_f32_16x16x32_bf16 v[152:155], v[64:67], v[32:35], v[152:155]
  ds_read_b64_tr_b16 v[56:57], v88 offset:9376
  s_nop 0
  v_mul_f32 v140, v140, v104
  v_mul_f32 v141, v141, v105
  v_mul_f32 v142, v142, v106
  v_mfma_f32_16x16x32_bf16 v[156:159], v[64:67], v[36:39], v[156:159]
  ds_read_b64_tr_b16 v[58:59], v88 offset:13984
  v_mul_f32 v143, v143, v107
  v_cvt_pk_bf16_f32 v110, v140, v141
  v_cvt_pk_bf16_f32 v111, v142, v143
  buffer_store_dwordx4 v[108:111], v92, s[16:19], s26 offen offset:1024 sc0 sc1
  v_mfma_f32_16x16x32_bf16 v[224:227], v[68:71], v[32:35], v[224:227]
  ds_read_b64_tr_b16 v[60:61], v88 offset:27808
  v_mfma_f32_16x16x32_bf16 v[228:231], v[68:71], v[36:39], v[228:231]
  ds_read_b64_tr_b16 v[62:63], v88 offset:32416
  s_waitcnt lgkmcnt(8)
  v_mfma_f32_16x16x32_bf16 v[152:155], v[72:75], v[40:43], v[152:155]
  ds_read_b64_tr_b16 v[64:65], v91 offset:192
  v_mul_f32 v96, s30, v144
  v_mul_f32 v97, s30, v145
  v_mul_f32 v98, s30, v146
  v_mul_f32 v99, s30, v147
  v_mfma_f32_16x16x32_bf16 v[156:159], v[72:75], v[44:47], v[156:159]
  ds_read_b64_tr_b16 v[66:67], v91 offset:4800
  v_exp_f32 v96, v96
  v_exp_f32 v97, v97
  v_exp_f32 v98, v98
  v_exp_f32 v99, v99
  v_mfma_f32_16x16x32_bf16 v[224:227], v[76:79], v[40:43], v[224:227]
  ds_read_b64_tr_b16 v[68:69], v91 offset:18624
  v_mul_f32 v144, v144, v216
  v_mul_f32 v145, v145, v217
  v_mul_f32 v146, v146, v218
  v_mul_f32 v147, v147, v219
  v_mfma_f32_16x16x32_bf16 v[228:231], v[76:79], v[44:47], v[228:231]
  ds_read_b64_tr_b16 v[70:71], v91 offset:23232
  v_add_f32 v96, 1.0, v96
  v_add_f32 v97, 1.0, v97
  v_add_f32 v98, 1.0, v98
  v_add_f32 v99, 1.0, v99
  s_waitcnt lgkmcnt(8)
  v_mfma_f32_16x16x32_bf16 v[152:155], v[48:51], v[16:19], v[152:155]
  ds_read_b64_tr_b16 v[72:73], v91 offset:9408
  v_rcp_f32 v96, v96
  v_rcp_f32 v97, v97
  v_rcp_f32 v98, v98
  v_rcp_f32 v99, v99
  v_mfma_f32_16x16x32_bf16 v[156:159], v[48:51], v[20:23], v[156:159]
  ds_read_b64_tr_b16 v[74:75], v91 offset:14016
  s_nop 0
  v_mul_f32 v144, v144, v96
  v_mul_f32 v145, v145, v97
  v_mul_f32 v146, v146, v98
  v_mfma_f32_16x16x32_bf16 v[224:227], v[52:55], v[16:19], v[224:227]
  ds_read_b64_tr_b16 v[76:77], v91 offset:27840
  v_mul_f32 v147, v147, v99
  v_cvt_pk_bf16_f32 v100, v144, v145
  v_cvt_pk_bf16_f32 v101, v146, v147
  v_mul_f32 v104, s30, v148
  v_mfma_f32_16x16x32_bf16 v[228:231], v[52:55], v[20:23], v[228:231]
  ds_read_b64_tr_b16 v[78:79], v91 offset:32448
  v_mul_f32 v105, s30, v149
  v_mul_f32 v106, s30, v150
  v_mul_f32 v107, s30, v151
  v_exp_f32 v104, v104
  s_waitcnt lgkmcnt(8)
  v_mfma_f32_16x16x32_bf16 v[152:155], v[56:59], v[24:27], v[152:155]
  ds_read_b64_tr_b16 v[48:49], v88 offset:192
  v_exp_f32 v105, v105
  v_exp_f32 v106, v106
  v_exp_f32 v107, v107
  v_mul_f32 v148, v148, v220
  v_mfma_f32_16x16x32_bf16 v[156:159], v[56:59], v[28:31], v[156:159]
  ds_read_b64_tr_b16 v[50:51], v88 offset:4800
  v_mul_f32 v149, v149, v221
  v_mul_f32 v150, v150, v222
  v_mul_f32 v151, v151, v223
  v_add_f32 v104, 1.0, v104
  v_mfma_f32_16x16x32_bf16 v[224:227], v[60:63], v[24:27], v[224:227]
  ds_read_b64_tr_b16 v[52:53], v88 offset:18624
  v_add_f32 v105, 1.0, v105
  v_add_f32 v106, 1.0, v106
  v_add_f32 v107, 1.0, v107
  v_rcp_f32 v104, v104
  v_mfma_f32_16x16x32_bf16 v[228:231], v[60:63], v[28:31], v[228:231]
  ds_read_b64_tr_b16 v[54:55], v88 offset:23232
  v_rcp_f32 v105, v105
  v_rcp_f32 v106, v106
  v_rcp_f32 v107, v107
  s_nop 0
  s_waitcnt lgkmcnt(8)
  v_mfma_f32_16x16x32_bf16 v[160:163], v[64:67], v[32:35], v[160:163]
  ds_read_b64_tr_b16 v[56:57], v88 offset:9408
  v_mul_f32 v148, v148, v104
  v_mul_f32 v149, v149, v105
  v_mul_f32 v150, v150, v106
  v_mul_f32 v151, v151, v107
  v_mfma_f32_16x16x32_bf16 v[164:167], v[64:67], v[36:39], v[164:167]
  ds_read_b64_tr_b16 v[58:59], v88 offset:14016
  v_cvt_pk_bf16_f32 v108, v148, v149
  v_cvt_pk_bf16_f32 v109, v150, v151
  v_mfma_f32_16x16x32_bf16 v[232:235], v[68:71], v[32:35], v[232:235]
  ds_read_b64_tr_b16 v[60:61], v88 offset:27840
  v_mfma_f32_16x16x32_bf16 v[236:239], v[68:71], v[36:39], v[236:239]
  ds_read_b64_tr_b16 v[62:63], v88 offset:32448
  s_waitcnt lgkmcnt(8)
  v_mfma_f32_16x16x32_bf16 v[160:163], v[72:75], v[40:43], v[160:163]
  ds_read_b64_tr_b16 v[64:65], v91 offset:224
  v_mul_f32 v96, s30, v152
  v_mul_f32 v97, s30, v153
  v_mul_f32 v98, s30, v154
  v_mul_f32 v99, s30, v155
  v_mfma_f32_16x16x32_bf16 v[164:167], v[72:75], v[44:47], v[164:167]
  ds_read_b64_tr_b16 v[66:67], v91 offset:4832
  v_exp_f32 v96, v96
  v_exp_f32 v97, v97
  v_exp_f32 v98, v98
  v_exp_f32 v99, v99
  v_mfma_f32_16x16x32_bf16 v[232:235], v[76:79], v[40:43], v[232:235]
  ds_read_b64_tr_b16 v[68:69], v91 offset:18656
  v_mul_f32 v152, v152, v224
  v_mul_f32 v153, v153, v225
  v_mul_f32 v154, v154, v226
  v_mul_f32 v155, v155, v227
  v_mfma_f32_16x16x32_bf16 v[236:239], v[76:79], v[44:47], v[236:239]
  ds_read_b64_tr_b16 v[70:71], v91 offset:23264
  v_add_f32 v96, 1.0, v96
  v_add_f32 v97, 1.0, v97
  v_add_f32 v98, 1.0, v98
  v_add_f32 v99, 1.0, v99
  s_waitcnt lgkmcnt(8)
  v_mfma_f32_16x16x32_bf16 v[160:163], v[48:51], v[16:19], v[160:163]
  ds_read_b64_tr_b16 v[72:73], v91 offset:9440
  v_rcp_f32 v96, v96
  v_rcp_f32 v97, v97
  v_rcp_f32 v98, v98
  v_rcp_f32 v99, v99
  v_mfma_f32_16x16x32_bf16 v[164:167], v[48:51], v[20:23], v[164:167]
  ds_read_b64_tr_b16 v[74:75], v91 offset:14048
  s_nop 0
  v_mul_f32 v152, v152, v96
  v_mul_f32 v153, v153, v97
  v_mul_f32 v154, v154, v98
  v_mfma_f32_16x16x32_bf16 v[232:235], v[52:55], v[16:19], v[232:235]
  ds_read_b64_tr_b16 v[76:77], v91 offset:27872
  v_mul_f32 v155, v155, v99
  v_cvt_pk_bf16_f32 v102, v152, v153
  v_cvt_pk_bf16_f32 v103, v154, v155
  buffer_store_dwordx4 v[100:103], v92, s[16:19], s25 offen offset:2048 sc0 sc1
  v_mfma_f32_16x16x32_bf16 v[236:239], v[52:55], v[20:23], v[236:239]
  ds_read_b64_tr_b16 v[78:79], v91 offset:32480
  v_mul_f32 v104, s30, v156
  v_mul_f32 v105, s30, v157
  v_mul_f32 v106, s30, v158
  v_mul_f32 v107, s30, v159
  s_waitcnt lgkmcnt(8)
  v_mfma_f32_16x16x32_bf16 v[160:163], v[56:59], v[24:27], v[160:163]
  ds_read_b64_tr_b16 v[48:49], v88 offset:224
  v_exp_f32 v104, v104
  v_exp_f32 v105, v105
  v_exp_f32 v106, v106
  v_exp_f32 v107, v107
  v_mfma_f32_16x16x32_bf16 v[164:167], v[56:59], v[28:31], v[164:167]
  ds_read_b64_tr_b16 v[50:51], v88 offset:4832
  v_mul_f32 v156, v156, v228
  v_mul_f32 v157, v157, v229
  v_mul_f32 v158, v158, v230
  v_mul_f32 v159, v159, v231
  v_mfma_f32_16x16x32_bf16 v[232:235], v[60:63], v[24:27], v[232:235]
  ds_read_b64_tr_b16 v[52:53], v88 offset:18656
  v_add_f32 v104, 1.0, v104
  v_add_f32 v105, 1.0, v105
  v_add_f32 v106, 1.0, v106
  v_add_f32 v107, 1.0, v107
  v_mfma_f32_16x16x32_bf16 v[236:239], v[60:63], v[28:31], v[236:239]
  ds_read_b64_tr_b16 v[54:55], v88 offset:23264
  v_rcp_f32 v104, v104
  v_rcp_f32 v105, v105
  v_rcp_f32 v106, v106
  v_rcp_f32 v107, v107
  s_waitcnt lgkmcnt(8)
  v_mfma_f32_16x16x32_bf16 v[168:171], v[64:67], v[32:35], v[168:171]
  ds_read_b64_tr_b16 v[56:57], v88 offset:9440
  s_nop 0
  v_mul_f32 v156, v156, v104
  v_mul_f32 v157, v157, v105
  v_mul_f32 v158, v158, v106
  v_mfma_f32_16x16x32_bf16 v[172:175], v[64:67], v[36:39], v[172:175]
  ds_read_b64_tr_b16 v[58:59], v88 offset:14048
  v_mul_f32 v159, v159, v107
  v_cvt_pk_bf16_f32 v110, v156, v157
  v_cvt_pk_bf16_f32 v111, v158, v159
  buffer_store_dwordx4 v[108:111], v92, s[16:19], s26 offen offset:2048 sc0 sc1
  v_mfma_f32_16x16x32_bf16 v[240:243], v[68:71], v[32:35], v[240:243]
  ds_read_b64_tr_b16 v[60:61], v88 offset:27872
  v_mfma_f32_16x16x32_bf16 v[244:247], v[68:71], v[36:39], v[244:247]
  ds_read_b64_tr_b16 v[62:63], v88 offset:32480
  s_waitcnt lgkmcnt(8)
  v_mfma_f32_16x16x32_bf16 v[168:171], v[72:75], v[40:43], v[168:171]
  ds_read_b64_tr_b16 v[64:65], v91 offset:256
  v_mul_f32 v96, s30, v160
  v_mul_f32 v97, s30, v161
  v_mul_f32 v98, s30, v162
  v_mul_f32 v99, s30, v163
  v_mfma_f32_16x16x32_bf16 v[172:175], v[72:75], v[44:47], v[172:175]
  ds_read_b64_tr_b16 v[66:67], v91 offset:4864
  v_exp_f32 v96, v96
  v_exp_f32 v97, v97
  v_exp_f32 v98, v98
  v_exp_f32 v99, v99
  v_mfma_f32_16x16x32_bf16 v[240:243], v[76:79], v[40:43], v[240:243]
  ds_read_b64_tr_b16 v[68:69], v91 offset:18688
  v_mul_f32 v160, v160, v232
  v_mul_f32 v161, v161, v233
  v_mul_f32 v162, v162, v234
  v_mul_f32 v163, v163, v235
  v_mfma_f32_16x16x32_bf16 v[244:247], v[76:79], v[44:47], v[244:247]
  ds_read_b64_tr_b16 v[70:71], v91 offset:23296
  v_add_f32 v96, 1.0, v96
  v_add_f32 v97, 1.0, v97
  v_add_f32 v98, 1.0, v98
  v_add_f32 v99, 1.0, v99
  s_waitcnt lgkmcnt(8)
  v_mfma_f32_16x16x32_bf16 v[168:171], v[48:51], v[16:19], v[168:171]
  ds_read_b64_tr_b16 v[72:73], v91 offset:9472
  v_rcp_f32 v96, v96
  v_rcp_f32 v97, v97
  v_rcp_f32 v98, v98
  v_rcp_f32 v99, v99
  v_mfma_f32_16x16x32_bf16 v[172:175], v[48:51], v[20:23], v[172:175]
  ds_read_b64_tr_b16 v[74:75], v91 offset:14080
  s_nop 0
  v_mul_f32 v160, v160, v96
  v_mul_f32 v161, v161, v97
  v_mul_f32 v162, v162, v98
  v_mfma_f32_16x16x32_bf16 v[240:243], v[52:55], v[16:19], v[240:243]
  ds_read_b64_tr_b16 v[76:77], v91 offset:27904
  v_mul_f32 v163, v163, v99
  v_cvt_pk_bf16_f32 v100, v160, v161
  v_cvt_pk_bf16_f32 v101, v162, v163
  v_mul_f32 v104, s30, v164
  v_mfma_f32_16x16x32_bf16 v[244:247], v[52:55], v[20:23], v[244:247]
  ds_read_b64_tr_b16 v[78:79], v91 offset:32512
  v_mul_f32 v105, s30, v165
  v_mul_f32 v106, s30, v166
  v_mul_f32 v107, s30, v167
  v_exp_f32 v104, v104
  s_waitcnt lgkmcnt(8)
  v_mfma_f32_16x16x32_bf16 v[168:171], v[56:59], v[24:27], v[168:171]
  ds_read_b64_tr_b16 v[48:49], v88 offset:256
  v_exp_f32 v105, v105
  v_exp_f32 v106, v106
  v_exp_f32 v107, v107
  v_mul_f32 v164, v164, v236
  v_mfma_f32_16x16x32_bf16 v[172:175], v[56:59], v[28:31], v[172:175]
  ds_read_b64_tr_b16 v[50:51], v88 offset:4864
  v_mul_f32 v165, v165, v237
  v_mul_f32 v166, v166, v238
  v_mul_f32 v167, v167, v239
  v_add_f32 v104, 1.0, v104
  v_mfma_f32_16x16x32_bf16 v[240:243], v[60:63], v[24:27], v[240:243]
  ds_read_b64_tr_b16 v[52:53], v88 offset:18688
  v_add_f32 v105, 1.0, v105
  v_add_f32 v106, 1.0, v106
  v_add_f32 v107, 1.0, v107
  v_rcp_f32 v104, v104
  v_mfma_f32_16x16x32_bf16 v[244:247], v[60:63], v[28:31], v[244:247]
  ds_read_b64_tr_b16 v[54:55], v88 offset:23296
  v_rcp_f32 v105, v105
  v_rcp_f32 v106, v106
  v_rcp_f32 v107, v107
  s_nop 0
  s_waitcnt lgkmcnt(8)
  v_mfma_f32_16x16x32_bf16 v[176:179], v[64:67], v[32:35], v[176:179]
  ds_read_b64_tr_b16 v[56:57], v88 offset:9472
  v_mul_f32 v164, v164, v104
  v_mul_f32 v165, v165, v105
  v_mul_f32 v166, v166, v106
  v_mul_f32 v167, v167, v107
  v_mfma_f32_16x16x32_bf16 v[180:183], v[64:67], v[36:39], v[180:183]
  ds_read_b64_tr_b16 v[58:59], v88 offset:14080
  v_cvt_pk_bf16_f32 v108, v164, v165
  v_cvt_pk_bf16_f32 v109, v166, v167
  v_mfma_f32_16x16x32_bf16 v[248:251], v[68:71], v[32:35], v[248:251]
  ds_read_b64_tr_b16 v[60:61], v88 offset:27904
  v_mfma_f32_16x16x32_bf16 v[252:255], v[68:71], v[36:39], v[252:255]
  ds_read_b64_tr_b16 v[62:63], v88 offset:32512
  s_waitcnt lgkmcnt(8)
  v_mfma_f32_16x16x32_bf16 v[176:179], v[72:75], v[40:43], v[176:179]
  v_mul_f32 v96, s30, v168
  v_mul_f32 v97, s30, v169
  v_mul_f32 v98, s30, v170
  v_mul_f32 v99, s30, v171
  v_mfma_f32_16x16x32_bf16 v[180:183], v[72:75], v[44:47], v[180:183]
  v_exp_f32 v96, v96
  v_exp_f32 v97, v97
  v_exp_f32 v98, v98
  v_exp_f32 v99, v99
  v_mfma_f32_16x16x32_bf16 v[248:251], v[76:79], v[40:43], v[248:251]
  v_mul_f32 v168, v168, v240
  v_mul_f32 v169, v169, v241
  v_mul_f32 v170, v170, v242
  v_mul_f32 v171, v171, v243
  v_mfma_f32_16x16x32_bf16 v[252:255], v[76:79], v[44:47], v[252:255]
  v_add_f32 v96, 1.0, v96
  v_add_f32 v97, 1.0, v97
  v_add_f32 v98, 1.0, v98
  v_add_f32 v99, 1.0, v99
  s_waitcnt lgkmcnt(4)
  v_mfma_f32_16x16x32_bf16 v[176:179], v[48:51], v[16:19], v[176:179]
  v_rcp_f32 v96, v96
  v_rcp_f32 v97, v97
  v_rcp_f32 v98, v98
  v_rcp_f32 v99, v99
  v_mfma_f32_16x16x32_bf16 v[180:183], v[48:51], v[20:23], v[180:183]
  s_nop 0
  v_mul_f32 v168, v168, v96
  v_mul_f32 v169, v169, v97
  v_mul_f32 v170, v170, v98
  v_mfma_f32_16x16x32_bf16 v[248:251], v[52:55], v[16:19], v[248:251]
  v_mul_f32 v171, v171, v99
  v_cvt_pk_bf16_f32 v102, v168, v169
  v_cvt_pk_bf16_f32 v103, v170, v171
  buffer_store_dwordx4 v[100:103], v92, s[16:19], s25 offen offset:3072 sc0 sc1
  v_mfma_f32_16x16x32_bf16 v[252:255], v[52:55], v[20:23], v[252:255]
  v_mul_f32 v104, s30, v172
  v_mul_f32 v105, s30, v173
  v_mul_f32 v106, s30, v174
  v_mul_f32 v107, s30, v175
  s_waitcnt lgkmcnt(0)
  v_mfma_f32_16x16x32_bf16 v[176:179], v[56:59], v[24:27], v[176:179]
  v_exp_f32 v104, v104
  v_exp_f32 v105, v105
  v_exp_f32 v106, v106
  v_exp_f32 v107, v107
  v_mfma_f32_16x16x32_bf16 v[180:183], v[56:59], v[28:31], v[180:183]
  v_mul_f32 v172, v172, v244
  v_mul_f32 v173, v173, v245
  v_mul_f32 v174, v174, v246
  v_mul_f32 v175, v175, v247
  v_mfma_f32_16x16x32_bf16 v[248:251], v[60:63], v[24:27], v[248:251]
  v_add_f32 v104, 1.0, v104
  v_add_f32 v105, 1.0, v105
  v_add_f32 v106, 1.0, v106
  v_add_f32 v107, 1.0, v107
  v_mfma_f32_16x16x32_bf16 v[252:255], v[60:63], v[28:31], v[252:255]
  v_rcp_f32 v104, v104
  v_rcp_f32 v105, v105
  v_rcp_f32 v106, v106
  v_rcp_f32 v107, v107
  s_nop 7
  s_nop 0
  v_mul_f32 v172, v172, v104
  v_mul_f32 v173, v173, v105
  v_mul_f32 v174, v174, v106
  v_mul_f32 v175, v175, v107
  v_cvt_pk_bf16_f32 v110, v172, v173
  v_cvt_pk_bf16_f32 v111, v174, v175
  buffer_store_dwordx4 v[108:111], v92, s[16:19], s26 offen offset:3072 sc0 sc1
  v_mul_f32 v96, s30, v176
  v_mul_f32 v97, s30, v177
  v_mul_f32 v98, s30, v178
  v_mul_f32 v99, s30, v179
  v_exp_f32 v96, v96
  v_exp_f32 v97, v97
  v_exp_f32 v98, v98
  v_exp_f32 v99, v99
  v_mul_f32 v176, v176, v248
  v_mul_f32 v177, v177, v249
  v_mul_f32 v178, v178, v250
  v_mul_f32 v179, v179, v251
  v_add_f32 v96, 1.0, v96
  v_add_f32 v97, 1.0, v97
  v_add_f32 v98, 1.0, v98
  v_add_f32 v99, 1.0, v99
  v_rcp_f32 v96, v96
  v_rcp_f32 v97, v97
  v_rcp_f32 v98, v98
  v_rcp_f32 v99, v99
  s_nop 0
  v_mul_f32 v176, v176, v96
  v_mul_f32 v177, v177, v97
  v_mul_f32 v178, v178, v98
  v_mul_f32 v179, v179, v99
  v_cvt_pk_bf16_f32 v100, v176, v177
  v_cvt_pk_bf16_f32 v101, v178, v179
  buffer_store_dwordx2 v[100:101], v85, s[16:19], s25 offen sc0 sc1
  v_mul_f32 v104, s30, v180
  v_mul_f32 v105, s30, v181
  v_mul_f32 v106, s30, v182
  v_mul_f32 v107, s30, v183
  v_exp_f32 v104, v104
  v_exp_f32 v105, v105
  v_exp_f32 v106, v106
  v_exp_f32 v107, v107
  v_mul_f32 v180, v180, v252
  v_mul_f32 v181, v181, v253
  v_mul_f32 v182, v182, v254
  v_mul_f32 v183, v183, v255
  v_add_f32 v104, 1.0, v104
  v_add_f32 v105, 1.0, v105
  v_add_f32 v106, 1.0, v106
  v_add_f32 v107, 1.0, v107
  v_rcp_f32 v104, v104
  v_rcp_f32 v105, v105
  v_rcp_f32 v106, v106
  v_rcp_f32 v107, v107
  s_nop 0
  v_mul_f32 v180, v180, v104
  v_mul_f32 v181, v181, v105
  v_mul_f32 v182, v182, v106
  v_mul_f32 v183, v183, v107
  v_cvt_pk_bf16_f32 v108, v180, v181
  v_cvt_pk_bf16_f32 v109, v182, v183
  buffer_store_dwordx2 v[108:109], v85, s[16:19], s26 offen sc0 sc1
  s_lshr_b32 s40, s22, 2
  s_and_b32 s20, s40, 3
  s_lshr_b32 s40, s40, 2
  s_lshl_b32 s21, s23, 1
  s_add_u32 s21, s21, s40
  s_and_b32 s31, s22, 3
  s_mov_b32 s8, s74
  s_mov_b32 s9, s75
  s_mov_b32 s10, 5308416
  s_mov_b32 s11, 0x00020000
  s_mul_i32 s25, s20, 1327104
  s_mul_i32 s26, s31, 288
  s_add_u32 s82, s25, s26
  s_mul_i32 s24, s3, 288
  s_movk_i32 s26, 3641
  s_movk_i32 s27, 1152
  v_add_u32 v3, 0, v2
  v_add_u32 v3, s24, v3
  v_mul_lo_u32 v4, v3, s26
  v_lshrrev_b32 v4, 16, v4
  v_mul_u32_u24 v5, 18, v4
  v_sub_u32 v5, v3, v5
  v_mul_lo_u32 v4, v4, s27
  v_lshl_add_u32 v4, v5, 4, v4
  v_add_u32 v80, s82, v4
  v_add_u32 v3, 64, v2
  v_add_u32 v3, s24, v3
  v_mul_lo_u32 v4, v3, s26
  v_lshrrev_b32 v4, 16, v4
  v_mul_u32_u24 v5, 18, v4
  v_sub_u32 v5, v3, v5
  v_mul_lo_u32 v4, v4, s27
  v_lshl_add_u32 v4, v5, 4, v4
  v_add_u32 v81, s82, v4
  v_add_u32 v3, 128, v2
  v_add_u32 v3, s24, v3
  v_mul_lo_u32 v4, v3, s26
  v_lshrrev_b32 v4, 16, v4
  v_mul_u32_u24 v5, 18, v4
  v_sub_u32 v5, v3, v5
  v_mul_lo_u32 v4, v4, s27
  v_lshl_add_u32 v4, v5, 4, v4
  v_add_u32 v82, s82, v4
  v_add_u32 v3, 192, v2
  v_add_u32 v3, s24, v3
  v_mul_lo_u32 v4, v3, s26
  v_lshrrev_b32 v4, 16, v4
  v_mul_u32_u24 v5, 18, v4
  v_sub_u32 v5, v3, v5
  v_mul_lo_u32 v4, v4, s27
  v_lshl_add_u32 v4, v5, 4, v4
  v_add_u32 v83, s82, v4
  v_add_u32 v3, 256, v2
  v_add_u32 v3, s24, v3
  v_mul_lo_u32 v4, v3, s26
  v_lshrrev_b32 v4, 16, v4
  v_mul_u32_u24 v5, 18, v4
  v_sub_u32 v5, v3, v5
  v_mul_lo_u32 v4, v4, s27
  v_lshl_add_u32 v4, v5, 4, v4
  v_add_u32 v84, s82, v4
  s_waitcnt vmcnt(0)
  s_barrier
  s_cmp_lg_u32 s3, 0
  s_cbranch_scc1 p2_noarr
  s_lshl_b32 s41, s23, 4
  s_lshr_b32 s42, s22, 3
  s_add_u32 s41, s41, s42
  s_lshl_b32 s41, s41, 8
  v_mov_b32 v3, 1
  v_mov_b32 v4, s41
  s_mov_b64 exec, 1
  buffer_atomic_add v3, v4, s[32:35], 0 offen sc1
  s_mov_b64 exec, -1
p2_noarr:
  s_cmp_eq_u32 s83, 0
  s_cbranch_scc1 cv_b1b
  s_cmp_eq_u32 s46, 0
  s_cbranch_scc1 cv_b1b
  s_mov_b64 exec, 0xff
  ds_write_b16 v7, v8
  s_mov_b64 exec, -1
cv_b1b:
  s_mov_b32 s29, 0
  s_add_u32 m0, s28, 110592
  s_nop 0
  buffer_load_dwordx4 v80, s[8:11], s29 offen lds
  s_mov_b32 s29, 0
  s_add_u32 m0, s28, 111616
  s_nop 0
  buffer_load_dwordx4 v81, s[8:11], s29 offen lds
  s_mov_b32 s29, 0
  s_add_u32 m0, s28, 112640
  s_nop 0
  buffer_load_dwordx4 v82, s[8:11], s29 offen lds
  s_mov_b32 s29, 0
  s_add_u32 m0, s28, 113664
  s_nop 0
  buffer_load_dwordx4 v83, s[8:11], s29 offen lds
  s_mov_b32 s29, 0
  s_add_u32 m0, s28, 114688
  s_mov_b32 exec_hi, 0
  buffer_load_dwordx4 v84, s[8:11], s29 offen lds
  s_mov_b32 exec_hi, -1
  s_mov_b32 s29, 165888
  s_add_u32 m0, s28, 0
  s_nop 0
  buffer_load_dwordx4 v80, s[8:11], s29 offen lds
  s_mov_b32 s29, 165888
  s_add_u32 m0, s28, 1024
  s_nop 0
  buffer_load_dwordx4 v81, s[8:11], s29 offen lds
  s_mov_b32 s29, 165888
  s_add_u32 m0, s28, 2048
  s_nop 0
  buffer_load_dwordx4 v82, s[8:11], s29 offen lds
  s_mov_b32 s29, 165888
  s_add_u32 m0, s28, 3072
  s_nop 0
  buffer_load_dwordx4 v83, s[8:11], s29 offen lds
  s_mov_b32 s29, 165888
  s_add_u32 m0, s28, 4096
  s_mov_b32 exec_hi, 0
  buffer_load_dwordx4 v84, s[8:11], s29 offen lds
  s_mov_b32 exec_hi, -1
  s_mov_b32 s48, s66
  s_mov_b32 s49, s67
  s_mov_b32 s50, 1152
  s_mov_b32 s51, 0x00020000
  s_lshl_b32 s27, s47, 1
  v_mov_b32 v9, s27
  buffer_load_ushort v10, v9, s[48:51], 0 offen
  v_add_u32 v12, s44, v92
  s_waitcnt lgkmcnt(0)
  s_barrier
  s_cmp_eq_u32 s83, 0
  s_cbranch_scc1 cv_b2
  v_lshrrev_b32 v3, 4, v2
  v_and_b32 v4, 15, v2
  v_add_u32 v5, 1, v4
  v_and_b32 v6, 3, v5
  v_lshrrev_b32 v5, 2, v5
  v_add_u32 v5, v5, v3
  v_mul_u32_u24 v6, 4288, v6
  v_lshl_add_u32 v5, v5, 3, v6
  v_add_u32 v5, s44, v5
  v_sub_u32 v6, 15, v4
  v_mul_u32_u24 v6, 144, v6
  v_lshl_add_u32 v6, v3, 4, v6
  v_add_u32 v6, s44, v6
  s_cmp_eq_u32 s46, 0
  s_cbranch_scc0 cv_hb
  ds_read_b64 v[16:17], v5 offset:0
  ds_read_b64 v[18:19], v5 offset:32
  ds_read_b64 v[20:21], v5 offset:64
  ds_read_b64 v[22:23], v5 offset:96
  ds_read_b64 v[24:25], v5 offset:128
  ds_read_b128 v[52:55], v6 offset:17152
  ds_read_b64 v[26:27], v5 offset:160
  ds_read_b64 v[28:29], v5 offset:192
  ds_read_b128 v[56:59], v6 offset:17216
  ds_read_b64 v[30:31], v5 offset:224
  ds_read_b64 v[32:33], v5 offset:256
  ds_read_b128 v[60:63], v6 offset:17296
  ds_read_b64 v[34:35], v5 offset:288
  ds_read_b64 v[36:37], v5 offset:320
  ds_read_b128 v[64:67], v6 offset:17360
  s_waitcnt lgkmcnt(9)
  v_mfma_f32_16x16x32_bf16 v[112:115], v[16:19], v[52:55], 0
  v_mfma_f32_16x16x32_bf16 v[116:119], v[18:21], v[52:55], 0
  v_mfma_f32_16x16x32_bf16 v[120:123], v[20:23], v[52:55], 0
  v_mfma_f32_16x16x32_bf16 v[124:127], v[22:25], v[52:55], 0
  ds_read_b64 v[38:39], v5 offset:352
  ds_read_b64 v[40:41], v5 offset:384
  ds_read_b128 v[68:71], v6 offset:17440
  s_waitcnt lgkmcnt(9)
  v_mfma_f32_16x16x32_bf16 v[112:115], v[20:23], v[56:59], v[112:115]
  v_mfma_f32_16x16x32_bf16 v[116:119], v[22:25], v[56:59], v[116:119]
  v_mfma_f32_16x16x32_bf16 v[120:123], v[24:27], v[56:59], v[120:123]
  v_mfma_f32_16x16x32_bf16 v[124:127], v[26:29], v[56:59], v[124:127]
  ds_read_b64 v[42:43], v5 offset:416
  ds_read_b64 v[44:45], v5 offset:448
  ds_read_b128 v[72:75], v6 offset:17504
  s_waitcnt lgkmcnt(9)
  v_mfma_f32_16x16x32_bf16 v[112:115], v[24:27], v[60:63], v[112:115]
  v_mfma_f32_16x16x32_bf16 v[116:119], v[26:29], v[60:63], v[116:119]
  v_mfma_f32_16x16x32_bf16 v[120:123], v[28:31], v[60:63], v[120:123]
  v_mfma_f32_16x16x32_bf16 v[124:127], v[30:33], v[60:63], v[124:127]
  ds_read_b64 v[46:47], v5 offset:480
  ds_read_b64 v[16:17], v5 offset:512
  ds_read_b64 v[48:49], v5 offset:512
  ds_read_b128 v[52:55], v6 offset:17584
  s_waitcnt lgkmcnt(10)
  v_mfma_f32_16x16x32_bf16 v[112:115], v[28:31], v[64:67], v[112:115]
  v_mfma_f32_16x16x32_bf16 v[116:119], v[30:33], v[64:67], v[116:119]
  v_mfma_f32_16x16x32_bf16 v[120:123], v[32:35], v[64:67], v[120:123]
  v_mfma_f32_16x16x32_bf16 v[124:127], v[34:37], v[64:67], v[124:127]
  ds_read_b64 v[18:19], v5 offset:544
  ds_read_b64 v[20:21], v5 offset:576
  ds_read_b128 v[56:59], v6 offset:17648
  s_waitcnt lgkmcnt(10)
  v_mfma_f32_16x16x32_bf16 v[112:115], v[32:35], v[68:71], v[112:115]
  v_mfma_f32_16x16x32_bf16 v[116:119], v[34:37], v[68:71], v[116:119]
  v_mfma_f32_16x16x32_bf16 v[120:123], v[36:39], v[68:71], v[120:123]
  v_mfma_f32_16x16x32_bf16 v[124:127], v[38:41], v[68:71], v[124:127]
  ds_read_b64 v[22:23], v5 offset:608
  ds_read_b64 v[24:25], v5 offset:640
  ds_read_b128 v[60:63], v6 offset:17728
  s_waitcnt lgkmcnt(10)
  v_mfma_f32_16x16x32_bf16 v[112:115], v[36:39], v[72:75], v[112:115]
  v_mfma_f32_16x16x32_bf16 v[116:119], v[38:41], v[72:75], v[116:119]
  v_mfma_f32_16x16x32_bf16 v[120:123], v[40:43], v[72:75], v[120:123]
  v_mfma_f32_16x16x32_bf16 v[124:127], v[42:45], v[72:75], v[124:127]
  ds_read_b64 v[26:27], v5 offset:672
  ds_read_b64 v[28:29], v5 offset:704
  ds_read_b128 v[64:67], v6 offset:17792
  s_waitcnt lgkmcnt(9)
  v_mfma_f32_16x16x32_bf16 v[112:115], v[40:43], v[52:55], v[112:115]
  v_mfma_f32_16x16x32_bf16 v[116:119], v[42:45], v[52:55], v[116:119]
  v_mfma_f32_16x16x32_bf16 v[120:123], v[44:47], v[52:55], v[120:123]
  v_mfma_f32_16x16x32_bf16 v[124:127], v[46:49], v[52:55], v[124:127]
  ds_read_b64 v[30:31], v5 offset:736
  ds_read_b64 v[32:33], v5 offset:768
  ds_read_b128 v[68:71], v6 offset:17872
  s_waitcnt lgkmcnt(9)
  v_mfma_f32_16x16x32_bf16 v[112:115], v[44:47], v[56:59], v[112:115]
  v_mfma_f32_16x16x32_bf16 v[116:119], v[46:49], v[56:59], v[116:119]
  v_mfma_f32_16x16x32_bf16 v[120:123], v[16:19], v[56:59], v[120:123]
  v_mfma_f32_16x16x32_bf16 v[124:127], v[18:21], v[56:59], v[124:127]
  ds_read_b64 v[34:35], v5 offset:800
  ds_read_b64 v[36:37], v5 offset:832
  ds_read_b128 v[72:75], v6 offset:17936
  s_waitcnt lgkmcnt(9)
  v_mfma_f32_16x16x32_bf16 v[112:115], v[16:19], v[60:63], v[112:115]
  v_mfma_f32_16x16x32_bf16 v[116:119], v[18:21], v[60:63], v[116:119]
  v_mfma_f32_16x16x32_bf16 v[120:123], v[20:23], v[60:63], v[120:123]
  v_mfma_f32_16x16x32_bf16 v[124:127], v[22:25], v[60:63], v[124:127]
  ds_read_b64 v[38:39], v5 offset:864
  ds_read_b64 v[40:41], v5 offset:896
  ds_read_b128 v[52:55], v6 offset:18016
  s_waitcnt lgkmcnt(9)
  v_mfma_f32_16x16x32_bf16 v[112:115], v[20:23], v[64:67], v[112:115]
  v_mfma_f32_16x16x32_bf16 v[116:119], v[22:25], v[64:67], v[116:119]
  v_mfma_f32_16x16x32_bf16 v[120:123], v[24:27], v[64:67], v[120:123]
  v_mfma_f32_16x16x32_bf16 v[124:127], v[26:29], v[64:67], v[124:127]
  ds_read_b64 v[42:43], v5 offset:928
  ds_read_b64 v[44:45], v5 offset:960
  ds_read_b128 v[56:59], v6 offset:18080
  s_waitcnt lgkmcnt(9)
  v_mfma_f32_16x16x32_bf16 v[112:115], v[24:27], v[68:71], v[112:115]
  v_mfma_f32_16x16x32_bf16 v[116:119], v[26:29], v[68:71], v[116:119]
  v_mfma_f32_16x16x32_bf16 v[120:123], v[28:31], v[68:71], v[120:123]
  v_mfma_f32_16x16x32_bf16 v[124:127], v[30:33], v[68:71], v[124:127]
  ds_read_b64 v[46:47], v5 offset:992
  ds_read_b64 v[16:17], v5 offset:1024
  ds_read_b64 v[48:49], v5 offset:1024
  ds_read_b128 v[60:63], v6 offset:18160
  s_waitcnt lgkmcnt(10)
  v_mfma_f32_16x16x32_bf16 v[112:115], v[28:31], v[72:75], v[112:115]
  v_mfma_f32_16x16x32_bf16 v[116:119], v[30:33], v[72:75], v[116:119]
  v_mfma_f32_16x16x32_bf16 v[120:123], v[32:35], v[72:75], v[120:123]
  v_mfma_f32_16x16x32_bf16 v[124:127], v[34:37], v[72:75], v[124:127]
  ds_read_b64 v[18:19], v5 offset:1056
  ds_read_b64 v[20:21], v5 offset:1088
  ds_read_b128 v[64:67], v6 offset:18224
  s_waitcnt lgkmcnt(10)
  v_mfma_f32_16x16x32_bf16 v[112:115], v[32:35], v[52:55], v[112:115]
  v_mfma_f32_16x16x32_bf16 v[116:119], v[34:37], v[52:55], v[116:119]
  v_mfma_f32_16x16x32_bf16 v[120:123], v[36:39], v[52:55], v[120:123]
  v_mfma_f32_16x16x32_bf16 v[124:127], v[38:41], v[52:55], v[124:127]
  ds_read_b64 v[22:23], v5 offset:1120
  ds_read_b64 v[24:25], v5 offset:1152
  ds_read_b128 v[68:71], v6 offset:18304
  s_waitcnt lgkmcnt(10)
  v_mfma_f32_16x16x32_bf16 v[112:115], v[36:39], v[56:59], v[112:115]
  v_mfma_f32_16x16x32_bf16 v[116:119], v[38:41], v[56:59], v[116:119]
  v_mfma_f32_16x16x32_bf16 v[120:123], v[40:43], v[56:59], v[120:123]
  v_mfma_f32_16x16x32_bf16 v[124:127], v[42:45], v[56:59], v[124:127]
  ds_read_b64 v[26:27], v5 offset:1184
  ds_read_b64 v[28:29], v5 offset:1216
  ds_read_b128 v[72:75], v6 offset:18368
  s_waitcnt lgkmcnt(9)
  v_mfma_f32_16x16x32_bf16 v[112:115], v[40:43], v[60:63], v[112:115]
  v_mfma_f32_16x16x32_bf16 v[116:119], v[42:45], v[60:63], v[116:119]
  v_mfma_f32_16x16x32_bf16 v[120:123], v[44:47], v[60:63], v[120:123]
  v_mfma_f32_16x16x32_bf16 v[124:127], v[46:49], v[60:63], v[124:127]
  ds_read_b64 v[30:31], v5 offset:1248
  ds_read_b64 v[32:33], v5 offset:1280
  ds_read_b128 v[52:55], v6 offset:18448
  s_waitcnt lgkmcnt(9)
  v_mfma_f32_16x16x32_bf16 v[112:115], v[44:47], v[64:67], v[112:115]
  v_mfma_f32_16x16x32_bf16 v[116:119], v[46:49], v[64:67], v[116:119]
  v_mfma_f32_16x16x32_bf16 v[120:123], v[16:19], v[64:67], v[120:123]
  v_mfma_f32_16x16x32_bf16 v[124:127], v[18:21], v[64:67], v[124:127]
  ds_read_b64 v[34:35], v5 offset:1312
  ds_read_b64 v[36:37], v5 offset:1344
  ds_read_b128 v[56:59], v6 offset:18512
  s_waitcnt lgkmcnt(9)
  v_mfma_f32_16x16x32_bf16 v[112:115], v[16:19], v[68:71], v[112:115]
  v_mfma_f32_16x16x32_bf16 v[116:119], v[18:21], v[68:71], v[116:119]
  v_mfma_f32_16x16x32_bf16 v[120:123], v[20:23], v[68:71], v[120:123]
  v_mfma_f32_16x16x32_bf16 v[124:127], v[22:25], v[68:71], v[124:127]
  ds_read_b64 v[38:39], v5 offset:1376
  ds_read_b64 v[40:41], v5 offset:1408
  ds_read_b128 v[60:63], v6 offset:18592
  s_waitcnt lgkmcnt(9)
  v_mfma_f32_16x16x32_bf16 v[112:115], v[20:23], v[72:75], v[112:115]
  v_mfma_f32_16x16x32_bf16 v[116:119], v[22:25], v[72:75], v[116:119]
  v_mfma_f32_16x16x32_bf16 v[120:123], v[24:27], v[72:75], v[120:123]
  v_mfma_f32_16x16x32_bf16 v[124:127], v[26:29], v[72:75], v[124:127]
  ds_read_b64 v[42:43], v5 offset:1440
  ds_read_b64 v[44:45], v5 offset:1472
  ds_read_b128 v[64:67], v6 offset:18656
  s_waitcnt lgkmcnt(9)
  v_mfma_f32_16x16x32_bf16 v[112:115], v[24:27], v[52:55], v[112:115]
  v_mfma_f32_16x16x32_bf16 v[116:119], v[26:29], v[52:55], v[116:119]
  v_mfma_f32_16x16x32_bf16 v[120:123], v[28:31], v[52:55], v[120:123]
  v_mfma_f32_16x16x32_bf16 v[124:127], v[30:33], v[52:55], v[124:127]
  ds_read_b64 v[46:47], v5 offset:1504
  ds_read_b64 v[16:17], v5 offset:1536
  ds_read_b64 v[48:49], v5 offset:1536
  ds_read_b128 v[68:71], v6 offset:18736
  s_waitcnt lgkmcnt(10)
  v_mfma_f32_16x16x32_bf16 v[112:115], v[28:31], v[56:59], v[112:115]
  v_mfma_f32_16x16x32_bf16 v[116:119], v[30:33], v[56:59], v[116:119]
  v_mfma_f32_16x16x32_bf16 v[120:123], v[32:35], v[56:59], v[120:123]
  v_mfma_f32_16x16x32_bf16 v[124:127], v[34:37], v[56:59], v[124:127]
  ds_read_b64 v[18:19], v5 offset:1568
  ds_read_b64 v[20:21], v5 offset:1600
  ds_read_b128 v[72:75], v6 offset:18800
  s_waitcnt lgkmcnt(10)
  v_mfma_f32_16x16x32_bf16 v[112:115], v[32:35], v[60:63], v[112:115]
  v_mfma_f32_16x16x32_bf16 v[116:119], v[34:37], v[60:63], v[116:119]
  v_mfma_f32_16x16x32_bf16 v[120:123], v[36:39], v[60:63], v[120:123]
  v_mfma_f32_16x16x32_bf16 v[124:127], v[38:41], v[60:63], v[124:127]
  ds_read_b64 v[22:23], v5 offset:1632
  ds_read_b64 v[24:25], v5 offset:1664
  ds_read_b128 v[52:55], v6 offset:18880
  s_waitcnt lgkmcnt(10)
  v_mfma_f32_16x16x32_bf16 v[112:115], v[36:39], v[64:67], v[112:115]
  v_mfma_f32_16x16x32_bf16 v[116:119], v[38:41], v[64:67], v[116:119]
  v_mfma_f32_16x16x32_bf16 v[120:123], v[40:43], v[64:67], v[120:123]
  v_mfma_f32_16x16x32_bf16 v[124:127], v[42:45], v[64:67], v[124:127]
  ds_read_b64 v[26:27], v5 offset:1696
  ds_read_b64 v[28:29], v5 offset:1728
  ds_read_b128 v[56:59], v6 offset:18944
  s_waitcnt lgkmcnt(9)
  v_mfma_f32_16x16x32_bf16 v[112:115], v[40:43], v[68:71], v[112:115]
  v_mfma_f32_16x16x32_bf16 v[116:119], v[42:45], v[68:71], v[116:119]
  v_mfma_f32_16x16x32_bf16 v[120:123], v[44:47], v[68:71], v[120:123]
  v_mfma_f32_16x16x32_bf16 v[124:127], v[46:49], v[68:71], v[124:127]
  ds_read_b64 v[30:31], v5 offset:1760
  ds_read_b64 v[32:33], v5 offset:1792
  ds_read_b128 v[60:63], v6 offset:19024
  s_waitcnt lgkmcnt(9)
  v_mfma_f32_16x16x32_bf16 v[112:115], v[44:47], v[72:75], v[112:115]
  v_mfma_f32_16x16x32_bf16 v[116:119], v[46:49], v[72:75], v[116:119]
  v_mfma_f32_16x16x32_bf16 v[120:123], v[16:19], v[72:75], v[120:123]
  v_mfma_f32_16x16x32_bf16 v[124:127], v[18:21], v[72:75], v[124:127]
  ds_read_b64 v[34:35], v5 offset:1824
  ds_read_b64 v[36:37], v5 offset:1856
  ds_read_b128 v[64:67], v6 offset:19088
  s_waitcnt lgkmcnt(9)
  v_mfma_f32_16x16x32_bf16 v[112:115], v[16:19], v[52:55], v[112:115]
  v_mfma_f32_16x16x32_bf16 v[116:119], v[18:21], v[52:55], v[116:119]
  v_mfma_f32_16x16x32_bf16 v[120:123], v[20:23], v[52:55], v[120:123]
  v_mfma_f32_16x16x32_bf16 v[124:127], v[22:25], v[52:55], v[124:127]
  ds_read_b64 v[38:39], v5 offset:1888
  ds_read_b64 v[40:41], v5 offset:1920
  ds_read_b128 v[68:71], v6 offset:19168
  s_waitcnt lgkmcnt(9)
  v_mfma_f32_16x16x32_bf16 v[112:115], v[20:23], v[56:59], v[112:115]
  v_mfma_f32_16x16x32_bf16 v[116:119], v[22:25], v[56:59], v[116:119]
  v_mfma_f32_16x16x32_bf16 v[120:123], v[24:27], v[56:59], v[120:123]
  v_mfma_f32_16x16x32_bf16 v[124:127], v[26:29], v[56:59], v[124:127]
  ds_read_b64 v[42:43], v5 offset:1952
  ds_read_b64 v[44:45], v5 offset:1984
  ds_read_b128 v[72:75], v6 offset:19232
  s_waitcnt lgkmcnt(9)
  v_mfma_f32_16x16x32_bf16 v[112:115], v[24:27], v[60:63], v[112:115]
  v_mfma_f32_16x16x32_bf16 v[116:119], v[26:29], v[60:63], v[116:119]
  v_mfma_f32_16x16x32_bf16 v[120:123], v[28:31], v[60:63], v[120:123]
  v_mfma_f32_16x16x32_bf16 v[124:127], v[30:33], v[60:63], v[124:127]
  ds_read_b64 v[46:47], v5 offset:2016
  ds_read_b64 v[16:17], v5 offset:2048
  ds_read_b64 v[48:49], v5 offset:2048
  ds_read_b128 v[52:55], v6 offset:19312
  s_waitcnt lgkmcnt(10)
  v_mfma_f32_16x16x32_bf16 v[112:115], v[28:31], v[64:67], v[112:115]
  v_mfma_f32_16x16x32_bf16 v[116:119], v[30:33], v[64:67], v[116:119]
  v_mfma_f32_16x16x32_bf16 v[120:123], v[32:35], v[64:67], v[120:123]
  v_mfma_f32_16x16x32_bf16 v[124:127], v[34:37], v[64:67], v[124:127]
  ds_read_b64 v[18:19], v5 offset:2080
  ds_read_b64 v[20:21], v5 offset:2112
  ds_read_b128 v[56:59], v6 offset:19376
  s_waitcnt lgkmcnt(10)
  v_mfma_f32_16x16x32_bf16 v[112:115], v[32:35], v[68:71], v[112:115]
  v_mfma_f32_16x16x32_bf16 v[116:119], v[34:37], v[68:71], v[116:119]
  v_mfma_f32_16x16x32_bf16 v[120:123], v[36:39], v[68:71], v[120:123]
  v_mfma_f32_16x16x32_bf16 v[124:127], v[38:41], v[68:71], v[124:127]
  ds_read_b64 v[22:23], v5 offset:2144
  ds_read_b64 v[24:25], v5 offset:2176
  ds_read_b128 v[60:63], v6 offset:19456
  s_waitcnt lgkmcnt(10)
  v_mfma_f32_16x16x32_bf16 v[112:115], v[36:39], v[72:75], v[112:115]
  v_mfma_f32_16x16x32_bf16 v[116:119], v[38:41], v[72:75], v[116:119]
  v_mfma_f32_16x16x32_bf16 v[120:123], v[40:43], v[72:75], v[120:123]
  v_mfma_f32_16x16x32_bf16 v[124:127], v[42:45], v[72:75], v[124:127]
  ds_read_b64 v[26:27], v5 offset:2208
  ds_read_b64 v[28:29], v5 offset:2240
  ds_read_b128 v[64:67], v6 offset:19520
  s_waitcnt lgkmcnt(9)
  v_mfma_f32_16x16x32_bf16 v[112:115], v[40:43], v[52:55], v[112:115]
  v_mfma_f32_16x16x32_bf16 v[116:119], v[42:45], v[52:55], v[116:119]
  v_mfma_f32_16x16x32_bf16 v[120:123], v[44:47], v[52:55], v[120:123]
  v_mfma_f32_16x16x32_bf16 v[124:127], v[46:49], v[52:55], v[124:127]
  ds_read_b64 v[30:31], v5 offset:2272
  ds_read_b64 v[32:33], v5 offset:2304
  ds_read_b128 v[68:71], v6 offset:19600
  s_waitcnt lgkmcnt(9)
  v_mfma_f32_16x16x32_bf16 v[112:115], v[44:47], v[56:59], v[112:115]
  v_mfma_f32_16x16x32_bf16 v[116:119], v[46:49], v[56:59], v[116:119]
  v_mfma_f32_16x16x32_bf16 v[120:123], v[16:19], v[56:59], v[120:123]
  v_mfma_f32_16x16x32_bf16 v[124:127], v[18:21], v[56:59], v[124:127]
  ds_read_b64 v[34:35], v5 offset:2336
  ds_read_b64 v[36:37], v5 offset:2368
  ds_read_b128 v[72:75], v6 offset:19664
  s_waitcnt lgkmcnt(9)
  v_mfma_f32_16x16x32_bf16 v[112:115], v[16:19], v[60:63], v[112:115]
  v_mfma_f32_16x16x32_bf16 v[116:119], v[18:21], v[60:63], v[116:119]
  v_mfma_f32_16x16x32_bf16 v[120:123], v[20:23], v[60:63], v[120:123]
  v_mfma_f32_16x16x32_bf16 v[124:127], v[22:25], v[60:63], v[124:127]
  ds_read_b64 v[38:39], v5 offset:2400
  ds_read_b64 v[40:41], v5 offset:2432
  ds_read_b128 v[52:55], v6 offset:19744
  s_waitcnt lgkmcnt(9)
  v_mfma_f32_16x16x32_bf16 v[112:115], v[20:23], v[64:67], v[112:115]
  v_mfma_f32_16x16x32_bf16 v[116:119], v[22:25], v[64:67], v[116:119]
  v_mfma_f32_16x16x32_bf16 v[120:123], v[24:27], v[64:67], v[120:123]
  v_mfma_f32_16x16x32_bf16 v[124:127], v[26:29], v[64:67], v[124:127]
  ds_read_b64 v[42:43], v5 offset:2464
  ds_read_b64 v[44:45], v5 offset:2496
  ds_read_b128 v[56:59], v6 offset:19808
  s_waitcnt lgkmcnt(9)
  v_mfma_f32_16x16x32_bf16 v[112:115], v[24:27], v[68:71], v[112:115]
  v_mfma_f32_16x16x32_bf16 v[116:119], v[26:29], v[68:71], v[116:119]
  v_mfma_f32_16x16x32_bf16 v[120:123], v[28:31], v[68:71], v[120:123]
  v_mfma_f32_16x16x32_bf16 v[124:127], v[30:33], v[68:71], v[124:127]
  ds_read_b64 v[46:47], v5 offset:2528
  ds_read_b64 v[16:17], v5 offset:2560
  ds_read_b64 v[48:49], v5 offset:2560
  ds_read_b128 v[60:63], v6 offset:19888
  s_waitcnt lgkmcnt(10)
  v_mfma_f32_16x16x32_bf16 v[112:115], v[28:31], v[72:75], v[112:115]
  v_mfma_f32_16x16x32_bf16 v[116:119], v[30:33], v[72:75], v[116:119]
  v_mfma_f32_16x16x32_bf16 v[120:123], v[32:35], v[72:75], v[120:123]
  v_mfma_f32_16x16x32_bf16 v[124:127], v[34:37], v[72:75], v[124:127]
  ds_read_b64 v[18:19], v5 offset:2592
  ds_read_b64 v[20:21], v5 offset:2624
  ds_read_b128 v[64:67], v6 offset:19952
  s_waitcnt lgkmcnt(10)
  v_mfma_f32_16x16x32_bf16 v[112:115], v[32:35], v[52:55], v[112:115]
  v_mfma_f32_16x16x32_bf16 v[116:119], v[34:37], v[52:55], v[116:119]
  v_mfma_f32_16x16x32_bf16 v[120:123], v[36:39], v[52:55], v[120:123]
  v_mfma_f32_16x16x32_bf16 v[124:127], v[38:41], v[52:55], v[124:127]
  ds_read_b64 v[22:23], v5 offset:2656
  ds_read_b64 v[24:25], v5 offset:2688
  ds_read_b128 v[68:71], v6 offset:20032
  s_waitcnt lgkmcnt(10)
  v_mfma_f32_16x16x32_bf16 v[112:115], v[36:39], v[56:59], v[112:115]
  v_mfma_f32_16x16x32_bf16 v[116:119], v[38:41], v[56:59], v[116:119]
  v_mfma_f32_16x16x32_bf16 v[120:123], v[40:43], v[56:59], v[120:123]
  v_mfma_f32_16x16x32_bf16 v[124:127], v[42:45], v[56:59], v[124:127]
  ds_read_b64 v[26:27], v5 offset:2720
  ds_read_b64 v[28:29], v5 offset:2752
  ds_read_b128 v[72:75], v6 offset:20096
  s_waitcnt lgkmcnt(9)
  v_mfma_f32_16x16x32_bf16 v[112:115], v[40:43], v[60:63], v[112:115]
  v_mfma_f32_16x16x32_bf16 v[116:119], v[42:45], v[60:63], v[116:119]
  v_mfma_f32_16x16x32_bf16 v[120:123], v[44:47], v[60:63], v[120:123]
  v_mfma_f32_16x16x32_bf16 v[124:127], v[46:49], v[60:63], v[124:127]
  ds_read_b64 v[30:31], v5 offset:2784
  ds_read_b64 v[32:33], v5 offset:2816
  ds_read_b128 v[52:55], v6 offset:20176
  s_waitcnt lgkmcnt(9)
  v_mfma_f32_16x16x32_bf16 v[112:115], v[44:47], v[64:67], v[112:115]
  v_mfma_f32_16x16x32_bf16 v[116:119], v[46:49], v[64:67], v[116:119]
  v_mfma_f32_16x16x32_bf16 v[120:123], v[16:19], v[64:67], v[120:123]
  v_mfma_f32_16x16x32_bf16 v[124:127], v[18:21], v[64:67], v[124:127]
  ds_read_b64 v[34:35], v5 offset:2848
  ds_read_b64 v[36:37], v5 offset:2880
  ds_read_b128 v[56:59], v6 offset:20240
  s_waitcnt lgkmcnt(9)
  v_mfma_f32_16x16x32_bf16 v[112:115], v[16:19], v[68:71], v[112:115]
  v_mfma_f32_16x16x32_bf16 v[116:119], v[18:21], v[68:71], v[116:119]
  v_mfma_f32_16x16x32_bf16 v[120:123], v[20:23], v[68:71], v[120:123]
  v_mfma_f32_16x16x32_bf16 v[124:127], v[22:25], v[68:71], v[124:127]
  ds_read_b64 v[38:39], v5 offset:2912
  ds_read_b64 v[40:41], v5 offset:2944
  ds_read_b128 v[60:63], v6 offset:20320
  s_waitcnt lgkmcnt(9)
  v_mfma_f32_16x16x32_bf16 v[112:115], v[20:23], v[72:75], v[112:115]
  v_mfma_f32_16x16x32_bf16 v[116:119], v[22:25], v[72:75], v[116:119]
  v_mfma_f32_16x16x32_bf16 v[120:123], v[24:27], v[72:75], v[120:123]
  v_mfma_f32_16x16x32_bf16 v[124:127], v[26:29], v[72:75], v[124:127]
  ds_read_b64 v[42:43], v5 offset:2976
  ds_read_b64 v[44:45], v5 offset:3008
  ds_read_b128 v[64:67], v6 offset:20384
  s_waitcnt lgkmcnt(9)
  v_mfma_f32_16x16x32_bf16 v[112:115], v[24:27], v[52:55], v[112:115]
  v_mfma_f32_16x16x32_bf16 v[116:119], v[26:29], v[52:55], v[116:119]
  v_mfma_f32_16x16x32_bf16 v[120:123], v[28:31], v[52:55], v[120:123]
  v_mfma_f32_16x16x32_bf16 v[124:127], v[30:33], v[52:55], v[124:127]
  ds_read_b64 v[46:47], v5 offset:3040
  ds_read_b64 v[16:17], v5 offset:3072
  ds_read_b64 v[48:49], v5 offset:3072
  ds_read_b128 v[68:71], v6 offset:20464
  s_waitcnt lgkmcnt(10)
  v_mfma_f32_16x16x32_bf16 v[112:115], v[28:31], v[56:59], v[112:115]
  v_mfma_f32_16x16x32_bf16 v[116:119], v[30:33], v[56:59], v[116:119]
  v_mfma_f32_16x16x32_bf16 v[120:123], v[32:35], v[56:59], v[120:123]
  v_mfma_f32_16x16x32_bf16 v[124:127], v[34:37], v[56:59], v[124:127]
  ds_read_b64 v[18:19], v5 offset:3104
  ds_read_b64 v[20:21], v5 offset:3136
  ds_read_b128 v[72:75], v6 offset:20528
  s_waitcnt lgkmcnt(10)
  v_mfma_f32_16x16x32_bf16 v[112:115], v[32:35], v[60:63], v[112:115]
  v_mfma_f32_16x16x32_bf16 v[116:119], v[34:37], v[60:63], v[116:119]
  v_mfma_f32_16x16x32_bf16 v[120:123], v[36:39], v[60:63], v[120:123]
  v_mfma_f32_16x16x32_bf16 v[124:127], v[38:41], v[60:63], v[124:127]
  ds_read_b64 v[22:23], v5 offset:3168
  ds_read_b64 v[24:25], v5 offset:3200
  ds_read_b128 v[52:55], v6 offset:20608
  s_waitcnt lgkmcnt(10)
  v_mfma_f32_16x16x32_bf16 v[112:115], v[36:39], v[64:67], v[112:115]
  v_mfma_f32_16x16x32_bf16 v[116:119], v[38:41], v[64:67], v[116:119]
  v_mfma_f32_16x16x32_bf16 v[120:123], v[40:43], v[64:67], v[120:123]
  v_mfma_f32_16x16x32_bf16 v[124:127], v[42:45], v[64:67], v[124:127]
  ds_read_b64 v[26:27], v5 offset:3232
  ds_read_b64 v[28:29], v5 offset:3264
  ds_read_b128 v[56:59], v6 offset:20672
  s_waitcnt lgkmcnt(9)
  v_mfma_f32_16x16x32_bf16 v[112:115], v[40:43], v[68:71], v[112:115]
  v_mfma_f32_16x16x32_bf16 v[116:119], v[42:45], v[68:71], v[116:119]
  v_mfma_f32_16x16x32_bf16 v[120:123], v[44:47], v[68:71], v[120:123]
  v_mfma_f32_16x16x32_bf16 v[124:127], v[46:49], v[68:71], v[124:127]
  ds_read_b64 v[30:31], v5 offset:3296
  ds_read_b64 v[32:33], v5 offset:3328
  ds_read_b128 v[60:63], v6 offset:20752
  s_waitcnt lgkmcnt(9)
  v_mfma_f32_16x16x32_bf16 v[112:115], v[44:47], v[72:75], v[112:115]
  v_mfma_f32_16x16x32_bf16 v[116:119], v[46:49], v[72:75], v[116:119]
  v_mfma_f32_16x16x32_bf16 v[120:123], v[16:19], v[72:75], v[120:123]
  v_mfma_f32_16x16x32_bf16 v[124:127], v[18:21], v[72:75], v[124:127]
  ds_read_b64 v[34:35], v5 offset:3360
  ds_read_b64 v[36:37], v5 offset:3392
  ds_read_b128 v[64:67], v6 offset:20816
  s_waitcnt lgkmcnt(9)
  v_mfma_f32_16x16x32_bf16 v[112:115], v[16:19], v[52:55], v[112:115]
  v_mfma_f32_16x16x32_bf16 v[116:119], v[18:21], v[52:55], v[116:119]
  v_mfma_f32_16x16x32_bf16 v[120:123], v[20:23], v[52:55], v[120:123]
  v_mfma_f32_16x16x32_bf16 v[124:127], v[22:25], v[52:55], v[124:127]
  ds_read_b64 v[38:39], v5 offset:3424
  ds_read_b64 v[40:41], v5 offset:3456
  ds_read_b128 v[68:71], v6 offset:20896
  s_waitcnt lgkmcnt(9)
  v_mfma_f32_16x16x32_bf16 v[112:115], v[20:23], v[56:59], v[112:115]
  v_mfma_f32_16x16x32_bf16 v[116:119], v[22:25], v[56:59], v[116:119]
  v_mfma_f32_16x16x32_bf16 v[120:123], v[24:27], v[56:59], v[120:123]
  v_mfma_f32_16x16x32_bf16 v[124:127], v[26:29], v[56:59], v[124:127]
  ds_read_b64 v[42:43], v5 offset:3488
  ds_read_b64 v[44:45], v5 offset:3520
  ds_read_b128 v[72:75], v6 offset:20960
  s_waitcnt lgkmcnt(9)
  v_mfma_f32_16x16x32_bf16 v[112:115], v[24:27], v[60:63], v[112:115]
  v_mfma_f32_16x16x32_bf16 v[116:119], v[26:29], v[60:63], v[116:119]
  v_mfma_f32_16x16x32_bf16 v[120:123], v[28:31], v[60:63], v[120:123]
  v_mfma_f32_16x16x32_bf16 v[124:127], v[30:33], v[60:63], v[124:127]
  ds_read_b64 v[46:47], v5 offset:3552
  ds_read_b64 v[16:17], v5 offset:3584
  ds_read_b64 v[48:49], v5 offset:3584
  ds_read_b128 v[52:55], v6 offset:21040
  s_waitcnt lgkmcnt(10)
  v_mfma_f32_16x16x32_bf16 v[112:115], v[28:31], v[64:67], v[112:115]
  v_mfma_f32_16x16x32_bf16 v[116:119], v[30:33], v[64:67], v[116:119]
  v_mfma_f32_16x16x32_bf16 v[120:123], v[32:35], v[64:67], v[120:123]
  v_mfma_f32_16x16x32_bf16 v[124:127], v[34:37], v[64:67], v[124:127]
  ds_read_b64 v[18:19], v5 offset:3616
  ds_read_b64 v[20:21], v5 offset:3648
  ds_read_b128 v[56:59], v6 offset:21104
  s_waitcnt lgkmcnt(10)
  v_mfma_f32_16x16x32_bf16 v[112:115], v[32:35], v[68:71], v[112:115]
  v_mfma_f32_16x16x32_bf16 v[116:119], v[34:37], v[68:71], v[116:119]
  v_mfma_f32_16x16x32_bf16 v[120:123], v[36:39], v[68:71], v[120:123]
  v_mfma_f32_16x16x32_bf16 v[124:127], v[38:41], v[68:71], v[124:127]
  ds_read_b64 v[22:23], v5 offset:3680
  ds_read_b64 v[24:25], v5 offset:3712
  ds_read_b128 v[60:63], v6 offset:21184
  s_waitcnt lgkmcnt(10)
  v_mfma_f32_16x16x32_bf16 v[112:115], v[36:39], v[72:75], v[112:115]
  v_mfma_f32_16x16x32_bf16 v[116:119], v[38:41], v[72:75], v[116:119]
  v_mfma_f32_16x16x32_bf16 v[120:123], v[40:43], v[72:75], v[120:123]
  v_mfma_f32_16x16x32_bf16 v[124:127], v[42:45], v[72:75], v[124:127]
  ds_read_b64 v[26:27], v5 offset:3744
  ds_read_b64 v[28:29], v5 offset:3776
  ds_read_b128 v[64:67], v6 offset:21248
  s_waitcnt lgkmcnt(9)
  v_mfma_f32_16x16x32_bf16 v[112:115], v[40:43], v[52:55], v[112:115]
  v_mfma_f32_16x16x32_bf16 v[116:119], v[42:45], v[52:55], v[116:119]
  v_mfma_f32_16x16x32_bf16 v[120:123], v[44:47], v[52:55], v[120:123]
  v_mfma_f32_16x16x32_bf16 v[124:127], v[46:49], v[52:55], v[124:127]
  ds_read_b64 v[30:31], v5 offset:3808
  ds_read_b64 v[32:33], v5 offset:3840
  ds_read_b128 v[68:71], v6 offset:21328
  s_waitcnt lgkmcnt(9)
  v_mfma_f32_16x16x32_bf16 v[112:115], v[44:47], v[56:59], v[112:115]
  v_mfma_f32_16x16x32_bf16 v[116:119], v[46:49], v[56:59], v[116:119]
  v_mfma_f32_16x16x32_bf16 v[120:123], v[16:19], v[56:59], v[120:123]
  v_mfma_f32_16x16x32_bf16 v[124:127], v[18:21], v[56:59], v[124:127]
  ds_read_b64 v[34:35], v5 offset:3872
  ds_read_b64 v[36:37], v5 offset:3904
  ds_read_b128 v[72:75], v6 offset:21392
  s_waitcnt lgkmcnt(9)
  v_mfma_f32_16x16x32_bf16 v[112:115], v[16:19], v[60:63], v[112:115]
  v_mfma_f32_16x16x32_bf16 v[116:119], v[18:21], v[60:63], v[116:119]
  v_mfma_f32_16x16x32_bf16 v[120:123], v[20:23], v[60:63], v[120:123]
  v_mfma_f32_16x16x32_bf16 v[124:127], v[22:25], v[60:63], v[124:127]
  ds_read_b64 v[38:39], v5 offset:3936
  ds_read_b64 v[40:41], v5 offset:3968
  ds_read_b128 v[52:55], v6 offset:21472
  s_waitcnt lgkmcnt(9)
  v_mfma_f32_16x16x32_bf16 v[112:115], v[20:23], v[64:67], v[112:115]
  v_mfma_f32_16x16x32_bf16 v[116:119], v[22:25], v[64:67], v[116:119]
  v_mfma_f32_16x16x32_bf16 v[120:123], v[24:27], v[64:67], v[120:123]
  v_mfma_f32_16x16x32_bf16 v[124:127], v[26:29], v[64:67], v[124:127]
  ds_read_b64 v[42:43], v5 offset:4000
  ds_read_b64 v[44:45], v5 offset:4032
  ds_read_b128 v[56:59], v6 offset:21536
  s_waitcnt lgkmcnt(9)
  v_mfma_f32_16x16x32_bf16 v[112:115], v[24:27], v[68:71], v[112:115]
  v_mfma_f32_16x16x32_bf16 v[116:119], v[26:29], v[68:71], v[116:119]
  v_mfma_f32_16x16x32_bf16 v[120:123], v[28:31], v[68:71], v[120:123]
  v_mfma_f32_16x16x32_bf16 v[124:127], v[30:33], v[68:71], v[124:127]
  ds_read_b64 v[46:47], v5 offset:4064
  ds_read_b64 v[16:17], v5 offset:4096
  ds_read_b64 v[48:49], v5 offset:4096
  ds_read_b128 v[60:63], v6 offset:21616
  s_waitcnt lgkmcnt(10)
  v_mfma_f32_16x16x32_bf16 v[112:115], v[28:31], v[72:75], v[112:115]
  v_mfma_f32_16x16x32_bf16 v[116:119], v[30:33], v[72:75], v[116:119]
  v_mfma_f32_16x16x32_bf16 v[120:123], v[32:35], v[72:75], v[120:123]
  v_mfma_f32_16x16x32_bf16 v[124:127], v[34:37], v[72:75], v[124:127]
  ds_read_b64 v[18:19], v5 offset:4128
  ds_read_b64 v[20:21], v5 offset:4160
  ds_read_b128 v[64:67], v6 offset:21680
  s_waitcnt lgkmcnt(10)
  v_mfma_f32_16x16x32_bf16 v[112:115], v[32:35], v[52:55], v[112:115]
  v_mfma_f32_16x16x32_bf16 v[116:119], v[34:37], v[52:55], v[116:119]
  v_mfma_f32_16x16x32_bf16 v[120:123], v[36:39], v[52:55], v[120:123]
  v_mfma_f32_16x16x32_bf16 v[124:127], v[38:41], v[52:55], v[124:127]
  s_waitcnt lgkmcnt(7)
  v_mfma_f32_16x16x32_bf16 v[112:115], v[36:39], v[56:59], v[112:115]
  v_mfma_f32_16x16x32_bf16 v[116:119], v[38:41], v[56:59], v[116:119]
  v_mfma_f32_16x16x32_bf16 v[120:123], v[40:43], v[56:59], v[120:123]
  v_mfma_f32_16x16x32_bf16 v[124:127], v[42:45], v[56:59], v[124:127]
  s_waitcnt lgkmcnt(3)
  v_mfma_f32_16x16x32_bf16 v[112:115], v[40:43], v[60:63], v[112:115]
  v_mfma_f32_16x16x32_bf16 v[116:119], v[42:45], v[60:63], v[116:119]
  v_mfma_f32_16x16x32_bf16 v[120:123], v[44:47], v[60:63], v[120:123]
  v_mfma_f32_16x16x32_bf16 v[124:127], v[46:49], v[60:63], v[124:127]
  s_waitcnt lgkmcnt(0)
  v_mfma_f32_16x16x32_bf16 v[112:115], v[44:47], v[64:67], v[112:115]
  v_mfma_f32_16x16x32_bf16 v[116:119], v[46:49], v[64:67], v[116:119]
  v_mfma_f32_16x16x32_bf16 v[120:123], v[16:19], v[64:67], v[120:123]
  v_mfma_f32_16x16x32_bf16 v[124:127], v[18:21], v[64:67], v[124:127]
  s_waitcnt lgkmcnt(0)
  s_branch cv_epi
cv_hb:
  ds_read_b64 v[16:17], v5 offset:0
  ds_read_b64 v[18:19], v5 offset:32
  ds_read_b64 v[20:21], v5 offset:64
  ds_read_b64 v[22:23], v5 offset:96
  ds_read_b64 v[24:25], v5 offset:128
  ds_read_b128 v[52:55], v6 offset:19456
  ds_read_b64 v[26:27], v5 offset:160
  ds_read_b64 v[28:29], v5 offset:192
  ds_read_b128 v[56:59], v6 offset:19520
  ds_read_b64 v[30:31], v5 offset:224
  ds_read_b64 v[32:33], v5 offset:256
  ds_read_b128 v[60:63], v6 offset:19600
  ds_read_b64 v[34:35], v5 offset:288
  ds_read_b64 v[36:37], v5 offset:320
  ds_read_b128 v[64:67], v6 offset:19664
  s_waitcnt lgkmcnt(9)
  v_mfma_f32_16x16x32_bf16 v[112:115], v[16:19], v[52:55], 0
  v_mfma_f32_16x16x32_bf16 v[116:119], v[18:21], v[52:55], 0
  v_mfma_f32_16x16x32_bf16 v[120:123], v[20:23], v[52:55], 0
  v_mfma_f32_16x16x32_bf16 v[124:127], v[22:25], v[52:55], 0
  ds_read_b64 v[38:39], v5 offset:352
  ds_read_b64 v[40:41], v5 offset:384
  ds_read_b128 v[68:71], v6 offset:19744
  s_waitcnt lgkmcnt(9)
  v_mfma_f32_16x16x32_bf16 v[112:115], v[20:23], v[56:59], v[112:115]
  v_mfma_f32_16x16x32_bf16 v[116:119], v[22:25], v[56:59], v[116:119]
  v_mfma_f32_16x16x32_bf16 v[120:123], v[24:27], v[56:59], v[120:123]
  v_mfma_f32_16x16x32_bf16 v[124:127], v[26:29], v[56:59], v[124:127]
  ds_read_b64 v[42:43], v5 offset:416
  ds_read_b64 v[44:45], v5 offset:448
  ds_read_b128 v[72:75], v6 offset:19808
  s_waitcnt lgkmcnt(9)
  v_mfma_f32_16x16x32_bf16 v[112:115], v[24:27], v[60:63], v[112:115]
  v_mfma_f32_16x16x32_bf16 v[116:119], v[26:29], v[60:63], v[116:119]
  v_mfma_f32_16x16x32_bf16 v[120:123], v[28:31], v[60:63], v[120:123]
  v_mfma_f32_16x16x32_bf16 v[124:127], v[30:33], v[60:63], v[124:127]
  ds_read_b64 v[46:47], v5 offset:480
  ds_read_b64 v[16:17], v5 offset:512
  ds_read_b64 v[48:49], v5 offset:512
  ds_read_b128 v[52:55], v6 offset:19888
  s_waitcnt lgkmcnt(10)
  v_mfma_f32_16x16x32_bf16 v[112:115], v[28:31], v[64:67], v[112:115]
  v_mfma_f32_16x16x32_bf16 v[116:119], v[30:33], v[64:67], v[116:119]
  v_mfma_f32_16x16x32_bf16 v[120:123], v[32:35], v[64:67], v[120:123]
  v_mfma_f32_16x16x32_bf16 v[124:127], v[34:37], v[64:67], v[124:127]
  ds_read_b64 v[18:19], v5 offset:544
  ds_read_b64 v[20:21], v5 offset:576
  ds_read_b128 v[56:59], v6 offset:19952
  s_waitcnt lgkmcnt(10)
  v_mfma_f32_16x16x32_bf16 v[112:115], v[32:35], v[68:71], v[112:115]
  v_mfma_f32_16x16x32_bf16 v[116:119], v[34:37], v[68:71], v[116:119]
  v_mfma_f32_16x16x32_bf16 v[120:123], v[36:39], v[68:71], v[120:123]
  v_mfma_f32_16x16x32_bf16 v[124:127], v[38:41], v[68:71], v[124:127]
  ds_read_b64 v[22:23], v5 offset:608
  ds_read_b64 v[24:25], v5 offset:640
  ds_read_b128 v[60:63], v6 offset:20032
  s_waitcnt lgkmcnt(10)
  v_mfma_f32_16x16x32_bf16 v[112:115], v[36:39], v[72:75], v[112:115]
  v_mfma_f32_16x16x32_bf16 v[116:119], v[38:41], v[72:75], v[116:119]
  v_mfma_f32_16x16x32_bf16 v[120:123], v[40:43], v[72:75], v[120:123]
  v_mfma_f32_16x16x32_bf16 v[124:127], v[42:45], v[72:75], v[124:127]
  ds_read_b64 v[26:27], v5 offset:672
  ds_read_b64 v[28:29], v5 offset:704
  ds_read_b128 v[64:67], v6 offset:20096
  s_waitcnt lgkmcnt(9)
  v_mfma_f32_16x16x32_bf16 v[112:115], v[40:43], v[52:55], v[112:115]
  v_mfma_f32_16x16x32_bf16 v[116:119], v[42:45], v[52:55], v[116:119]
  v_mfma_f32_16x16x32_bf16 v[120:123], v[44:47], v[52:55], v[120:123]
  v_mfma_f32_16x16x32_bf16 v[124:127], v[46:49], v[52:55], v[124:127]
  ds_read_b64 v[30:31], v5 offset:736
  ds_read_b64 v[32:33], v5 offset:768
  ds_read_b128 v[68:71], v6 offset:20176
  s_waitcnt lgkmcnt(9)
  v_mfma_f32_16x16x32_bf16 v[112:115], v[44:47], v[56:59], v[112:115]
  v_mfma_f32_16x16x32_bf16 v[116:119], v[46:49], v[56:59], v[116:119]
  v_mfma_f32_16x16x32_bf16 v[120:123], v[16:19], v[56:59], v[120:123]
  v_mfma_f32_16x16x32_bf16 v[124:127], v[18:21], v[56:59], v[124:127]
  ds_read_b64 v[34:35], v5 offset:800
  ds_read_b64 v[36:37], v5 offset:832
  ds_read_b128 v[72:75], v6 offset:20240
  s_waitcnt lgkmcnt(9)
  v_mfma_f32_16x16x32_bf16 v[112:115], v[16:19], v[60:63], v[112:115]
  v_mfma_f32_16x16x32_bf16 v[116:119], v[18:21], v[60:63], v[116:119]
  v_mfma_f32_16x16x32_bf16 v[120:123], v[20:23], v[60:63], v[120:123]
  v_mfma_f32_16x16x32_bf16 v[124:127], v[22:25], v[60:63], v[124:127]
  ds_read_b64 v[38:39], v5 offset:864
  ds_read_b64 v[40:41], v5 offset:896
  ds_read_b128 v[52:55], v6 offset:20320
  s_waitcnt lgkmcnt(9)
  v_mfma_f32_16x16x32_bf16 v[112:115], v[20:23], v[64:67], v[112:115]
  v_mfma_f32_16x16x32_bf16 v[116:119], v[22:25], v[64:67], v[116:119]
  v_mfma_f32_16x16x32_bf16 v[120:123], v[24:27], v[64:67], v[120:123]
  v_mfma_f32_16x16x32_bf16 v[124:127], v[26:29], v[64:67], v[124:127]
  ds_read_b64 v[42:43], v5 offset:928
  ds_read_b64 v[44:45], v5 offset:960
  ds_read_b128 v[56:59], v6 offset:20384
  s_waitcnt lgkmcnt(9)
  v_mfma_f32_16x16x32_bf16 v[112:115], v[24:27], v[68:71], v[112:115]
  v_mfma_f32_16x16x32_bf16 v[116:119], v[26:29], v[68:71], v[116:119]
  v_mfma_f32_16x16x32_bf16 v[120:123], v[28:31], v[68:71], v[120:123]
  v_mfma_f32_16x16x32_bf16 v[124:127], v[30:33], v[68:71], v[124:127]
  ds_read_b64 v[46:47], v5 offset:992
  ds_read_b64 v[16:17], v5 offset:1024
  ds_read_b64 v[48:49], v5 offset:1024
  ds_read_b128 v[60:63], v6 offset:20464
  s_waitcnt lgkmcnt(10)
  v_mfma_f32_16x16x32_bf16 v[112:115], v[28:31], v[72:75], v[112:115]
  v_mfma_f32_16x16x32_bf16 v[116:119], v[30:33], v[72:75], v[116:119]
  v_mfma_f32_16x16x32_bf16 v[120:123], v[32:35], v[72:75], v[120:123]
  v_mfma_f32_16x16x32_bf16 v[124:127], v[34:37], v[72:75], v[124:127]
  ds_read_b64 v[18:19], v5 offset:1056
  ds_read_b64 v[20:21], v5 offset:1088
  ds_read_b128 v[64:67], v6 offset:20528
  s_waitcnt lgkmcnt(10)
  v_mfma_f32_16x16x32_bf16 v[112:115], v[32:35], v[52:55], v[112:115]
  v_mfma_f32_16x16x32_bf16 v[116:119], v[34:37], v[52:55], v[116:119]
  v_mfma_f32_16x16x32_bf16 v[120:123], v[36:39], v[52:55], v[120:123]
  v_mfma_f32_16x16x32_bf16 v[124:127], v[38:41], v[52:55], v[124:127]
  ds_read_b64 v[22:23], v5 offset:1120
  ds_read_b64 v[24:25], v5 offset:1152
  ds_read_b128 v[68:71], v6 offset:20608
  s_waitcnt lgkmcnt(10)
  v_mfma_f32_16x16x32_bf16 v[112:115], v[36:39], v[56:59], v[112:115]
  v_mfma_f32_16x16x32_bf16 v[116:119], v[38:41], v[56:59], v[116:119]
  v_mfma_f32_16x16x32_bf16 v[120:123], v[40:43], v[56:59], v[120:123]
  v_mfma_f32_16x16x32_bf16 v[124:127], v[42:45], v[56:59], v[124:127]
  ds_read_b64 v[26:27], v5 offset:1184
  ds_read_b64 v[28:29], v5 offset:1216
  ds_read_b128 v[72:75], v6 offset:20672
  s_waitcnt lgkmcnt(9)
  v_mfma_f32_16x16x32_bf16 v[112:115], v[40:43], v[60:63], v[112:115]
  v_mfma_f32_16x16x32_bf16 v[116:119], v[42:45], v[60:63], v[116:119]
  v_mfma_f32_16x16x32_bf16 v[120:123], v[44:47], v[60:63], v[120:123]
  v_mfma_f32_16x16x32_bf16 v[124:127], v[46:49], v[60:63], v[124:127]
  ds_read_b64 v[30:31], v5 offset:1248
  ds_read_b64 v[32:33], v5 offset:1280
  ds_read_b128 v[52:55], v6 offset:20752
  s_waitcnt lgkmcnt(9)
  v_mfma_f32_16x16x32_bf16 v[112:115], v[44:47], v[64:67], v[112:115]
  v_mfma_f32_16x16x32_bf16 v[116:119], v[46:49], v[64:67], v[116:119]
  v_mfma_f32_16x16x32_bf16 v[120:123], v[16:19], v[64:67], v[120:123]
  v_mfma_f32_16x16x32_bf16 v[124:127], v[18:21], v[64:67], v[124:127]
  ds_read_b64 v[34:35], v5 offset:1312
  ds_read_b64 v[36:37], v5 offset:1344
  ds_read_b128 v[56:59], v6 offset:20816
  s_waitcnt lgkmcnt(9)
  v_mfma_f32_16x16x32_bf16 v[112:115], v[16:19], v[68:71], v[112:115]
  v_mfma_f32_16x16x32_bf16 v[116:119], v[18:21], v[68:71], v[116:119]
  v_mfma_f32_16x16x32_bf16 v[120:123], v[20:23], v[68:71], v[120:123]
  v_mfma_f32_16x16x32_bf16 v[124:127], v[22:25], v[68:71], v[124:127]
  ds_read_b64 v[38:39], v5 offset:1376
  ds_read_b64 v[40:41], v5 offset:1408
  ds_read_b128 v[60:63], v6 offset:20896
  s_waitcnt lgkmcnt(9)
  v_mfma_f32_16x16x32_bf16 v[112:115], v[20:23], v[72:75], v[112:115]
  v_mfma_f32_16x16x32_bf16 v[116:119], v[22:25], v[72:75], v[116:119]
  v_mfma_f32_16x16x32_bf16 v[120:123], v[24:27], v[72:75], v[120:123]
  v_mfma_f32_16x16x32_bf16 v[124:127], v[26:29], v[72:75], v[124:127]
  ds_read_b64 v[42:43], v5 offset:1440
  ds_read_b64 v[44:45], v5 offset:1472
  ds_read_b128 v[64:67], v6 offset:20960
  s_waitcnt lgkmcnt(9)
  v_mfma_f32_16x16x32_bf16 v[112:115], v[24:27], v[52:55], v[112:115]
  v_mfma_f32_16x16x32_bf16 v[116:119], v[26:29], v[52:55], v[116:119]
  v_mfma_f32_16x16x32_bf16 v[120:123], v[28:31], v[52:55], v[120:123]
  v_mfma_f32_16x16x32_bf16 v[124:127], v[30:33], v[52:55], v[124:127]
  ds_read_b64 v[46:47], v5 offset:1504
  ds_read_b64 v[16:17], v5 offset:1536
  ds_read_b64 v[48:49], v5 offset:1536
  ds_read_b128 v[68:71], v6 offset:21040
  s_waitcnt lgkmcnt(10)
  v_mfma_f32_16x16x32_bf16 v[112:115], v[28:31], v[56:59], v[112:115]
  v_mfma_f32_16x16x32_bf16 v[116:119], v[30:33], v[56:59], v[116:119]
  v_mfma_f32_16x16x32_bf16 v[120:123], v[32:35], v[56:59], v[120:123]
  v_mfma_f32_16x16x32_bf16 v[124:127], v[34:37], v[56:59], v[124:127]
  ds_read_b64 v[18:19], v5 offset:1568
  ds_read_b64 v[20:21], v5 offset:1600
  ds_read_b128 v[72:75], v6 offset:21104
  s_waitcnt lgkmcnt(10)
  v_mfma_f32_16x16x32_bf16 v[112:115], v[32:35], v[60:63], v[112:115]
  v_mfma_f32_16x16x32_bf16 v[116:119], v[34:37], v[60:63], v[116:119]
  v_mfma_f32_16x16x32_bf16 v[120:123], v[36:39], v[60:63], v[120:123]
  v_mfma_f32_16x16x32_bf16 v[124:127], v[38:41], v[60:63], v[124:127]
  ds_read_b64 v[22:23], v5 offset:1632
  ds_read_b64 v[24:25], v5 offset:1664
  ds_read_b128 v[52:55], v6 offset:21184
  s_waitcnt lgkmcnt(10)
  v_mfma_f32_16x16x32_bf16 v[112:115], v[36:39], v[64:67], v[112:115]
  v_mfma_f32_16x16x32_bf16 v[116:119], v[38:41], v[64:67], v[116:119]
  v_mfma_f32_16x16x32_bf16 v[120:123], v[40:43], v[64:67], v[120:123]
  v_mfma_f32_16x16x32_bf16 v[124:127], v[42:45], v[64:67], v[124:127]
  ds_read_b64 v[26:27], v5 offset:1696
  ds_read_b64 v[28:29], v5 offset:1728
  ds_read_b128 v[56:59], v6 offset:21248
  s_waitcnt lgkmcnt(9)
  v_mfma_f32_16x16x32_bf16 v[112:115], v[40:43], v[68:71], v[112:115]
  v_mfma_f32_16x16x32_bf16 v[116:119], v[42:45], v[68:71], v[116:119]
  v_mfma_f32_16x16x32_bf16 v[120:123], v[44:47], v[68:71], v[120:123]
  v_mfma_f32_16x16x32_bf16 v[124:127], v[46:49], v[68:71], v[124:127]
  ds_read_b64 v[30:31], v5 offset:1760
  ds_read_b64 v[32:33], v5 offset:1792
  ds_read_b128 v[60:63], v6 offset:21328
  s_waitcnt lgkmcnt(9)
  v_mfma_f32_16x16x32_bf16 v[112:115], v[44:47], v[72:75], v[112:115]
  v_mfma_f32_16x16x32_bf16 v[116:119], v[46:49], v[72:75], v[116:119]
  v_mfma_f32_16x16x32_bf16 v[120:123], v[16:19], v[72:75], v[120:123]
  v_mfma_f32_16x16x32_bf16 v[124:127], v[18:21], v[72:75], v[124:127]
  ds_read_b64 v[34:35], v5 offset:1824
  ds_read_b64 v[36:37], v5 offset:1856
  ds_read_b128 v[64:67], v6 offset:21392
  s_waitcnt lgkmcnt(9)
  v_mfma_f32_16x16x32_bf16 v[112:115], v[16:19], v[52:55], v[112:115]
  v_mfma_f32_16x16x32_bf16 v[116:119], v[18:21], v[52:55], v[116:119]
  v_mfma_f32_16x16x32_bf16 v[120:123], v[20:23], v[52:55], v[120:123]
  v_mfma_f32_16x16x32_bf16 v[124:127], v[22:25], v[52:55], v[124:127]
  ds_read_b64 v[38:39], v5 offset:1888
  ds_read_b64 v[40:41], v5 offset:1920
  ds_read_b128 v[68:71], v6 offset:21472
  s_waitcnt lgkmcnt(9)
  v_mfma_f32_16x16x32_bf16 v[112:115], v[20:23], v[56:59], v[112:115]
  v_mfma_f32_16x16x32_bf16 v[116:119], v[22:25], v[56:59], v[116:119]
  v_mfma_f32_16x16x32_bf16 v[120:123], v[24:27], v[56:59], v[120:123]
  v_mfma_f32_16x16x32_bf16 v[124:127], v[26:29], v[56:59], v[124:127]
  ds_read_b64 v[42:43], v5 offset:1952
  ds_read_b64 v[44:45], v5 offset:1984
  ds_read_b128 v[72:75], v6 offset:21536
  s_waitcnt lgkmcnt(9)
  v_mfma_f32_16x16x32_bf16 v[112:115], v[24:27], v[60:63], v[112:115]
  v_mfma_f32_16x16x32_bf16 v[116:119], v[26:29], v[60:63], v[116:119]
  v_mfma_f32_16x16x32_bf16 v[120:123], v[28:31], v[60:63], v[120:123]
  v_mfma_f32_16x16x32_bf16 v[124:127], v[30:33], v[60:63], v[124:127]
  ds_read_b64 v[46:47], v5 offset:2016
  ds_read_b64 v[16:17], v5 offset:2048
  ds_read_b64 v[48:49], v5 offset:2048
  ds_read_b128 v[52:55], v6 offset:21616
  s_waitcnt lgkmcnt(10)
  v_mfma_f32_16x16x32_bf16 v[112:115], v[28:31], v[64:67], v[112:115]
  v_mfma_f32_16x16x32_bf16 v[116:119], v[30:33], v[64:67], v[116:119]
  v_mfma_f32_16x16x32_bf16 v[120:123], v[32:35], v[64:67], v[120:123]
  v_mfma_f32_16x16x32_bf16 v[124:127], v[34:37], v[64:67], v[124:127]
  ds_read_b64 v[18:19], v5 offset:2080
  ds_read_b64 v[20:21], v5 offset:2112
  ds_read_b128 v[56:59], v6 offset:21680
  s_waitcnt lgkmcnt(10)
  v_mfma_f32_16x16x32_bf16 v[112:115], v[32:35], v[68:71], v[112:115]
  v_mfma_f32_16x16x32_bf16 v[116:119], v[34:37], v[68:71], v[116:119]
  v_mfma_f32_16x16x32_bf16 v[120:123], v[36:39], v[68:71], v[120:123]
  v_mfma_f32_16x16x32_bf16 v[124:127], v[38:41], v[68:71], v[124:127]
  s_waitcnt lgkmcnt(7)
  v_mfma_f32_16x16x32_bf16 v[112:115], v[36:39], v[72:75], v[112:115]
  v_mfma_f32_16x16x32_bf16 v[116:119], v[38:41], v[72:75], v[116:119]
  v_mfma_f32_16x16x32_bf16 v[120:123], v[40:43], v[72:75], v[120:123]
  v_mfma_f32_16x16x32_bf16 v[124:127], v[42:45], v[72:75], v[124:127]
  s_waitcnt lgkmcnt(3)
  v_mfma_f32_16x16x32_bf16 v[112:115], v[40:43], v[52:55], v[112:115]
  v_mfma_f32_16x16x32_bf16 v[116:119], v[42:45], v[52:55], v[116:119]
  v_mfma_f32_16x16x32_bf16 v[120:123], v[44:47], v[52:55], v[120:123]
  v_mfma_f32_16x16x32_bf16 v[124:127], v[46:49], v[52:55], v[124:127]
  s_waitcnt lgkmcnt(0)
  v_mfma_f32_16x16x32_bf16 v[112:115], v[44:47], v[56:59], v[112:115]
  v_mfma_f32_16x16x32_bf16 v[116:119], v[46:49], v[56:59], v[116:119]
  v_mfma_f32_16x16x32_bf16 v[120:123], v[16:19], v[56:59], v[120:123]
  v_mfma_f32_16x16x32_bf16 v[124:127], v[18:21], v[56:59], v[124:127]
  s_waitcnt lgkmcnt(0)
cv_epi:
  s_mul_i32 s27, s46, 2304
  s_add_u32 s27, s27, s44
  v_sub_u32 v7, 3, v3
  v_sub_u32 v8, 15, v4
  v_mul_u32_u24 v8, 144, v8
  v_lshl_add_u32 v8, v7, 4, v8
  v_add_u32 v8, s27, v8
  ds_read_b64 v[16:17], v8 offset:17224
  ds_read_b64 v[18:19], v8 offset:17216
  ds_read_b64 v[20:21], v8 offset:17160
  ds_read_b64 v[22:23], v8 offset:17152
  s_lshl_b32 s27, s3, 11
  s_add_u32 s27, s27, 148480
  v_lshlrev_b32 v9, 7, v4
  v_lshl_add_u32 v9, v3, 3, v9
  v_add_u32 v9, s27, v9
  v_add_u32 v11, s27, v92
  s_waitcnt lgkmcnt(0) vmcnt(0)
  v_lshlrev_b32 v10, 16, v10
  v_lshlrev_b32 v43, 16, v16
  v_and_b32 v42, 0xffff0000, v16
  v_lshlrev_b32 v41, 16, v17
  v_and_b32 v40, 0xffff0000, v17
  v_mul_f32 v40, v40, v10
  v_mul_f32 v41, v41, v10
  v_mul_f32 v42, v42, v10
  v_mul_f32 v43, v43, v10
  v_cvt_pk_bf16_f32 v44, v40, v41
  v_lshlrev_b32 v40, 16, v44
  v_and_b32 v41, 0xffff0000, v44
  v_cvt_pk_bf16_f32 v44, v42, v43
  v_lshlrev_b32 v42, 16, v44
  v_and_b32 v43, 0xffff0000, v44
  v_cvt_pk_bf16_f32 v44, v112, v113
  v_lshlrev_b32 v112, 16, v44
  v_and_b32 v113, 0xffff0000, v44
  v_cvt_pk_bf16_f32 v44, v114, v115
  v_lshlrev_b32 v114, 16, v44
  v_and_b32 v115, 0xffff0000, v44
  v_add_f32 v112, v112, v40
  v_add_f32 v113, v113, v41
  v_add_f32 v114, v114, v42
  v_add_f32 v115, v115, v43
  v_cvt_pk_bf16_f32 v112, v112, v113
  v_cvt_pk_bf16_f32 v113, v114, v115
  ds_write_b64 v9, v[112:113] offset:0
  v_lshlrev_b32 v43, 16, v18
  v_and_b32 v42, 0xffff0000, v18
  v_lshlrev_b32 v41, 16, v19
  v_and_b32 v40, 0xffff0000, v19
  v_mul_f32 v40, v40, v10
  v_mul_f32 v41, v41, v10
  v_mul_f32 v42, v42, v10
  v_mul_f32 v43, v43, v10
  v_cvt_pk_bf16_f32 v44, v40, v41
  v_lshlrev_b32 v40, 16, v44
  v_and_b32 v41, 0xffff0000, v44
  v_cvt_pk_bf16_f32 v44, v42, v43
  v_lshlrev_b32 v42, 16, v44
  v_and_b32 v43, 0xffff0000, v44
  v_cvt_pk_bf16_f32 v44, v116, v117
  v_lshlrev_b32 v116, 16, v44
  v_and_b32 v117, 0xffff0000, v44
  v_cvt_pk_bf16_f32 v44, v118, v119
  v_lshlrev_b32 v118, 16, v44
  v_and_b32 v119, 0xffff0000, v44
  v_add_f32 v116, v116, v40
  v_add_f32 v117, v117, v41
  v_add_f32 v118, v118, v42
  v_add_f32 v119, v119, v43
  v_cvt_pk_bf16_f32 v116, v116, v117
  v_cvt_pk_bf16_f32 v117, v118, v119
  ds_write_b64 v9, v[116:117] offset:32
  v_lshlrev_b32 v43, 16, v20
  v_and_b32 v42, 0xffff0000, v20
  v_lshlrev_b32 v41, 16, v21
  v_and_b32 v40, 0xffff0000, v21
  v_mul_f32 v40, v40, v10
  v_mul_f32 v41, v41, v10
  v_mul_f32 v42, v42, v10
  v_mul_f32 v43, v43, v10
  v_cvt_pk_bf16_f32 v44, v40, v41
  v_lshlrev_b32 v40, 16, v44
  v_and_b32 v41, 0xffff0000, v44
  v_cvt_pk_bf16_f32 v44, v42, v43
  v_lshlrev_b32 v42, 16, v44
  v_and_b32 v43, 0xffff0000, v44
  v_cvt_pk_bf16_f32 v44, v120, v121
  v_lshlrev_b32 v120, 16, v44
  v_and_b32 v121, 0xffff0000, v44
  v_cvt_pk_bf16_f32 v44, v122, v123
  v_lshlrev_b32 v122, 16, v44
  v_and_b32 v123, 0xffff0000, v44
  v_add_f32 v120, v120, v40
  v_add_f32 v121, v121, v41
  v_add_f32 v122, v122, v42
  v_add_f32 v123, v123, v43
  v_cvt_pk_bf16_f32 v120, v120, v121
  v_cvt_pk_bf16_f32 v121, v122, v123
  ds_write_b64 v9, v[120:121] offset:64
  v_lshlrev_b32 v43, 16, v22
  v_and_b32 v42, 0xffff0000, v22
  v_lshlrev_b32 v41, 16, v23
  v_and_b32 v40, 0xffff0000, v23
  v_mul_f32 v40, v40, v10
  v_mul_f32 v41, v41, v10
  v_mul_f32 v42, v42, v10
  v_mul_f32 v43, v43, v10
  v_cvt_pk_bf16_f32 v44, v40, v41
  v_lshlrev_b32 v40, 16, v44
  v_and_b32 v41, 0xffff0000, v44
  v_cvt_pk_bf16_f32 v44, v42, v43
  v_lshlrev_b32 v42, 16, v44
  v_and_b32 v43, 0xffff0000, v44
  v_cvt_pk_bf16_f32 v44, v124, v125
  v_lshlrev_b32 v124, 16, v44
  v_and_b32 v125, 0xffff0000, v44
  v_cvt_pk_bf16_f32 v44, v126, v127
  v_lshlrev_b32 v126, 16, v44
  v_and_b32 v127, 0xffff0000, v44
  v_add_f32 v124, v124, v40
  v_add_f32 v125, v125, v41
  v_add_f32 v126, v126, v42
  v_add_f32 v127, v127, v43
  v_cvt_pk_bf16_f32 v124, v124, v125
  v_cvt_pk_bf16_f32 v125, v126, v127
  ds_write_b64 v9, v[124:125] offset:96
  s_waitcnt lgkmcnt(0)
  s_add_u32 s48, s80, 5013504
  s_addc_u32 s49, s81, 0
  s_mov_b32 s50, 2359296
  s_mov_b32 s51, 0x00020000
  ds_read_b128 v[144:147], v11
  ds_read_b128 v[148:151], v11 offset:1024
  s_sub_u32 s27, 1, s46
  s_lshl_b32 s27, s27, 11
  s_add_u32 s27, s27, s45
  s_waitcnt lgkmcnt(1)
  buffer_store_dwordx4 v[144:147], v92, s[48:51], s27 offen sc0 sc1
  s_waitcnt lgkmcnt(0)
  buffer_store_dwordx4 v[148:151], v92, s[48:51], s27 offen offset:1024 sc0 sc1
  s_branch p3_go
cv_b2:
  s_waitcnt vmcnt(0)
  s_cmp_lg_u32 s3, 7
  s_cbranch_scc1 p3_go
  v_mov_b32 v4, 0
  s_lshl_b32 s27, s23, 4
  s_add_u32 s27, s27, s20
  s_lshl_b32 s27, s27, 8
  s_mov_b32 s55, 0
p3_poll:
  buffer_load_dword v3, v4, s[32:35], s27 offen sc0 sc1
  s_waitcnt vmcnt(0)
  v_readfirstlane_b32 s29, v3
  s_cmp_ge_u32 s29, 8
  s_cselect_b32 s29, 1, 0
  s_cmp_lg_u32 s29, 0
  s_cbranch_scc1 p3_poll_done
  s_add_u32 s55, s55, 1
  s_cmp_ge_u32 s55, 200000
  s_cbranch_scc1 p3_poll_done
  s_sleep 4
  s_branch p3_poll
p3_poll_done:
p3_go:
  s_barrier
  s_and_b32 s40, s3, 3
  s_lshr_b32 s41, s3, 2
  s_lshl_b32 s42, s21, 3
  s_lshl_b32 s43, s40, 1
  s_add_u32 s42, s42, s43
  s_lshl_b32 s43, s42, 5
  s_lshl_b32 s44, s20, 3
  s_add_u32 s43, s43, s44
  s_mul_i32 s43, s43, 4608
  s_lshl_b32 s44, s41, 10
  s_add_u32 s44, s44, s43
  v_add_u32 v96, s44, v92
  v_add_u32 v97, 147456, v96
  s_mul_i32 s44, s41, 9216
  s_add_u32 s44, s44, s43
  s_add_u32 s44, s44, 4096
  v_lshlrev_b32 v98, 3, v2
  v_add_u32 v98, s44, v98
  v_add_u32 v99, 147456, v98
  v_lshrrev_b32 v3, 2, v2
  s_lshl_b32 s44, s41, 5
  v_add_u32 v3, s44, v3
  v_mul_u32_u24 v3, 288, v3
  v_and_b32 v4, 3, v2
  v_lshl_add_u32 v3, v4, 3, v3
  v_add_u32 v100, 0, v3
  v_add_u32 v101, 36864, v3
  v_add_u32 v102, 73728, v3
  v_add_u32 v103, 110592, v3
  s_movk_i32 s29, 0
  buffer_load_dwordx4 v[16:19], v96, s[16:19], s29 offen offset:0 sc1
  buffer_load_dwordx4 v[20:23], v97, s[16:19], s29 offen offset:0 sc1
  buffer_load_dwordx4 v[24:27], v96, s[16:19], s29 offen offset:2048 sc1
  buffer_load_dwordx4 v[28:31], v97, s[16:19], s29 offen offset:2048 sc1
  ds_read_b64_tr_b16 v[112:113], v103 offset:0
  ds_read_b64_tr_b16 v[114:115], v103 offset:4608
  ds_read_b64_tr_b16 v[116:117], v103 offset:32
  ds_read_b64_tr_b16 v[118:119], v103 offset:4640
  ds_read_b64_tr_b16 v[120:121], v103 offset:64
  ds_read_b64_tr_b16 v[122:123], v103 offset:4672
  ds_read_b64_tr_b16 v[124:125], v103 offset:96
  ds_read_b64_tr_b16 v[126:127], v103 offset:4704
  ds_read_b64_tr_b16 v[128:129], v103 offset:128
  ds_read_b64_tr_b16 v[130:131], v103 offset:4736
  ds_read_b64_tr_b16 v[132:133], v103 offset:160
  ds_read_b64_tr_b16 v[134:135], v103 offset:4768
  s_waitcnt vmcnt(0)
  ds_read_b64_tr_b16 v[136:137], v103 offset:192
  ds_read_b64_tr_b16 v[138:139], v103 offset:4800
  s_waitcnt lgkmcnt(10)
  v_mfma_f32_16x16x32_bf16 v[184:187], v[112:115], v[16:19], 0
  v_mfma_f32_16x16x32_bf16 v[188:191], v[112:115], v[20:23], 0
  s_movk_i32 s29, 4608
  buffer_load_dwordx4 v[32:35], v96, s[16:19], s29 offen offset:0 sc1
  buffer_load_dwordx4 v[36:39], v97, s[16:19], s29 offen offset:0 sc1
  buffer_load_dwordx4 v[40:43], v96, s[16:19], s29 offen offset:2048 sc1
  buffer_load_dwordx4 v[44:47], v97, s[16:19], s29 offen offset:2048 sc1
  ds_read_b64_tr_b16 v[140:141], v103 offset:224
  ds_read_b64_tr_b16 v[142:143], v103 offset:4832
  v_mfma_f32_16x16x32_bf16 v[192:195], v[116:119], v[16:19], 0
  v_mfma_f32_16x16x32_bf16 v[196:199], v[116:119], v[20:23], 0
  ds_read_b64_tr_b16 v[112:113], v103 offset:256
  ds_read_b64_tr_b16 v[114:115], v103 offset:4864
  s_waitcnt lgkmcnt(10)
  v_mfma_f32_16x16x32_bf16 v[200:203], v[120:123], v[16:19], 0
  v_mfma_f32_16x16x32_bf16 v[204:207], v[120:123], v[20:23], 0
  s_mov_b32 s29, 331776
  s_add_u32 m0, s28, 36864
  s_nop 0
  buffer_load_dwordx4 v80, s[8:11], s29 offen lds
  s_mov_b32 s29, 331776
  s_add_u32 m0, s28, 37888
  s_nop 0
  buffer_load_dwordx4 v81, s[8:11], s29 offen lds
  s_mov_b32 s29, 331776
  s_add_u32 m0, s28, 38912
  s_nop 0
  buffer_load_dwordx4 v82, s[8:11], s29 offen lds
  ds_read_b64_tr_b16 v[116:117], v103 offset:18432
  ds_read_b64_tr_b16 v[118:119], v103 offset:23040
  v_mfma_f32_16x16x32_bf16 v[208:211], v[124:127], v[16:19], 0
  v_mfma_f32_16x16x32_bf16 v[212:215], v[124:127], v[20:23], 0
  ds_read_b64_tr_b16 v[120:121], v103 offset:18464
  ds_read_b64_tr_b16 v[122:123], v103 offset:23072
  s_waitcnt lgkmcnt(10)
  v_mfma_f32_16x16x32_bf16 v[216:219], v[128:131], v[16:19], 0
  v_mfma_f32_16x16x32_bf16 v[220:223], v[128:131], v[20:23], 0
  s_mov_b32 s29, 331776
  s_add_u32 m0, s28, 39936
  s_nop 0
  buffer_load_dwordx4 v83, s[8:11], s29 offen lds
  s_mov_b32 s29, 331776
  s_add_u32 m0, s28, 40960
  s_mov_b32 exec_hi, 0
  buffer_load_dwordx4 v84, s[8:11], s29 offen lds
  s_mov_b32 exec_hi, -1
  ds_read_b64_tr_b16 v[124:125], v103 offset:18496
  ds_read_b64_tr_b16 v[126:127], v103 offset:23104
  v_mfma_f32_16x16x32_bf16 v[224:227], v[132:135], v[16:19], 0
  v_mfma_f32_16x16x32_bf16 v[228:231], v[132:135], v[20:23], 0
  ds_read_b64_tr_b16 v[128:129], v103 offset:18528
  ds_read_b64_tr_b16 v[130:131], v103 offset:23136
  s_waitcnt lgkmcnt(10)
  v_mfma_f32_16x16x32_bf16 v[232:235], v[136:139], v[16:19], 0
  v_mfma_f32_16x16x32_bf16 v[236:239], v[136:139], v[20:23], 0
  s_movk_i32 s29, 9216
  buffer_load_dwordx4 v[48:51], v96, s[16:19], s29 offen offset:0 sc1
  buffer_load_dwordx4 v[52:55], v97, s[16:19], s29 offen offset:0 sc1
  buffer_load_dwordx4 v[56:59], v96, s[16:19], s29 offen offset:2048 sc1
  buffer_load_dwordx4 v[60:63], v97, s[16:19], s29 offen offset:2048 sc1
  ds_read_b64_tr_b16 v[132:133], v103 offset:18560
  ds_read_b64_tr_b16 v[134:135], v103 offset:23168
  v_mfma_f32_16x16x32_bf16 v[240:243], v[140:143], v[16:19], 0
  v_mfma_f32_16x16x32_bf16 v[244:247], v[140:143], v[20:23], 0
  ds_read_b64_tr_b16 v[136:137], v103 offset:18592
  ds_read_b64_tr_b16 v[138:139], v103 offset:23200
  s_waitcnt lgkmcnt(10)
  v_mfma_f32_16x16x32_bf16 v[248:251], v[112:115], v[16:19], 0
  v_mfma_f32_16x16x32_bf16 v[252:255], v[112:115], v[20:23], 0
  s_barrier
  s_lshl_b32 s27, s47, 2
  s_add_u32 s27, s27, 40960
  s_xor_b32 s29, s46, 1
  s_and_b32 s29, s29, s83
  s_cmp_lg_u32 s29, 0
  s_cselect_b32 s27, s27, 0xfffffff0
  v_mov_b32 v3, s85
  v_mov_b32 v4, s27
  s_mov_b64 exec, 1
  buffer_store_dword v3, v4, s[32:35], 0 offen sc0 sc1
  s_mov_b64 exec, -1
  ds_read_b64_tr_b16 v[140:141], v103 offset:18624
  ds_read_b64_tr_b16 v[142:143], v103 offset:23232
  v_mfma_f32_16x16x32_bf16 v[184:187], v[116:119], v[24:27], v[184:187]
  v_mfma_f32_16x16x32_bf16 v[188:191], v[116:119], v[28:31], v[188:191]
  ds_read_b64_tr_b16 v[112:113], v103 offset:18656
  ds_read_b64_tr_b16 v[114:115], v103 offset:23264
  s_waitcnt lgkmcnt(10)
  v_mfma_f32_16x16x32_bf16 v[192:195], v[120:123], v[24:27], v[192:195]
  v_mfma_f32_16x16x32_bf16 v[196:199], v[120:123], v[28:31], v[196:199]
  s_movk_i32 s29, 13824
  buffer_load_dwordx4 v[64:67], v96, s[16:19], s29 offen offset:0 sc1
  buffer_load_dwordx4 v[68:71], v97, s[16:19], s29 offen offset:0 sc1
  buffer_load_dwordx4 v[72:75], v96, s[16:19], s29 offen offset:2048 sc1
  buffer_load_dwordx4 v[76:79], v97, s[16:19], s29 offen offset:2048 sc1
  s_mov_b32 s29, 497664
  s_add_u32 m0, s28, 73728
  s_nop 0
  buffer_load_dwordx4 v80, s[8:11], s29 offen lds
  ds_read_b64_tr_b16 v[116:117], v103 offset:18688
  ds_read_b64_tr_b16 v[118:119], v103 offset:23296
  v_mfma_f32_16x16x32_bf16 v[200:203], v[124:127], v[24:27], v[200:203]
  v_mfma_f32_16x16x32_bf16 v[204:207], v[124:127], v[28:31], v[204:207]
  ds_read_b64_tr_b16 v[120:121], v100 offset:0
  ds_read_b64_tr_b16 v[122:123], v100 offset:4608
  s_waitcnt lgkmcnt(10)
  v_mfma_f32_16x16x32_bf16 v[208:211], v[128:131], v[24:27], v[208:211]
  v_mfma_f32_16x16x32_bf16 v[212:215], v[128:131], v[28:31], v[212:215]
  s_mov_b32 s29, 497664
  s_add_u32 m0, s28, 74752
  s_nop 0
  buffer_load_dwordx4 v81, s[8:11], s29 offen lds
  ds_read_b64_tr_b16 v[124:125], v100 offset:32
  ds_read_b64_tr_b16 v[126:127], v100 offset:4640
  v_mfma_f32_16x16x32_bf16 v[216:219], v[132:135], v[24:27], v[216:219]
  v_mfma_f32_16x16x32_bf16 v[220:223], v[132:135], v[28:31], v[220:223]
  ds_read_b64_tr_b16 v[128:129], v100 offset:64
  ds_read_b64_tr_b16 v[130:131], v100 offset:4672
  s_waitcnt lgkmcnt(10)
  v_mfma_f32_16x16x32_bf16 v[224:227], v[136:139], v[24:27], v[224:227]
  v_mfma_f32_16x16x32_bf16 v[228:231], v[136:139], v[28:31], v[228:231]
  s_mov_b32 s29, 497664
  s_add_u32 m0, s28, 75776
  s_nop 0
  buffer_load_dwordx4 v82, s[8:11], s29 offen lds
  ds_read_b64_tr_b16 v[132:133], v100 offset:96
  ds_read_b64_tr_b16 v[134:135], v100 offset:4704
  v_mfma_f32_16x16x32_bf16 v[232:235], v[140:143], v[24:27], v[232:235]
  v_mfma_f32_16x16x32_bf16 v[236:239], v[140:143], v[28:31], v[236:239]
  ds_read_b64_tr_b16 v[136:137], v100 offset:128
  ds_read_b64_tr_b16 v[138:139], v100 offset:4736
  s_waitcnt lgkmcnt(10)
  v_mfma_f32_16x16x32_bf16 v[240:243], v[112:115], v[24:27], v[240:243]
  v_mfma_f32_16x16x32_bf16 v[244:247], v[112:115], v[28:31], v[244:247]
  s_mov_b32 s29, 497664
  s_add_u32 m0, s28, 76800
  s_nop 0
  buffer_load_dwordx4 v83, s[8:11], s29 offen lds
  ds_read_b64_tr_b16 v[140:141], v100 offset:160
  ds_read_b64_tr_b16 v[142:143], v100 offset:4768
  v_mfma_f32_16x16x32_bf16 v[248:251], v[116:119], v[24:27], v[248:251]
  v_mfma_f32_16x16x32_bf16 v[252:255], v[116:119], v[28:31], v[252:255]
  s_movk_i32 s29, 18432
  buffer_load_dwordx4 v[16:19], v96, s[16:19], s29 offen offset:0 sc1
  buffer_load_dwordx4 v[20:23], v97, s[16:19], s29 offen offset:0 sc1
  buffer_load_dwordx4 v[24:27], v96, s[16:19], s29 offen offset:2048 sc1
  buffer_load_dwordx4 v[28:31], v97, s[16:19], s29 offen offset:2048 sc1
  s_waitcnt vmcnt(22)
  ds_read_b64_tr_b16 v[112:113], v100 offset:192
  ds_read_b64_tr_b16 v[114:115], v100 offset:4800
  s_waitcnt lgkmcnt(10)
  v_mfma_f32_16x16x32_bf16 v[184:187], v[120:123], v[32:35], v[184:187]
  v_mfma_f32_16x16x32_bf16 v[188:191], v[120:123], v[36:39], v[188:191]
  s_mov_b32 s29, 497664
  s_add_u32 m0, s28, 77824
  s_mov_b32 exec_hi, 0
  buffer_load_dwordx4 v84, s[8:11], s29 offen lds
  s_mov_b32 exec_hi, -1
  ds_read_b64_tr_b16 v[116:117], v100 offset:224
  ds_read_b64_tr_b16 v[118:119], v100 offset:4832
  v_mfma_f32_16x16x32_bf16 v[192:195], v[124:127], v[32:35], v[192:195]
  v_mfma_f32_16x16x32_bf16 v[196:199], v[124:127], v[36:39], v[196:199]
  ds_read_b64_tr_b16 v[120:121], v100 offset:256
  ds_read_b64_tr_b16 v[122:123], v100 offset:4864
  s_waitcnt lgkmcnt(10)
  v_mfma_f32_16x16x32_bf16 v[200:203], v[128:131], v[32:35], v[200:203]
  v_mfma_f32_16x16x32_bf16 v[204:207], v[128:131], v[36:39], v[204:207]
  ds_read_b64_tr_b16 v[124:125], v100 offset:18432
  ds_read_b64_tr_b16 v[126:127], v100 offset:23040
  v_mfma_f32_16x16x32_bf16 v[208:211], v[132:135], v[32:35], v[208:211]
  v_mfma_f32_16x16x32_bf16 v[212:215], v[132:135], v[36:39], v[212:215]
  ds_read_b64_tr_b16 v[128:129], v100 offset:18464
  ds_read_b64_tr_b16 v[130:131], v100 offset:23072
  s_waitcnt lgkmcnt(10)
  v_mfma_f32_16x16x32_bf16 v[216:219], v[136:139], v[32:35], v[216:219]
  v_mfma_f32_16x16x32_bf16 v[220:223], v[136:139], v[36:39], v[220:223]
  ds_read_b64_tr_b16 v[132:133], v100 offset:18496
  ds_read_b64_tr_b16 v[134:135], v100 offset:23104
  v_mfma_f32_16x16x32_bf16 v[224:227], v[140:143], v[32:35], v[224:227]
  v_mfma_f32_16x16x32_bf16 v[228:231], v[140:143], v[36:39], v[228:231]
  ds_read_b64_tr_b16 v[136:137], v100 offset:18528
  ds_read_b64_tr_b16 v[138:139], v100 offset:23136
  s_waitcnt lgkmcnt(10)
  v_mfma_f32_16x16x32_bf16 v[232:235], v[112:115], v[32:35], v[232:235]
  v_mfma_f32_16x16x32_bf16 v[236:239], v[112:115], v[36:39], v[236:239]
  ds_read_b64_tr_b16 v[140:141], v100 offset:18560
  ds_read_b64_tr_b16 v[142:143], v100 offset:23168
  v_mfma_f32_16x16x32_bf16 v[240:243], v[116:119], v[32:35], v[240:243]
  v_mfma_f32_16x16x32_bf16 v[244:247], v[116:119], v[36:39], v[244:247]
  ds_read_b64_tr_b16 v[112:113], v100 offset:18592
  ds_read_b64_tr_b16 v[114:115], v100 offset:23200
  s_waitcnt lgkmcnt(10)
  v_mfma_f32_16x16x32_bf16 v[248:251], v[120:123], v[32:35], v[248:251]
  v_mfma_f32_16x16x32_bf16 v[252:255], v[120:123], v[36:39], v[252:255]
  s_waitcnt vmcnt(18)
  s_barrier
  ds_read_b64_tr_b16 v[116:117], v100 offset:18624
  ds_read_b64_tr_b16 v[118:119], v100 offset:23232
  v_mfma_f32_16x16x32_bf16 v[184:187], v[124:127], v[40:43], v[184:187]
  v_mfma_f32_16x16x32_bf16 v[188:191], v[124:127], v[44:47], v[188:191]
  ds_read_b64_tr_b16 v[120:121], v100 offset:18656
  ds_read_b64_tr_b16 v[122:123], v100 offset:23264
  s_waitcnt lgkmcnt(10)
  v_mfma_f32_16x16x32_bf16 v[192:195], v[128:131], v[40:43], v[192:195]
  v_mfma_f32_16x16x32_bf16 v[196:199], v[128:131], v[44:47], v[196:199]
  s_mov_b32 s29, 663552
  s_add_u32 m0, s28, 110592
  s_nop 0
  buffer_load_dwordx4 v80, s[8:11], s29 offen lds
  ds_read_b64_tr_b16 v[124:125], v100 offset:18688
  ds_read_b64_tr_b16 v[126:127], v100 offset:23296
  v_mfma_f32_16x16x32_bf16 v[200:203], v[132:135], v[40:43], v[200:203]
  v_mfma_f32_16x16x32_bf16 v[204:207], v[132:135], v[44:47], v[204:207]
  ds_read_b64_tr_b16 v[128:129], v101 offset:0
  ds_read_b64_tr_b16 v[130:131], v101 offset:4608
  s_waitcnt lgkmcnt(10)
  v_mfma_f32_16x16x32_bf16 v[208:211], v[136:139], v[40:43], v[208:211]
  v_mfma_f32_16x16x32_bf16 v[212:215], v[136:139], v[44:47], v[212:215]
  s_mov_b32 s29, 663552
  s_add_u32 m0, s28, 111616
  s_nop 0
  buffer_load_dwordx4 v81, s[8:11], s29 offen lds
  ds_read_b64_tr_b16 v[132:133], v101 offset:32
  ds_read_b64_tr_b16 v[134:135], v101 offset:4640
  v_mfma_f32_16x16x32_bf16 v[216:219], v[140:143], v[40:43], v[216:219]
  v_mfma_f32_16x16x32_bf16 v[220:223], v[140:143], v[44:47], v[220:223]
  ds_read_b64_tr_b16 v[136:137], v101 offset:64
  ds_read_b64_tr_b16 v[138:139], v101 offset:4672
  s_waitcnt lgkmcnt(10)
  v_mfma_f32_16x16x32_bf16 v[224:227], v[112:115], v[40:43], v[224:227]
  v_mfma_f32_16x16x32_bf16 v[228:231], v[112:115], v[44:47], v[228:231]
  s_mov_b32 s29, 663552
  s_add_u32 m0, s28, 112640
  s_nop 0
  buffer_load_dwordx4 v82, s[8:11], s29 offen lds
  ds_read_b64_tr_b16 v[140:141], v101 offset:96
  ds_read_b64_tr_b16 v[142:143], v101 offset:4704
  v_mfma_f32_16x16x32_bf16 v[232:235], v[116:119], v[40:43], v[232:235]
  v_mfma_f32_16x16x32_bf16 v[236:239], v[116:119], v[44:47], v[236:239]
  ds_read_b64_tr_b16 v[112:113], v101 offset:128
  ds_read_b64_tr_b16 v[114:115], v101 offset:4736
  s_waitcnt lgkmcnt(10)
  v_mfma_f32_16x16x32_bf16 v[240:243], v[120:123], v[40:43], v[240:243]
  v_mfma_f32_16x16x32_bf16 v[244:247], v[120:123], v[44:47], v[244:247]
  s_mov_b32 s29, 663552
  s_add_u32 m0, s28, 113664
  s_nop 0
  buffer_load_dwordx4 v83, s[8:11], s29 offen lds
  ds_read_b64_tr_b16 v[116:117], v101 offset:160
  ds_read_b64_tr_b16 v[118:119], v101 offset:4768
  v_mfma_f32_16x16x32_bf16 v[248:251], v[124:127], v[40:43], v[248:251]
  v_mfma_f32_16x16x32_bf16 v[252:255], v[124:127], v[44:47], v[252:255]
  s_movk_i32 s29, 23040
  buffer_load_dwordx4 v[32:35], v96, s[16:19], s29 offen offset:0 sc1
  buffer_load_dwordx4 v[36:39], v97, s[16:19], s29 offen offset:0 sc1
  buffer_load_dwordx4 v[40:43], v96, s[16:19], s29 offen offset:2048 sc1
  buffer_load_dwordx4 v[44:47], v97, s[16:19], s29 offen offset:2048 sc1
  s_waitcnt vmcnt(22)
  ds_read_b64_tr_b16 v[120:121], v101 offset:192
  ds_read_b64_tr_b16 v[122:123], v101 offset:4800
  s_waitcnt lgkmcnt(10)
  v_mfma_f32_16x16x32_bf16 v[184:187], v[128:131], v[48:51], v[184:187]
  v_mfma_f32_16x16x32_bf16 v[188:191], v[128:131], v[52:55], v[188:191]
  s_mov_b32 s29, 663552
  s_add_u32 m0, s28, 114688
  s_mov_b32 exec_hi, 0
  buffer_load_dwordx4 v84, s[8:11], s29 offen lds
  s_mov_b32 exec_hi, -1
  ds_read_b64_tr_b16 v[124:125], v101 offset:224
  ds_read_b64_tr_b16 v[126:127], v101 offset:4832
  v_mfma_f32_16x16x32_bf16 v[192:195], v[132:135], v[48:51], v[192:195]
  v_mfma_f32_16x16x32_bf16 v[196:199], v[132:135], v[52:55], v[196:199]
  ds_read_b64_tr_b16 v[128:129], v101 offset:256
  ds_read_b64_tr_b16 v[130:131], v101 offset:4864
  s_waitcnt lgkmcnt(10)
  v_mfma_f32_16x16x32_bf16 v[200:203], v[136:139], v[48:51], v[200:203]
  v_mfma_f32_16x16x32_bf16 v[204:207], v[136:139], v[52:55], v[204:207]
  ds_read_b64_tr_b16 v[132:133], v101 offset:18432
  ds_read_b64_tr_b16 v[134:135], v101 offset:23040
  v_mfma_f32_16x16x32_bf16 v[208:211], v[140:143], v[48:51], v[208:211]
  v_mfma_f32_16x16x32_bf16 v[212:215], v[140:143], v[52:55], v[212:215]
  ds_read_b64_tr_b16 v[136:137], v101 offset:18464
  ds_read_b64_tr_b16 v[138:139], v101 offset:23072
  s_waitcnt lgkmcnt(10)
  v_mfma_f32_16x16x32_bf16 v[216:219], v[112:115], v[48:51], v[216:219]
  v_mfma_f32_16x16x32_bf16 v[220:223], v[112:115], v[52:55], v[220:223]
  ds_read_b64_tr_b16 v[140:141], v101 offset:18496
  ds_read_b64_tr_b16 v[142:143], v101 offset:23104
  v_mfma_f32_16x16x32_bf16 v[224:227], v[116:119], v[48:51], v[224:227]
  v_mfma_f32_16x16x32_bf16 v[228:231], v[116:119], v[52:55], v[228:231]
  ds_read_b64_tr_b16 v[112:113], v101 offset:18528
  ds_read_b64_tr_b16 v[114:115], v101 offset:23136
  s_waitcnt lgkmcnt(10)
  v_mfma_f32_16x16x32_bf16 v[232:235], v[120:123], v[48:51], v[232:235]
  v_mfma_f32_16x16x32_bf16 v[236:239], v[120:123], v[52:55], v[236:239]
  ds_read_b64_tr_b16 v[116:117], v101 offset:18560
  ds_read_b64_tr_b16 v[118:119], v101 offset:23168
  v_mfma_f32_16x16x32_bf16 v[240:243], v[124:127], v[48:51], v[240:243]
  v_mfma_f32_16x16x32_bf16 v[244:247], v[124:127], v[52:55], v[244:247]
  ds_read_b64_tr_b16 v[120:121], v101 offset:18592
  ds_read_b64_tr_b16 v[122:123], v101 offset:23200
  s_waitcnt lgkmcnt(10)
  v_mfma_f32_16x16x32_bf16 v[248:251], v[128:131], v[48:51], v[248:251]
  v_mfma_f32_16x16x32_bf16 v[252:255], v[128:131], v[52:55], v[252:255]
  s_waitcnt vmcnt(9)
  s_barrier
  ds_read_b64_tr_b16 v[124:125], v101 offset:18624
  ds_read_b64_tr_b16 v[126:127], v101 offset:23232
  v_mfma_f32_16x16x32_bf16 v[184:187], v[132:135], v[56:59], v[184:187]
  v_mfma_f32_16x16x32_bf16 v[188:191], v[132:135], v[60:63], v[188:191]
  ds_read_b64_tr_b16 v[128:129], v101 offset:18656
  ds_read_b64_tr_b16 v[130:131], v101 offset:23264
  s_waitcnt lgkmcnt(10)
  v_mfma_f32_16x16x32_bf16 v[192:195], v[136:139], v[56:59], v[192:195]
  v_mfma_f32_16x16x32_bf16 v[196:199], v[136:139], v[60:63], v[196:199]
  s_mov_b32 s29, 829440
  s_add_u32 m0, s28, 0
  s_nop 0
  buffer_load_dwordx4 v80, s[8:11], s29 offen lds
  ds_read_b64_tr_b16 v[132:133], v101 offset:18688
  ds_read_b64_tr_b16 v[134:135], v101 offset:23296
  v_mfma_f32_16x16x32_bf16 v[200:203], v[140:143], v[56:59], v[200:203]
  v_mfma_f32_16x16x32_bf16 v[204:207], v[140:143], v[60:63], v[204:207]
  ds_read_b64_tr_b16 v[136:137], v102 offset:0
  ds_read_b64_tr_b16 v[138:139], v102 offset:4608
  s_waitcnt lgkmcnt(10)
  v_mfma_f32_16x16x32_bf16 v[208:211], v[112:115], v[56:59], v[208:211]
  v_mfma_f32_16x16x32_bf16 v[212:215], v[112:115], v[60:63], v[212:215]
  s_mov_b32 s29, 829440
  s_add_u32 m0, s28, 1024
  s_nop 0
  buffer_load_dwordx4 v81, s[8:11], s29 offen lds
  ds_read_b64_tr_b16 v[140:141], v102 offset:32
  ds_read_b64_tr_b16 v[142:143], v102 offset:4640
  v_mfma_f32_16x16x32_bf16 v[216:219], v[116:119], v[56:59], v[216:219]
  v_mfma_f32_16x16x32_bf16 v[220:223], v[116:119], v[60:63], v[220:223]
  ds_read_b64_tr_b16 v[112:113], v102 offset:64
  ds_read_b64_tr_b16 v[114:115], v102 offset:4672
  s_waitcnt lgkmcnt(10)
  v_mfma_f32_16x16x32_bf16 v[224:227], v[120:123], v[56:59], v[224:227]
  v_mfma_f32_16x16x32_bf16 v[228:231], v[120:123], v[60:63], v[228:231]
  s_mov_b32 s29, 829440
  s_add_u32 m0, s28, 2048
  s_nop 0
  buffer_load_dwordx4 v82, s[8:11], s29 offen lds
  ds_read_b64_tr_b16 v[116:117], v102 offset:96
  ds_read_b64_tr_b16 v[118:119], v102 offset:4704
  v_mfma_f32_16x16x32_bf16 v[232:235], v[124:127], v[56:59], v[232:235]
  v_mfma_f32_16x16x32_bf16 v[236:239], v[124:127], v[60:63], v[236:239]
  ds_read_b64_tr_b16 v[120:121], v102 offset:128
  ds_read_b64_tr_b16 v[122:123], v102 offset:4736
  s_waitcnt lgkmcnt(10)
  v_mfma_f32_16x16x32_bf16 v[240:243], v[128:131], v[56:59], v[240:243]
  v_mfma_f32_16x16x32_bf16 v[244:247], v[128:131], v[60:63], v[244:247]
  s_mov_b32 s29, 829440
  s_add_u32 m0, s28, 3072
  s_nop 0
  buffer_load_dwordx4 v83, s[8:11], s29 offen lds
  ds_read_b64_tr_b16 v[124:125], v102 offset:160
  ds_read_b64_tr_b16 v[126:127], v102 offset:4768
  v_mfma_f32_16x16x32_bf16 v[248:251], v[132:135], v[56:59], v[248:251]
  v_mfma_f32_16x16x32_bf16 v[252:255], v[132:135], v[60:63], v[252:255]
  s_movk_i32 s29, 27648
  buffer_load_dwordx4 v[48:51], v96, s[16:19], s29 offen offset:0 sc1
  buffer_load_dwordx4 v[52:55], v97, s[16:19], s29 offen offset:0 sc1
  buffer_load_dwordx4 v[56:59], v96, s[16:19], s29 offen offset:2048 sc1
  buffer_load_dwordx4 v[60:63], v97, s[16:19], s29 offen offset:2048 sc1
  ds_read_b64_tr_b16 v[128:129], v102 offset:192
  ds_read_b64_tr_b16 v[130:131], v102 offset:4800
  s_waitcnt lgkmcnt(10)
  v_mfma_f32_16x16x32_bf16 v[184:187], v[136:139], v[64:67], v[184:187]
  v_mfma_f32_16x16x32_bf16 v[188:191], v[136:139], v[68:71], v[188:191]
  s_mov_b32 s29, 829440
  s_add_u32 m0, s28, 4096
  s_mov_b32 exec_hi, 0
  buffer_load_dwordx4 v84, s[8:11], s29 offen lds
  s_mov_b32 exec_hi, -1
  ds_read_b64_tr_b16 v[132:133], v102 offset:224
  ds_read_b64_tr_b16 v[134:135], v102 offset:4832
  v_mfma_f32_16x16x32_bf16 v[192:195], v[140:143], v[64:67], v[192:195]
  v_mfma_f32_16x16x32_bf16 v[196:199], v[140:143], v[68:71], v[196:199]
  ds_read_b64_tr_b16 v[136:137], v102 offset:256
  ds_read_b64_tr_b16 v[138:139], v102 offset:4864
  s_waitcnt lgkmcnt(10)
  v_mfma_f32_16x16x32_bf16 v[200:203], v[112:115], v[64:67], v[200:203]
  v_mfma_f32_16x16x32_bf16 v[204:207], v[112:115], v[68:71], v[204:207]
  ds_read_b64_tr_b16 v[140:141], v102 offset:18432
  ds_read_b64_tr_b16 v[142:143], v102 offset:23040
  v_mfma_f32_16x16x32_bf16 v[208:211], v[116:119], v[64:67], v[208:211]
  v_mfma_f32_16x16x32_bf16 v[212:215], v[116:119], v[68:71], v[212:215]
  ds_read_b64_tr_b16 v[112:113], v102 offset:18464
  ds_read_b64_tr_b16 v[114:115], v102 offset:23072
  s_waitcnt lgkmcnt(10)
  v_mfma_f32_16x16x32_bf16 v[216:219], v[120:123], v[64:67], v[216:219]
  v_mfma_f32_16x16x32_bf16 v[220:223], v[120:123], v[68:71], v[220:223]
  ds_read_b64_tr_b16 v[116:117], v102 offset:18496
  ds_read_b64_tr_b16 v[118:119], v102 offset:23104
  v_mfma_f32_16x16x32_bf16 v[224:227], v[124:127], v[64:67], v[224:227]
  v_mfma_f32_16x16x32_bf16 v[228:231], v[124:127], v[68:71], v[228:231]
  ds_read_b64_tr_b16 v[120:121], v102 offset:18528
  ds_read_b64_tr_b16 v[122:123], v102 offset:23136
  s_waitcnt lgkmcnt(10)
  v_mfma_f32_16x16x32_bf16 v[232:235], v[128:131], v[64:67], v[232:235]
  v_mfma_f32_16x16x32_bf16 v[236:239], v[128:131], v[68:71], v[236:239]
  ds_read_b64_tr_b16 v[124:125], v102 offset:18560
  ds_read_b64_tr_b16 v[126:127], v102 offset:23168
  v_mfma_f32_16x16x32_bf16 v[240:243], v[132:135], v[64:67], v[240:243]
  v_mfma_f32_16x16x32_bf16 v[244:247], v[132:135], v[68:71], v[244:247]
  ds_read_b64_tr_b16 v[128:129], v102 offset:18592
  ds_read_b64_tr_b16 v[130:131], v102 offset:23200
  s_waitcnt lgkmcnt(10)
  v_mfma_f32_16x16x32_bf16 v[248:251], v[136:139], v[64:67], v[248:251]
  v_mfma_f32_16x16x32_bf16 v[252:255], v[136:139], v[68:71], v[252:255]
  s_waitcnt vmcnt(9)
  s_barrier
  ds_read_b64_tr_b16 v[132:133], v102 offset:18624
  ds_read_b64_tr_b16 v[134:135], v102 offset:23232
  v_mfma_f32_16x16x32_bf16 v[184:187], v[140:143], v[72:75], v[184:187]
  v_mfma_f32_16x16x32_bf16 v[188:191], v[140:143], v[76:79], v[188:191]
  ds_read_b64_tr_b16 v[136:137], v102 offset:18656
  ds_read_b64_tr_b16 v[138:139], v102 offset:23264
  s_waitcnt lgkmcnt(10)
  v_mfma_f32_16x16x32_bf16 v[192:195], v[112:115], v[72:75], v[192:195]
  v_mfma_f32_16x16x32_bf16 v[196:199], v[112:115], v[76:79], v[196:199]
  s_mov_b32 s29, 995328
  s_add_u32 m0, s28, 36864
  s_nop 0
  buffer_load_dwordx4 v80, s[8:11], s29 offen lds
  ds_read_b64_tr_b16 v[140:141], v102 offset:18688
  ds_read_b64_tr_b16 v[142:143], v102 offset:23296
  v_mfma_f32_16x16x32_bf16 v[200:203], v[116:119], v[72:75], v[200:203]
  v_mfma_f32_16x16x32_bf16 v[204:207], v[116:119], v[76:79], v[204:207]
  ds_read_b64_tr_b16 v[112:113], v103 offset:0
  ds_read_b64_tr_b16 v[114:115], v103 offset:4608
  s_waitcnt lgkmcnt(10)
  v_mfma_f32_16x16x32_bf16 v[208:211], v[120:123], v[72:75], v[208:211]
  v_mfma_f32_16x16x32_bf16 v[212:215], v[120:123], v[76:79], v[212:215]
  s_mov_b32 s29, 995328
  s_add_u32 m0, s28, 37888
  s_nop 0
  buffer_load_dwordx4 v81, s[8:11], s29 offen lds
  ds_read_b64_tr_b16 v[116:117], v103 offset:32
  ds_read_b64_tr_b16 v[118:119], v103 offset:4640
  v_mfma_f32_16x16x32_bf16 v[216:219], v[124:127], v[72:75], v[216:219]
  v_mfma_f32_16x16x32_bf16 v[220:223], v[124:127], v[76:79], v[220:223]
  ds_read_b64_tr_b16 v[120:121], v103 offset:64
  ds_read_b64_tr_b16 v[122:123], v103 offset:4672
  s_waitcnt lgkmcnt(10)
  v_mfma_f32_16x16x32_bf16 v[224:227], v[128:131], v[72:75], v[224:227]
  v_mfma_f32_16x16x32_bf16 v[228:231], v[128:131], v[76:79], v[228:231]
  s_mov_b32 s29, 995328
  s_add_u32 m0, s28, 38912
  s_nop 0
  buffer_load_dwordx4 v82, s[8:11], s29 offen lds
  ds_read_b64_tr_b16 v[124:125], v103 offset:96
  ds_read_b64_tr_b16 v[126:127], v103 offset:4704
  v_mfma_f32_16x16x32_bf16 v[232:235], v[132:135], v[72:75], v[232:235]
  v_mfma_f32_16x16x32_bf16 v[236:239], v[132:135], v[76:79], v[236:239]
  ds_read_b64_tr_b16 v[128:129], v103 offset:128
  ds_read_b64_tr_b16 v[130:131], v103 offset:4736
  s_waitcnt lgkmcnt(10)
  v_mfma_f32_16x16x32_bf16 v[240:243], v[136:139], v[72:75], v[240:243]
  v_mfma_f32_16x16x32_bf16 v[244:247], v[136:139], v[76:79], v[244:247]
  s_mov_b32 s29, 995328
  s_add_u32 m0, s28, 39936
  s_nop 0
  buffer_load_dwordx4 v83, s[8:11], s29 offen lds
  ds_read_b64_tr_b16 v[132:133], v103 offset:160
  ds_read_b64_tr_b16 v[134:135], v103 offset:4768
  v_mfma_f32_16x16x32_bf16 v[248:251], v[140:143], v[72:75], v[248:251]
  v_mfma_f32_16x16x32_bf16 v[252:255], v[140:143], v[76:79], v[252:255]
  s_movk_i32 s29, 32256
  buffer_load_dwordx4 v[64:67], v96, s[16:19], s29 offen offset:0 sc1
  buffer_load_dwordx4 v[68:71], v97, s[16:19], s29 offen offset:0 sc1
  buffer_load_dwordx4 v[72:75], v96, s[16:19], s29 offen offset:2048 sc1
  buffer_load_dwordx4 v[76:79], v97, s[16:19], s29 offen offset:2048 sc1
  ds_read_b64_tr_b16 v[136:137], v103 offset:192
  ds_read_b64_tr_b16 v[138:139], v103 offset:4800
  s_waitcnt lgkmcnt(10)
  v_mfma_f32_16x16x32_bf16 v[184:187], v[112:115], v[16:19], v[184:187]
  v_mfma_f32_16x16x32_bf16 v[188:191], v[112:115], v[20:23], v[188:191]
  s_mov_b32 s29, 995328
  s_add_u32 m0, s28, 40960
  s_mov_b32 exec_hi, 0
  buffer_load_dwordx4 v84, s[8:11], s29 offen lds
  s_mov_b32 exec_hi, -1
  ds_read_b64_tr_b16 v[140:141], v103 offset:224
  ds_read_b64_tr_b16 v[142:143], v103 offset:4832
  v_mfma_f32_16x16x32_bf16 v[192:195], v[116:119], v[16:19], v[192:195]
  v_mfma_f32_16x16x32_bf16 v[196:199], v[116:119], v[20:23], v[196:199]
  ds_read_b64_tr_b16 v[112:113], v103 offset:256
  ds_read_b64_tr_b16 v[114:115], v103 offset:4864
  s_waitcnt lgkmcnt(10)
  v_mfma_f32_16x16x32_bf16 v[200:203], v[120:123], v[16:19], v[200:203]
  v_mfma_f32_16x16x32_bf16 v[204:207], v[120:123], v[20:23], v[204:207]
  ds_read_b64_tr_b16 v[116:117], v103 offset:18432
  ds_read_b64_tr_b16 v[118:119], v103 offset:23040
  v_mfma_f32_16x16x32_bf16 v[208:211], v[124:127], v[16:19], v[208:211]
  v_mfma_f32_16x16x32_bf16 v[212:215], v[124:127], v[20:23], v[212:215]
  ds_read_b64_tr_b16 v[120:121], v103 offset:18464
  ds_read_b64_tr_b16 v[122:123], v103 offset:23072
  s_waitcnt lgkmcnt(10)
  v_mfma_f32_16x16x32_bf16 v[216:219], v[128:131], v[16:19], v[216:219]
  v_mfma_f32_16x16x32_bf16 v[220:223], v[128:131], v[20:23], v[220:223]
  ds_read_b64_tr_b16 v[124:125], v103 offset:18496
  ds_read_b64_tr_b16 v[126:127], v103 offset:23104
  v_mfma_f32_16x16x32_bf16 v[224:227], v[132:135], v[16:19], v[224:227]
  v_mfma_f32_16x16x32_bf16 v[228:231], v[132:135], v[20:23], v[228:231]
  ds_read_b64_tr_b16 v[128:129], v103 offset:18528
  ds_read_b64_tr_b16 v[130:131], v103 offset:23136
  s_waitcnt lgkmcnt(10)
  v_mfma_f32_16x16x32_bf16 v[232:235], v[136:139], v[16:19], v[232:235]
  v_mfma_f32_16x16x32_bf16 v[236:239], v[136:139], v[20:23], v[236:239]
  ds_read_b64_tr_b16 v[132:133], v103 offset:18560
  ds_read_b64_tr_b16 v[134:135], v103 offset:23168
  v_mfma_f32_16x16x32_bf16 v[240:243], v[140:143], v[16:19], v[240:243]
  v_mfma_f32_16x16x32_bf16 v[244:247], v[140:143], v[20:23], v[244:247]
  ds_read_b64_tr_b16 v[136:137], v103 offset:18592
  ds_read_b64_tr_b16 v[138:139], v103 offset:23200
  s_waitcnt lgkmcnt(10)
  v_mfma_f32_16x16x32_bf16 v[248:251], v[112:115], v[16:19], v[248:251]
  v_mfma_f32_16x16x32_bf16 v[252:255], v[112:115], v[20:23], v[252:255]
  s_waitcnt vmcnt(9)
  s_barrier
  ds_read_b64_tr_b16 v[140:141], v103 offset:18624
  ds_read_b64_tr_b16 v[142:143], v103 offset:23232
  v_mfma_f32_16x16x32_bf16 v[184:187], v[116:119], v[24:27], v[184:187]
  v_mfma_f32_16x16x32_bf16 v[188:191], v[116:119], v[28:31], v[188:191]
  ds_read_b64_tr_b16 v[112:113], v103 offset:18656
  ds_read_b64_tr_b16 v[114:115], v103 offset:23264
  s_waitcnt lgkmcnt(10)
  v_mfma_f32_16x16x32_bf16 v[192:195], v[120:123], v[24:27], v[192:195]
  v_mfma_f32_16x16x32_bf16 v[196:199], v[120:123], v[28:31], v[196:199]
  s_mov_b32 s29, 1161216
  s_add_u32 m0, s28, 73728
  s_nop 0
  buffer_load_dwordx4 v80, s[8:11], s29 offen lds
  ds_read_b64_tr_b16 v[116:117], v103 offset:18688
  ds_read_b64_tr_b16 v[118:119], v103 offset:23296
  v_mfma_f32_16x16x32_bf16 v[200:203], v[124:127], v[24:27], v[200:203]
  v_mfma_f32_16x16x32_bf16 v[204:207], v[124:127], v[28:31], v[204:207]
  ds_read_b64_tr_b16 v[120:121], v100 offset:0
  ds_read_b64_tr_b16 v[122:123], v100 offset:4608
  s_waitcnt lgkmcnt(10)
  v_mfma_f32_16x16x32_bf16 v[208:211], v[128:131], v[24:27], v[208:211]
  v_mfma_f32_16x16x32_bf16 v[212:215], v[128:131], v[28:31], v[212:215]
  s_mov_b32 s29, 1161216
  s_add_u32 m0, s28, 74752
  s_nop 0
  buffer_load_dwordx4 v81, s[8:11], s29 offen lds
  ds_read_b64_tr_b16 v[124:125], v100 offset:32
  ds_read_b64_tr_b16 v[126:127], v100 offset:4640
  v_mfma_f32_16x16x32_bf16 v[216:219], v[132:135], v[24:27], v[216:219]
  v_mfma_f32_16x16x32_bf16 v[220:223], v[132:135], v[28:31], v[220:223]
  ds_read_b64_tr_b16 v[128:129], v100 offset:64
  ds_read_b64_tr_b16 v[130:131], v100 offset:4672
  s_waitcnt lgkmcnt(10)
  v_mfma_f32_16x16x32_bf16 v[224:227], v[136:139], v[24:27], v[224:227]
  v_mfma_f32_16x16x32_bf16 v[228:231], v[136:139], v[28:31], v[228:231]
  s_mov_b32 s29, 1161216
  s_add_u32 m0, s28, 75776
  s_nop 0
  buffer_load_dwordx4 v82, s[8:11], s29 offen lds
  ds_read_b64_tr_b16 v[132:133], v100 offset:96
  ds_read_b64_tr_b16 v[134:135], v100 offset:4704
  v_mfma_f32_16x16x32_bf16 v[232:235], v[140:143], v[24:27], v[232:235]
  v_mfma_f32_16x16x32_bf16 v[236:239], v[140:143], v[28:31], v[236:239]
  ds_read_b64_tr_b16 v[136:137], v100 offset:128
  ds_read_b64_tr_b16 v[138:139], v100 offset:4736
  s_waitcnt lgkmcnt(10)
  v_mfma_f32_16x16x32_bf16 v[240:243], v[112:115], v[24:27], v[240:243]
  v_mfma_f32_16x16x32_bf16 v[244:247], v[112:115], v[28:31], v[244:247]
  s_mov_b32 s29, 1161216
  s_add_u32 m0, s28, 76800
  s_nop 0
  buffer_load_dwordx4 v83, s[8:11], s29 offen lds
  ds_read_b64_tr_b16 v[140:141], v100 offset:160
  ds_read_b64_tr_b16 v[142:143], v100 offset:4768
  v_mfma_f32_16x16x32_bf16 v[248:251], v[116:119], v[24:27], v[248:251]
  v_mfma_f32_16x16x32_bf16 v[252:255], v[116:119], v[28:31], v[252:255]
  s_movk_i32 s29, 0
  buffer_load_dwordx2 v[16:17], v98, s[16:19], s29 offen sc1
  buffer_load_dwordx2 v[20:21], v99, s[16:19], s29 offen sc1
  s_movk_i32 s29, 4608
  buffer_load_dwordx2 v[18:19], v98, s[16:19], s29 offen sc1
  buffer_load_dwordx2 v[22:23], v99, s[16:19], s29 offen sc1
  s_movk_i32 s29, 18432
  buffer_load_dwordx2 v[24:25], v98, s[16:19], s29 offen sc1
  buffer_load_dwordx2 v[28:29], v99, s[16:19], s29 offen sc1
  s_movk_i32 s29, 23040
  buffer_load_dwordx2 v[26:27], v98, s[16:19], s29 offen sc1
  buffer_load_dwordx2 v[30:31], v99, s[16:19], s29 offen sc1
  ds_read_b64_tr_b16 v[112:113], v100 offset:192
  ds_read_b64_tr_b16 v[114:115], v100 offset:4800
  s_waitcnt lgkmcnt(10)
  v_mfma_f32_16x16x32_bf16 v[184:187], v[120:123], v[32:35], v[184:187]
  v_mfma_f32_16x16x32_bf16 v[188:191], v[120:123], v[36:39], v[188:191]
  s_mov_b32 s29, 1161216
  s_add_u32 m0, s28, 77824
  s_mov_b32 exec_hi, 0
  buffer_load_dwordx4 v84, s[8:11], s29 offen lds
  s_mov_b32 exec_hi, -1
  ds_read_b64_tr_b16 v[116:117], v100 offset:224
  ds_read_b64_tr_b16 v[118:119], v100 offset:4832
  v_mfma_f32_16x16x32_bf16 v[192:195], v[124:127], v[32:35], v[192:195]
  v_mfma_f32_16x16x32_bf16 v[196:199], v[124:127], v[36:39], v[196:199]
  ds_read_b64_tr_b16 v[120:121], v100 offset:256
  ds_read_b64_tr_b16 v[122:123], v100 offset:4864
  s_waitcnt lgkmcnt(10)
  v_mfma_f32_16x16x32_bf16 v[200:203], v[128:131], v[32:35], v[200:203]
  v_mfma_f32_16x16x32_bf16 v[204:207], v[128:131], v[36:39], v[204:207]
  ds_read_b64_tr_b16 v[124:125], v100 offset:18432
  ds_read_b64_tr_b16 v[126:127], v100 offset:23040
  v_mfma_f32_16x16x32_bf16 v[208:211], v[132:135], v[32:35], v[208:211]
  v_mfma_f32_16x16x32_bf16 v[212:215], v[132:135], v[36:39], v[212:215]
  ds_read_b64_tr_b16 v[128:129], v100 offset:18464
  ds_read_b64_tr_b16 v[130:131], v100 offset:23072
  s_waitcnt lgkmcnt(10)
  v_mfma_f32_16x16x32_bf16 v[216:219], v[136:139], v[32:35], v[216:219]
  v_mfma_f32_16x16x32_bf16 v[220:223], v[136:139], v[36:39], v[220:223]
  ds_read_b64_tr_b16 v[132:133], v100 offset:18496
  ds_read_b64_tr_b16 v[134:135], v100 offset:23104
  v_mfma_f32_16x16x32_bf16 v[224:227], v[140:143], v[32:35], v[224:227]
  v_mfma_f32_16x16x32_bf16 v[228:231], v[140:143], v[36:39], v[228:231]
  ds_read_b64_tr_b16 v[136:137], v100 offset:18528
  ds_read_b64_tr_b16 v[138:139], v100 offset:23136
  s_waitcnt lgkmcnt(10)
  v_mfma_f32_16x16x32_bf16 v[232:235], v[112:115], v[32:35], v[232:235]
  v_mfma_f32_16x16x32_bf16 v[236:239], v[112:115], v[36:39], v[236:239]
  ds_read_b64_tr_b16 v[140:141], v100 offset:18560
  ds_read_b64_tr_b16 v[142:143], v100 offset:23168
  v_mfma_f32_16x16x32_bf16 v[240:243], v[116:119], v[32:35], v[240:243]
  v_mfma_f32_16x16x32_bf16 v[244:247], v[116:119], v[36:39], v[244:247]
  ds_read_b64_tr_b16 v[112:113], v100 offset:18592
  ds_read_b64_tr_b16 v[114:115], v100 offset:23200
  s_waitcnt lgkmcnt(10)
  v_mfma_f32_16x16x32_bf16 v[248:251], v[120:123], v[32:35], v[248:251]
  v_mfma_f32_16x16x32_bf16 v[252:255], v[120:123], v[36:39], v[252:255]
  s_waitcnt vmcnt(13)
  s_barrier
  ds_read_b64_tr_b16 v[116:117], v100 offset:18624
  ds_read_b64_tr_b16 v[118:119], v100 offset:23232
  v_mfma_f32_16x16x32_bf16 v[184:187], v[124:127], v[40:43], v[184:187]
  v_mfma_f32_16x16x32_bf16 v[188:191], v[124:127], v[44:47], v[188:191]
  ds_read_b64_tr_b16 v[120:121], v100 offset:18656
  ds_read_b64_tr_b16 v[122:123], v100 offset:23264
  s_waitcnt lgkmcnt(10)
  v_mfma_f32_16x16x32_bf16 v[192:195], v[128:131], v[40:43], v[192:195]
  v_mfma_f32_16x16x32_bf16 v[196:199], v[128:131], v[44:47], v[196:199]
  s_mul_i32 s24, s3, 288
  s_movk_i32 s26, 3641
  s_movk_i32 s27, 1152
  v_add_u32 v3, 0, v2
  v_add_u32 v3, s24, v3
  v_mul_lo_u32 v4, v3, s26
  v_lshrrev_b32 v4, 16, v4
  v_mul_u32_u24 v5, 18, v4
  v_sub_u32 v5, v3, v5
  v_lshrrev_b32 v6, 4, v4
  v_and_b32 v4, 15, v4
  v_mul_u32_u24 v6, 144, v6
  v_add3_u32 v4, v4, v6, 64
  v_add_u32 v4, 64, v4
  v_mul_lo_u32 v4, v4, s27
  v_lshl_add_u32 v4, v5, 4, v4
  v_add_u32 v80, s82, v4
  v_add_u32 v3, 64, v2
  v_add_u32 v3, s24, v3
  v_mul_lo_u32 v4, v3, s26
  v_lshrrev_b32 v4, 16, v4
  v_mul_u32_u24 v5, 18, v4
  v_sub_u32 v5, v3, v5
  v_lshrrev_b32 v6, 4, v4
  v_and_b32 v4, 15, v4
  v_mul_u32_u24 v6, 144, v6
  v_add3_u32 v4, v4, v6, 64
  v_add_u32 v4, 64, v4
  v_mul_lo_u32 v4, v4, s27
  v_lshl_add_u32 v4, v5, 4, v4
  v_add_u32 v81, s82, v4
  v_add_u32 v3, 128, v2
  v_add_u32 v3, s24, v3
  v_mul_lo_u32 v4, v3, s26
  v_lshrrev_b32 v4, 16, v4
  v_mul_u32_u24 v5, 18, v4
  v_sub_u32 v5, v3, v5
  v_lshrrev_b32 v6, 4, v4
  v_and_b32 v4, 15, v4
  v_mul_u32_u24 v6, 144, v6
  v_add3_u32 v4, v4, v6, 64
  v_add_u32 v4, 64, v4
  v_mul_lo_u32 v4, v4, s27
  v_lshl_add_u32 v4, v5, 4, v4
  v_add_u32 v82, s82, v4
  v_add_u32 v3, 192, v2
  v_add_u32 v3, s24, v3
  v_mul_lo_u32 v4, v3, s26
  v_lshrrev_b32 v4, 16, v4
  v_mul_u32_u24 v5, 18, v4
  v_sub_u32 v5, v3, v5
  v_lshrrev_b32 v6, 4, v4
  v_and_b32 v4, 15, v4
  v_mul_u32_u24 v6, 144, v6
  v_add3_u32 v4, v4, v6, 64
  v_add_u32 v4, 64, v4
  v_mul_lo_u32 v4, v4, s27
  v_lshl_add_u32 v4, v5, 4, v4
  v_add_u32 v83, s82, v4
  v_add_u32 v3, 256, v2
  v_add_u32 v3, s24, v3
  v_mul_lo_u32 v4, v3, s26
  v_lshrrev_b32 v4, 16, v4
  v_mul_u32_u24 v5, 18, v4
  v_sub_u32 v5, v3, v5
  v_lshrrev_b32 v6, 4, v4
  v_and_b32 v4, 15, v4
  v_mul_u32_u24 v6, 144, v6
  v_add3_u32 v4, v4, v6, 64
  v_add_u32 v4, 64, v4
  v_mul_lo_u32 v4, v4, s27
  v_lshl_add_u32 v4, v5, 4, v4
  v_add_u32 v84, s82, v4
  s_mov_b32 s29, 0
  s_add_u32 m0, s28, 110592
  s_nop 0
  buffer_load_dwordx4 v80, s[8:11], s29 offen lds
  ds_read_b64_tr_b16 v[124:125], v100 offset:18688
  ds_read_b64_tr_b16 v[126:127], v100 offset:23296
  v_mfma_f32_16x16x32_bf16 v[200:203], v[132:135], v[40:43], v[200:203]
  v_mfma_f32_16x16x32_bf16 v[204:207], v[132:135], v[44:47], v[204:207]
  ds_read_b64_tr_b16 v[128:129], v101 offset:0
  ds_read_b64_tr_b16 v[130:131], v101 offset:4608
  s_waitcnt lgkmcnt(10)
  v_mfma_f32_16x16x32_bf16 v[208:211], v[136:139], v[40:43], v[208:211]
  v_mfma_f32_16x16x32_bf16 v[212:215], v[136:139], v[44:47], v[212:215]
  s_mov_b32 s29, 0
  s_add_u32 m0, s28, 111616
  s_nop 0
  buffer_load_dwordx4 v81, s[8:11], s29 offen lds
  ds_read_b64_tr_b16 v[132:133], v101 offset:32
  ds_read_b64_tr_b16 v[134:135], v101 offset:4640
  v_mfma_f32_16x16x32_bf16 v[216:219], v[140:143], v[40:43], v[216:219]
  v_mfma_f32_16x16x32_bf16 v[220:223], v[140:143], v[44:47], v[220:223]
  ds_read_b64_tr_b16 v[136:137], v101 offset:64
  ds_read_b64_tr_b16 v[138:139], v101 offset:4672
  s_waitcnt lgkmcnt(10)
  v_mfma_f32_16x16x32_bf16 v[224:227], v[112:115], v[40:43], v[224:227]
  v_mfma_f32_16x16x32_bf16 v[228:231], v[112:115], v[44:47], v[228:231]
  s_mov_b32 s29, 0
  s_add_u32 m0, s28, 112640
  s_nop 0
  buffer_load_dwordx4 v82, s[8:11], s29 offen lds
  ds_read_b64_tr_b16 v[140:141], v101 offset:96
  ds_read_b64_tr_b16 v[142:143], v101 offset:4704
  v_mfma_f32_16x16x32_bf16 v[232:235], v[116:119], v[40:43], v[232:235]
  v_mfma_f32_16x16x32_bf16 v[236:239], v[116:119], v[44:47], v[236:239]
  ds_read_b64_tr_b16 v[112:113], v101 offset:128
  ds_read_b64_tr_b16 v[114:115], v101 offset:4736
  s_waitcnt lgkmcnt(10)
  v_mfma_f32_16x16x32_bf16 v[240:243], v[120:123], v[40:43], v[240:243]
  v_mfma_f32_16x16x32_bf16 v[244:247], v[120:123], v[44:47], v[244:247]
  s_mov_b32 s29, 0
  s_add_u32 m0, s28, 113664
  s_nop 0
  buffer_load_dwordx4 v83, s[8:11], s29 offen lds
  ds_read_b64_tr_b16 v[116:117], v101 offset:160
  ds_read_b64_tr_b16 v[118:119], v101 offset:4768
  v_mfma_f32_16x16x32_bf16 v[248:251], v[124:127], v[40:43], v[248:251]
  v_mfma_f32_16x16x32_bf16 v[252:255], v[124:127], v[44:47], v[252:255]
  ds_read_b64_tr_b16 v[120:121], v101 offset:192
  ds_read_b64_tr_b16 v[122:123], v101 offset:4800
  s_waitcnt lgkmcnt(10)
  v_mfma_f32_16x16x32_bf16 v[184:187], v[128:131], v[48:51], v[184:187]
  v_mfma_f32_16x16x32_bf16 v[188:191], v[128:131], v[52:55], v[188:191]
  s_mov_b32 s29, 0
  s_add_u32 m0, s28, 114688
  s_mov_b32 exec_hi, 0
  buffer_load_dwordx4 v84, s[8:11], s29 offen lds
  s_mov_b32 exec_hi, -1
  ds_read_b64_tr_b16 v[124:125], v101 offset:224
  ds_read_b64_tr_b16 v[126:127], v101 offset:4832
  v_mfma_f32_16x16x32_bf16 v[192:195], v[132:135], v[48:51], v[192:195]
  v_mfma_f32_16x16x32_bf16 v[196:199], v[132:135], v[52:55], v[196:199]
  ds_read_b64_tr_b16 v[128:129], v101 offset:256
  ds_read_b64_tr_b16 v[130:131], v101 offset:4864
  s_waitcnt lgkmcnt(10)
  v_mfma_f32_16x16x32_bf16 v[200:203], v[136:139], v[48:51], v[200:203]
  v_mfma_f32_16x16x32_bf16 v[204:207], v[136:139], v[52:55], v[204:207]
  ds_read_b64_tr_b16 v[132:133], v101 offset:18432
  ds_read_b64_tr_b16 v[134:135], v101 offset:23040
  v_mfma_f32_16x16x32_bf16 v[208:211], v[140:143], v[48:51], v[208:211]
  v_mfma_f32_16x16x32_bf16 v[212:215], v[140:143], v[52:55], v[212:215]
  ds_read_b64_tr_b16 v[136:137], v101 offset:18464
  ds_read_b64_tr_b16 v[138:139], v101 offset:23072
  s_waitcnt lgkmcnt(10)
  v_mfma_f32_16x16x32_bf16 v[216:219], v[112:115], v[48:51], v[216:219]
  v_mfma_f32_16x16x32_bf16 v[220:223], v[112:115], v[52:55], v[220:223]
  ds_read_b64_tr_b16 v[140:141], v101 offset:18496
  ds_read_b64_tr_b16 v[142:143], v101 offset:23104
  v_mfma_f32_16x16x32_bf16 v[224:227], v[116:119], v[48:51], v[224:227]
  v_mfma_f32_16x16x32_bf16 v[228:231], v[116:119], v[52:55], v[228:231]
  ds_read_b64_tr_b16 v[112:113], v101 offset:18528
  ds_read_b64_tr_b16 v[114:115], v101 offset:23136
  s_waitcnt lgkmcnt(10)
  v_mfma_f32_16x16x32_bf16 v[232:235], v[120:123], v[48:51], v[232:235]
  v_mfma_f32_16x16x32_bf16 v[236:239], v[120:123], v[52:55], v[236:239]
  ds_read_b64_tr_b16 v[116:117], v101 offset:18560
  ds_read_b64_tr_b16 v[118:119], v101 offset:23168
  v_mfma_f32_16x16x32_bf16 v[240:243], v[124:127], v[48:51], v[240:243]
  v_mfma_f32_16x16x32_bf16 v[244:247], v[124:127], v[52:55], v[244:247]
  ds_read_b64_tr_b16 v[120:121], v101 offset:18592
  ds_read_b64_tr_b16 v[122:123], v101 offset:23200
  s_waitcnt lgkmcnt(10)
  v_mfma_f32_16x16x32_bf16 v[248:251], v[128:131], v[48:51], v[248:251]
  v_mfma_f32_16x16x32_bf16 v[252:255], v[128:131], v[52:55], v[252:255]
  s_waitcnt vmcnt(5)
  s_barrier
  ds_read_b64_tr_b16 v[124:125], v101 offset:18624
  ds_read_b64_tr_b16 v[126:127], v101 offset:23232
  v_mfma_f32_16x16x32_bf16 v[184:187], v[132:135], v[56:59], v[184:187]
  v_mfma_f32_16x16x32_bf16 v[188:191], v[132:135], v[60:63], v[188:191]
  ds_read_b64_tr_b16 v[128:129], v101 offset:18656
  ds_read_b64_tr_b16 v[130:131], v101 offset:23264
  s_waitcnt lgkmcnt(10)
  v_mfma_f32_16x16x32_bf16 v[192:195], v[136:139], v[56:59], v[192:195]
  v_mfma_f32_16x16x32_bf16 v[196:199], v[136:139], v[60:63], v[196:199]
  ds_read_b64_tr_b16 v[132:133], v101 offset:18688
  ds_read_b64_tr_b16 v[134:135], v101 offset:23296
  v_mfma_f32_16x16x32_bf16 v[200:203], v[140:143], v[56:59], v[200:203]
  v_mfma_f32_16x16x32_bf16 v[204:207], v[140:143], v[60:63], v[204:207]
  ds_read_b64_tr_b16 v[136:137], v102 offset:0
  ds_read_b64_tr_b16 v[138:139], v102 offset:4608
  s_waitcnt lgkmcnt(10)
  v_mfma_f32_16x16x32_bf16 v[208:211], v[112:115], v[56:59], v[208:211]
  v_mfma_f32_16x16x32_bf16 v[212:215], v[112:115], v[60:63], v[212:215]
  ds_read_b64_tr_b16 v[140:141], v102 offset:32
  ds_read_b64_tr_b16 v[142:143], v102 offset:4640
  v_mfma_f32_16x16x32_bf16 v[216:219], v[116:119], v[56:59], v[216:219]
  v_mfma_f32_16x16x32_bf16 v[220:223], v[116:119], v[60:63], v[220:223]
  ds_read_b64_tr_b16 v[112:113], v102 offset:64
  ds_read_b64_tr_b16 v[114:115], v102 offset:4672
  s_waitcnt lgkmcnt(10)
  v_mfma_f32_16x16x32_bf16 v[224:227], v[120:123], v[56:59], v[224:227]
  v_mfma_f32_16x16x32_bf16 v[228:231], v[120:123], v[60:63], v[228:231]
  ds_read_b64_tr_b16 v[116:117], v102 offset:96
  ds_read_b64_tr_b16 v[118:119], v102 offset:4704
  v_mfma_f32_16x16x32_bf16 v[232:235], v[124:127], v[56:59], v[232:235]
  v_mfma_f32_16x16x32_bf16 v[236:239], v[124:127], v[60:63], v[236:239]
  ds_read_b64_tr_b16 v[120:121], v102 offset:128
  ds_read_b64_tr_b16 v[122:123], v102 offset:4736
  s_waitcnt lgkmcnt(10)
  v_mfma_f32_16x16x32_bf16 v[240:243], v[128:131], v[56:59], v[240:243]
  v_mfma_f32_16x16x32_bf16 v[244:247], v[128:131], v[60:63], v[244:247]
  ds_read_b64_tr_b16 v[124:125], v102 offset:160
  ds_read_b64_tr_b16 v[126:127], v102 offset:4768
  v_mfma_f32_16x16x32_bf16 v[248:251], v[132:135], v[56:59], v[248:251]
  v_mfma_f32_16x16x32_bf16 v[252:255], v[132:135], v[60:63], v[252:255]
  ds_read_b64_tr_b16 v[128:129], v102 offset:192
  ds_read_b64_tr_b16 v[130:131], v102 offset:4800
  s_waitcnt lgkmcnt(10)
  v_mfma_f32_16x16x32_bf16 v[184:187], v[136:139], v[64:67], v[184:187]
  v_mfma_f32_16x16x32_bf16 v[188:191], v[136:139], v[68:71], v[188:191]
  ds_read_b64_tr_b16 v[132:133], v102 offset:224
  ds_read_b64_tr_b16 v[134:135], v102 offset:4832
  v_mfma_f32_16x16x32_bf16 v[192:195], v[140:143], v[64:67], v[192:195]
  v_mfma_f32_16x16x32_bf16 v[196:199], v[140:143], v[68:71], v[196:199]
  ds_read_b64_tr_b16 v[136:137], v102 offset:256
  ds_read_b64_tr_b16 v[138:139], v102 offset:4864
  s_waitcnt lgkmcnt(10)
  v_mfma_f32_16x16x32_bf16 v[200:203], v[112:115], v[64:67], v[200:203]
  v_mfma_f32_16x16x32_bf16 v[204:207], v[112:115], v[68:71], v[204:207]
  ds_read_b64_tr_b16 v[140:141], v102 offset:18432
  ds_read_b64_tr_b16 v[142:143], v102 offset:23040
  v_mfma_f32_16x16x32_bf16 v[208:211], v[116:119], v[64:67], v[208:211]
  v_mfma_f32_16x16x32_bf16 v[212:215], v[116:119], v[68:71], v[212:215]
  ds_read_b64_tr_b16 v[112:113], v102 offset:18464
  ds_read_b64_tr_b16 v[114:115], v102 offset:23072
  s_waitcnt lgkmcnt(10)
  v_mfma_f32_16x16x32_bf16 v[216:219], v[120:123], v[64:67], v[216:219]
  v_mfma_f32_16x16x32_bf16 v[220:223], v[120:123], v[68:71], v[220:223]
  ds_read_b64_tr_b16 v[116:117], v102 offset:18496
  ds_read_b64_tr_b16 v[118:119], v102 offset:23104
  v_mfma_f32_16x16x32_bf16 v[224:227], v[124:127], v[64:67], v[224:227]
  v_mfma_f32_16x16x32_bf16 v[228:231], v[124:127], v[68:71], v[228:231]
  ds_read_b64_tr_b16 v[120:121], v102 offset:18528
  ds_read_b64_tr_b16 v[122:123], v102 offset:23136
  s_waitcnt lgkmcnt(10)
  v_mfma_f32_16x16x32_bf16 v[232:235], v[128:131], v[64:67], v[232:235]
  v_mfma_f32_16x16x32_bf16 v[236:239], v[128:131], v[68:71], v[236:239]
  ds_read_b64_tr_b16 v[124:125], v102 offset:18560
  ds_read_b64_tr_b16 v[126:127], v102 offset:23168
  v_mfma_f32_16x16x32_bf16 v[240:243], v[132:135], v[64:67], v[240:243]
  v_mfma_f32_16x16x32_bf16 v[244:247], v[132:135], v[68:71], v[244:247]
  ds_read_b64_tr_b16 v[128:129], v102 offset:18592
  ds_read_b64_tr_b16 v[130:131], v102 offset:23200
  s_waitcnt lgkmcnt(10)
  v_mfma_f32_16x16x32_bf16 v[248:251], v[136:139], v[64:67], v[248:251]
  v_mfma_f32_16x16x32_bf16 v[252:255], v[136:139], v[68:71], v[252:255]
  s_waitcnt vmcnt(0)
  s_barrier
  ds_read_b64_tr_b16 v[132:133], v102 offset:18624
  ds_read_b64_tr_b16 v[134:135], v102 offset:23232
  v_mfma_f32_16x16x32_bf16 v[184:187], v[140:143], v[72:75], v[184:187]
  v_mfma_f32_16x16x32_bf16 v[188:191], v[140:143], v[76:79], v[188:191]
  ds_read_b64_tr_b16 v[136:137], v102 offset:18656
  ds_read_b64_tr_b16 v[138:139], v102 offset:23264
  s_waitcnt lgkmcnt(10)
  v_mfma_f32_16x16x32_bf16 v[192:195], v[112:115], v[72:75], v[192:195]
  v_mfma_f32_16x16x32_bf16 v[196:199], v[112:115], v[76:79], v[196:199]
  ds_read_b64_tr_b16 v[140:141], v102 offset:18688
  ds_read_b64_tr_b16 v[142:143], v102 offset:23296
  v_mfma_f32_16x16x32_bf16 v[200:203], v[116:119], v[72:75], v[200:203]
  v_mfma_f32_16x16x32_bf16 v[204:207], v[116:119], v[76:79], v[204:207]
  ds_read_b64_tr_b16 v[112:113], v103 offset:0
  ds_read_b64_tr_b16 v[114:115], v103 offset:4608
  s_waitcnt lgkmcnt(10)
  v_mfma_f32_16x16x32_bf16 v[208:211], v[120:123], v[72:75], v[208:211]
  v_mfma_f32_16x16x32_bf16 v[212:215], v[120:123], v[76:79], v[212:215]
  ds_read_b64_tr_b16 v[116:117], v103 offset:32
  ds_read_b64_tr_b16 v[118:119], v103 offset:4640
  v_mfma_f32_16x16x32_bf16 v[216:219], v[124:127], v[72:75], v[216:219]
  v_mfma_f32_16x16x32_bf16 v[220:223], v[124:127], v[76:79], v[220:223]
  ds_read_b64_tr_b16 v[120:121], v103 offset:64
  ds_read_b64_tr_b16 v[122:123], v103 offset:4672
  s_waitcnt lgkmcnt(10)
  v_mfma_f32_16x16x32_bf16 v[224:227], v[128:131], v[72:75], v[224:227]
  v_mfma_f32_16x16x32_bf16 v[228:231], v[128:131], v[76:79], v[228:231]
  ds_read_b64_tr_b16 v[124:125], v103 offset:96
  ds_read_b64_tr_b16 v[126:127], v103 offset:4704
  v_mfma_f32_16x16x32_bf16 v[232:235], v[132:135], v[72:75], v[232:235]
  v_mfma_f32_16x16x32_bf16 v[236:239], v[132:135], v[76:79], v[236:239]
  ds_read_b64_tr_b16 v[128:129], v103 offset:128
  ds_read_b64_tr_b16 v[130:131], v103 offset:4736
  s_waitcnt lgkmcnt(10)
  v_mfma_f32_16x16x32_bf16 v[240:243], v[136:139], v[72:75], v[240:243]
  v_mfma_f32_16x16x32_bf16 v[244:247], v[136:139], v[76:79], v[244:247]
  ds_read_b64_tr_b16 v[132:133], v103 offset:160
  ds_read_b64_tr_b16 v[134:135], v103 offset:4768
  v_mfma_f32_16x16x32_bf16 v[248:251], v[140:143], v[72:75], v[248:251]
  v_mfma_f32_16x16x32_bf16 v[252:255], v[140:143], v[76:79], v[252:255]
  ds_read_b64_tr_b16 v[136:137], v103 offset:192
  ds_read_b64_tr_b16 v[138:139], v103 offset:4800
  s_waitcnt lgkmcnt(10)
  v_mfma_f32_16x16x32_bf16 v[184:187], v[112:115], v[16:19], v[184:187]
  v_mfma_f32_16x16x32_bf16 v[188:191], v[112:115], v[20:23], v[188:191]
  ds_read_b64_tr_b16 v[140:141], v103 offset:224
  ds_read_b64_tr_b16 v[142:143], v103 offset:4832
  v_mfma_f32_16x16x32_bf16 v[192:195], v[116:119], v[16:19], v[192:195]
  v_mfma_f32_16x16x32_bf16 v[196:199], v[116:119], v[20:23], v[196:199]
  ds_read_b64_tr_b16 v[112:113], v103 offset:256
  ds_read_b64_tr_b16 v[114:115], v103 offset:4864
  s_waitcnt lgkmcnt(10)
  v_mfma_f32_16x16x32_bf16 v[200:203], v[120:123], v[16:19], v[200:203]
  v_mfma_f32_16x16x32_bf16 v[204:207], v[120:123], v[20:23], v[204:207]
  ds_read_b64_tr_b16 v[116:117], v103 offset:18432
  ds_read_b64_tr_b16 v[118:119], v103 offset:23040
  v_mfma_f32_16x16x32_bf16 v[208:211], v[124:127], v[16:19], v[208:211]
  v_mfma_f32_16x16x32_bf16 v[212:215], v[124:127], v[20:23], v[212:215]
  ds_read_b64_tr_b16 v[120:121], v103 offset:18464
  ds_read_b64_tr_b16 v[122:123], v103 offset:23072
  s_waitcnt lgkmcnt(10)
  v_mfma_f32_16x16x32_bf16 v[216:219], v[128:131], v[16:19], v[216:219]
  v_mfma_f32_16x16x32_bf16 v[220:223], v[128:131], v[20:23], v[220:223]
  ds_read_b64_tr_b16 v[124:125], v103 offset:18496
  ds_read_b64_tr_b16 v[126:127], v103 offset:23104
  v_mfma_f32_16x16x32_bf16 v[224:227], v[132:135], v[16:19], v[224:227]
  v_mfma_f32_16x16x32_bf16 v[228:231], v[132:135], v[20:23], v[228:231]
  ds_read_b64_tr_b16 v[128:129], v103 offset:18528
  ds_read_b64_tr_b16 v[130:131], v103 offset:23136
  s_waitcnt lgkmcnt(10)
  v_mfma_f32_16x16x32_bf16 v[232:235], v[136:139], v[16:19], v[232:235]
  v_mfma_f32_16x16x32_bf16 v[236:239], v[136:139], v[20:23], v[236:239]
  ds_read_b64_tr_b16 v[132:133], v103 offset:18560
  ds_read_b64_tr_b16 v[134:135], v103 offset:23168
  v_mfma_f32_16x16x32_bf16 v[240:243], v[140:143], v[16:19], v[240:243]
  v_mfma_f32_16x16x32_bf16 v[244:247], v[140:143], v[20:23], v[244:247]
  ds_read_b64_tr_b16 v[136:137], v103 offset:18592
  ds_read_b64_tr_b16 v[138:139], v103 offset:23200
  s_waitcnt lgkmcnt(10)
  v_mfma_f32_16x16x32_bf16 v[248:251], v[112:115], v[16:19], v[248:251]
  v_mfma_f32_16x16x32_bf16 v[252:255], v[112:115], v[20:23], v[252:255]
  ds_read_b64_tr_b16 v[140:141], v103 offset:18624
  ds_read_b64_tr_b16 v[142:143], v103 offset:23232
  v_mfma_f32_16x16x32_bf16 v[184:187], v[116:119], v[24:27], v[184:187]
  v_mfma_f32_16x16x32_bf16 v[188:191], v[116:119], v[28:31], v[188:191]
  ds_read_b64_tr_b16 v[112:113], v103 offset:18656
  ds_read_b64_tr_b16 v[114:115], v103 offset:23264
  s_waitcnt lgkmcnt(10)
  v_mfma_f32_16x16x32_bf16 v[192:195], v[120:123], v[24:27], v[192:195]
  v_mfma_f32_16x16x32_bf16 v[196:199], v[120:123], v[28:31], v[196:199]
  ds_read_b64_tr_b16 v[116:117], v103 offset:18688
  ds_read_b64_tr_b16 v[118:119], v103 offset:23296
  v_mfma_f32_16x16x32_bf16 v[200:203], v[124:127], v[24:27], v[200:203]
  v_mfma_f32_16x16x32_bf16 v[204:207], v[124:127], v[28:31], v[204:207]
  s_waitcnt lgkmcnt(8)
  v_mfma_f32_16x16x32_bf16 v[208:211], v[128:131], v[24:27], v[208:211]
  v_mfma_f32_16x16x32_bf16 v[212:215], v[128:131], v[28:31], v[212:215]
  v_mfma_f32_16x16x32_bf16 v[216:219], v[132:135], v[24:27], v[216:219]
  v_mfma_f32_16x16x32_bf16 v[220:223], v[132:135], v[28:31], v[220:223]
  s_waitcnt lgkmcnt(4)
  v_mfma_f32_16x16x32_bf16 v[224:227], v[136:139], v[24:27], v[224:227]
  v_mfma_f32_16x16x32_bf16 v[228:231], v[136:139], v[28:31], v[228:231]
  v_mfma_f32_16x16x32_bf16 v[232:235], v[140:143], v[24:27], v[232:235]
  v_mfma_f32_16x16x32_bf16 v[236:239], v[140:143], v[28:31], v[236:239]
  s_waitcnt lgkmcnt(0)
  v_mfma_f32_16x16x32_bf16 v[240:243], v[112:115], v[24:27], v[240:243]
  v_mfma_f32_16x16x32_bf16 v[244:247], v[112:115], v[28:31], v[244:247]
  v_mfma_f32_16x16x32_bf16 v[248:251], v[116:119], v[24:27], v[248:251]
  v_mfma_f32_16x16x32_bf16 v[252:255], v[116:119], v[28:31], v[252:255]
  v_mov_b32 v15, v92
  s_mul_i32 s27, s3, 9216
  v_add_u32 v4, s27, v15
  s_xor_b32 s27, s3, 4
  s_mul_i32 s27, s27, 9216
  v_add_u32 v5, s27, v15
  s_add_u32 s16, s80, 26247168
  s_addc_u32 s17, s81, 0
  s_mov_b32 s18, 18874368
  s_mov_b32 s19, 0x00020000
  s_mov_b32 s4, s56
  s_mov_b32 s5, s57
  s_mov_b32 s6, 2359296
  s_mov_b32 s7, 0x00020000
  s_mov_b32 s8, s76
  s_mov_b32 s9, s77
  s_mov_b32 s10, 2359296
  s_mov_b32 s11, 0x00020000
  s_add_u32 s48, s80, 5013504
  s_addc_u32 s49, s81, 0
  s_mov_b32 s50, 2359296
  s_mov_b32 s51, 0x00020000
  s_add_u32 s43, s42, s41
  s_mul_i32 s44, s43, 36864
  s_mul_i32 s29, s31, 9216
  s_add_u32 s44, s44, s29
  s_mul_i32 s27, s20, 4718592
  s_add_u32 s45, s44, s27
  s_lshl_b32 s27, s21, 2
  s_add_u32 s27, s27, s31
  s_lshl_b32 s27, s27, 7
  s_lshl_b32 s29, s3, 4
  s_add_u32 s27, s27, s29
  s_add_u32 s52, s27, 49152
  s_lshl_b32 s27, s20, 2
  s_add_u32 s53, s52, s27
  v_lshrrev_b32 v7, 4, v2
  v_and_b32 v8, 15, v2
  s_lshl_b32 s29, s43, 4
  v_add_u32 v9, s29, v8
  s_movk_i32 s29, 1152
  v_mul_lo_u32 v10, v9, s29
  v_lshl_add_u32 v10, v7, 3, v10
  v_lshlrev_b32 v12, 14, v7
  v_lshl_add_u32 v12, v9, 1, v12
  v_and_b32 v13, 3, v2
  v_lshlrev_b32 v13, 2, v13
  s_nop 2
  s_cmp_eq_u32 s41, 0
  s_cbranch_scc0 p4_kp1
  ds_write_b128 v4, v[188:191] offset:0
  ds_write_b128 v4, v[196:199] offset:1024
  ds_write_b128 v4, v[204:207] offset:2048
  ds_write_b128 v4, v[212:215] offset:3072
  ds_write_b128 v4, v[220:223] offset:4096
  ds_write_b128 v4, v[228:231] offset:5120
  ds_write_b128 v4, v[236:239] offset:6144
  ds_write_b128 v4, v[244:247] offset:7168
  ds_write_b128 v4, v[252:255] offset:8192
  s_waitcnt lgkmcnt(0)
  s_barrier
  ds_read_b128 v[16:19], v5 offset:0
  ds_read_b128 v[20:23], v5 offset:1024
  ds_read_b128 v[24:27], v5 offset:2048
  ds_read_b128 v[28:31], v5 offset:3072
  ds_read_b128 v[32:35], v5 offset:4096
  ds_read_b128 v[36:39], v5 offset:5120
  ds_read_b128 v[40:43], v5 offset:6144
  ds_read_b128 v[44:47], v5 offset:7168
  ds_read_b128 v[48:51], v5 offset:8192
  s_waitcnt lgkmcnt(8)
  v_add_f32 v184, v184, v16
  v_add_f32 v185, v185, v17
  v_add_f32 v186, v186, v18
  v_add_f32 v187, v187, v19
  v_cvt_pk_bf16_f32 v60, v184, v185
  v_cvt_pk_bf16_f32 v61, v186, v187
  s_waitcnt lgkmcnt(7)
  v_add_f32 v192, v192, v20
  v_add_f32 v193, v193, v21
  v_add_f32 v194, v194, v22
  v_add_f32 v195, v195, v23
  v_cvt_pk_bf16_f32 v62, v192, v193
  v_cvt_pk_bf16_f32 v63, v194, v195
  s_cmp_eq_u32 s20, 0
  s_cbranch_scc1 p4_skip0_1
  s_add_u32 s29, s45, 0
  buffer_store_dwordx4 v[60:63], v15, s[16:19], s29 offen sc0 sc1
p4_skip0_1:
  s_waitcnt lgkmcnt(6)
  v_add_f32 v200, v200, v24
  v_add_f32 v201, v201, v25
  v_add_f32 v202, v202, v26
  v_add_f32 v203, v203, v27
  v_cvt_pk_bf16_f32 v64, v200, v201
  v_cvt_pk_bf16_f32 v65, v202, v203
  s_waitcnt lgkmcnt(5)
  v_add_f32 v208, v208, v28
  v_add_f32 v209, v209, v29
  v_add_f32 v210, v210, v30
  v_add_f32 v211, v211, v31
  v_cvt_pk_bf16_f32 v66, v208, v209
  v_cvt_pk_bf16_f32 v67, v210, v211
  s_cmp_eq_u32 s20, 1
  s_cbranch_scc1 p4_skip0_3
  s_add_u32 s29, s45, 1024
  buffer_store_dwordx4 v[64:67], v15, s[16:19], s29 offen sc0 sc1
p4_skip0_3:
  s_waitcnt lgkmcnt(4)
  v_add_f32 v216, v216, v32
  v_add_f32 v217, v217, v33
  v_add_f32 v218, v218, v34
  v_add_f32 v219, v219, v35
  v_cvt_pk_bf16_f32 v68, v216, v217
  v_cvt_pk_bf16_f32 v69, v218, v219
  s_waitcnt lgkmcnt(3)
  v_add_f32 v224, v224, v36
  v_add_f32 v225, v225, v37
  v_add_f32 v226, v226, v38
  v_add_f32 v227, v227, v39
  v_cvt_pk_bf16_f32 v70, v224, v225
  v_cvt_pk_bf16_f32 v71, v226, v227
  s_cmp_eq_u32 s20, 2
  s_cbranch_scc1 p4_skip0_5
  s_add_u32 s29, s45, 2048
  buffer_store_dwordx4 v[68:71], v15, s[16:19], s29 offen sc0 sc1
p4_skip0_5:
  s_waitcnt lgkmcnt(2)
  v_add_f32 v232, v232, v40
  v_add_f32 v233, v233, v41
  v_add_f32 v234, v234, v42
  v_add_f32 v235, v235, v43
  v_cvt_pk_bf16_f32 v72, v232, v233
  v_cvt_pk_bf16_f32 v73, v234, v235
  s_waitcnt lgkmcnt(1)
  v_add_f32 v240, v240, v44
  v_add_f32 v241, v241, v45
  v_add_f32 v242, v242, v46
  v_add_f32 v243, v243, v47
  v_cvt_pk_bf16_f32 v74, v240, v241
  v_cvt_pk_bf16_f32 v75, v242, v243
  s_cmp_eq_u32 s20, 3
  s_cbranch_scc1 p4_skip0_7
  s_add_u32 s29, s45, 3072
  buffer_store_dwordx4 v[72:75], v15, s[16:19], s29 offen sc0 sc1
p4_skip0_7:
  s_waitcnt lgkmcnt(0)
  v_add_f32 v248, v248, v48
  v_add_f32 v249, v249, v49
  v_add_f32 v250, v250, v50
  v_add_f32 v251, v251, v51
  v_cvt_pk_bf16_f32 v76, v248, v249
  v_cvt_pk_bf16_f32 v77, v250, v251
  s_cmp_eq_u32 s20, 3
  s_cbranch_scc1 p4_skip0_8
  s_add_u32 s29, s45, 4096
  buffer_store_dwordx4 v[76:79], v15, s[16:19], s29 offen sc0 sc1
p4_skip0_8:
  s_waitcnt vmcnt(0)
  v_mov_b32 v3, s85
  v_mov_b32 v6, s53
  s_mov_b64 exec, 1
  buffer_store_dword v3, v6, s[32:35], 0 offen sc0 sc1
  s_mov_b64 exec, -1
  s_cmp_eq_u32 s20, 0
  s_cbranch_scc1 p4_fin0_0
  s_cmp_eq_u32 s20, 1
  s_cbranch_scc1 p4_fin0_1
  s_cmp_eq_u32 s20, 2
  s_cbranch_scc1 p4_fin0_2
  s_cmp_eq_u32 s20, 3
  s_cbranch_scc1 p4_fin0_3
p4_fin0_0:
  s_mul_i32 s29, s31, 288
  s_add_u32 s29, s29, 0
  buffer_load_dwordx2 v[16:17], v10, s[4:7], s29 offen
  s_mul_i32 s27, s31, 9
  s_add_u32 s27, s27, 0
  s_lshr_b32 s29, s27, 1
  s_lshl_b32 s29, s29, 10
  s_and_b32 s27, s27, 1
  s_lshl_b32 s27, s27, 3
  s_add_u32 s29, s29, s27
  s_mul_i32 s27, s43, 18432
  s_add_u32 s29, s29, s27
  buffer_load_dwordx2 v[28:29], v15, s[12:15], s29 offen sc1
  s_mul_i32 s29, s31, 288
  s_add_u32 s29, s29, 32
  buffer_load_dwordx2 v[18:19], v10, s[4:7], s29 offen
  s_mul_i32 s27, s31, 9
  s_add_u32 s27, s27, 1
  s_lshr_b32 s29, s27, 1
  s_lshl_b32 s29, s29, 10
  s_and_b32 s27, s27, 1
  s_lshl_b32 s27, s27, 3
  s_add_u32 s29, s29, s27
  s_mul_i32 s27, s43, 18432
  s_add_u32 s29, s29, s27
  buffer_load_dwordx2 v[30:31], v15, s[12:15], s29 offen sc1
  v_lshlrev_b32 v11, 2, v2
  v_min_u32 v11, 124, v11
  s_mul_i32 s54, s31, 576
  s_add_u32 s54, s54, 40960
  s_mov_b32 s55, 0
p4_poll0_0:
  buffer_load_dword v35, v13, s[32:35], s52 offen sc0 sc1
  buffer_load_dword v36, v11, s[32:35], s54 offen sc0 sc1
  s_waitcnt vmcnt(0)
  v_xor_b32 v35, s85, v35
  v_xor_b32 v36, s85, v36
  v_or_b32 v35, v35, v36
  v_cmp_ne_u32 vcc, 0, v35
  s_cmp_eq_u64 vcc, 0
  s_cbranch_scc1 p4_poll0_0_done
  s_add_u32 s55, s55, 1
  s_cmp_ge_u32 s55, 200000
  s_cbranch_scc1 p4_poll0_0_done
  s_sleep 2
  s_branch p4_poll0_0
p4_poll0_0_done:
  s_add_u32 s29, s44, 4718592
  buffer_load_dwordx4 v[40:43], v15, s[16:19], s29 offen sc0 sc1
  s_add_u32 s29, s44, 9437184
  buffer_load_dwordx4 v[44:47], v15, s[16:19], s29 offen sc0 sc1
  s_add_u32 s29, s44, 14155776
  buffer_load_dwordx4 v[48:51], v15, s[16:19], s29 offen sc0 sc1
  s_mul_i32 s27, s31, 589824
  s_add_u32 s29, s27, 0
  buffer_load_ushort v148, v12, s[48:51], s29 offen sc0 sc1
  s_add_u32 s29, s27, 4096
  buffer_load_ushort v149, v12, s[48:51], s29 offen sc0 sc1
  s_add_u32 s29, s27, 8192
  buffer_load_ushort v150, v12, s[48:51], s29 offen sc0 sc1
  s_add_u32 s29, s27, 12288
  buffer_load_ushort v151, v12, s[48:51], s29 offen sc0 sc1
  s_mul_i32 s27, s31, 589824
  s_add_u32 s29, s27, 65536
  buffer_load_ushort v152, v12, s[48:51], s29 offen sc0 sc1
  s_add_u32 s29, s27, 69632
  buffer_load_ushort v153, v12, s[48:51], s29 offen sc0 sc1
  s_add_u32 s29, s27, 73728
  buffer_load_ushort v154, v12, s[48:51], s29 offen sc0 sc1
  s_add_u32 s29, s27, 77824
  buffer_load_ushort v155, v12, s[48:51], s29 offen sc0 sc1
  s_waitcnt vmcnt(8)
  v_lshlrev_b32 v64, 16, v40
  v_and_b32 v65, 0xffff0000, v40
  v_lshlrev_b32 v66, 16, v41
  v_and_b32 v67, 0xffff0000, v41
  v_add_f32 v184, v184, v64
  v_add_f32 v185, v185, v65
  v_add_f32 v186, v186, v66
  v_add_f32 v187, v187, v67
  v_lshlrev_b32 v64, 16, v44
  v_and_b32 v65, 0xffff0000, v44
  v_lshlrev_b32 v66, 16, v45
  v_and_b32 v67, 0xffff0000, v45
  v_add_f32 v184, v184, v64
  v_add_f32 v185, v185, v65
  v_add_f32 v186, v186, v66
  v_add_f32 v187, v187, v67
  v_lshlrev_b32 v64, 16, v48
  v_and_b32 v65, 0xffff0000, v48
  v_lshlrev_b32 v66, 16, v49
  v_and_b32 v67, 0xffff0000, v49
  v_add_f32 v184, v184, v64
  v_add_f32 v185, v185, v65
  v_add_f32 v186, v186, v66
  v_add_f32 v187, v187, v67
  v_cvt_pk_bf16_f32 v14, v184, v185
  v_lshlrev_b32 v184, 16, v14
  v_and_b32 v185, 0xffff0000, v14
  v_cvt_pk_bf16_f32 v14, v186, v187
  v_lshlrev_b32 v186, 16, v14
  v_and_b32 v187, 0xffff0000, v14
  s_waitcnt vmcnt(8)
  v_lshlrev_b32 v64, 16, v42
  v_and_b32 v65, 0xffff0000, v42
  v_lshlrev_b32 v66, 16, v43
  v_and_b32 v67, 0xffff0000, v43
  v_add_f32 v192, v192, v64
  v_add_f32 v193, v193, v65
  v_add_f32 v194, v194, v66
  v_add_f32 v195, v195, v67
  v_lshlrev_b32 v64, 16, v46
  v_and_b32 v65, 0xffff0000, v46
  v_lshlrev_b32 v66, 16, v47
  v_and_b32 v67, 0xffff0000, v47
  v_add_f32 v192, v192, v64
  v_add_f32 v193, v193, v65
  v_add_f32 v194, v194, v66
  v_add_f32 v195, v195, v67
  v_lshlrev_b32 v64, 16, v50
  v_and_b32 v65, 0xffff0000, v50
  v_lshlrev_b32 v66, 16, v51
  v_and_b32 v67, 0xffff0000, v51
  v_add_f32 v192, v192, v64
  v_add_f32 v193, v193, v65
  v_add_f32 v194, v194, v66
  v_add_f32 v195, v195, v67
  v_cvt_pk_bf16_f32 v14, v192, v193
  v_lshlrev_b32 v192, 16, v14
  v_and_b32 v193, 0xffff0000, v14
  v_cvt_pk_bf16_f32 v14, v194, v195
  v_lshlrev_b32 v194, 16, v14
  v_and_b32 v195, 0xffff0000, v14
  s_waitcnt vmcnt(4)
  v_lshlrev_b32 v40, 16, v28
  v_and_b32 v41, 0xffff0000, v28
  v_lshlrev_b32 v42, 16, v29
  v_and_b32 v43, 0xffff0000, v29
  v_lshlrev_b32 v44, 16, v16
  v_and_b32 v45, 0xffff0000, v16
  v_lshlrev_b32 v46, 16, v17
  v_and_b32 v47, 0xffff0000, v17
  v_lshlrev_b32 v148, 16, v148
  v_mul_f32 v40, v40, v148
  v_lshlrev_b32 v149, 16, v149
  v_mul_f32 v41, v41, v149
  v_lshlrev_b32 v150, 16, v150
  v_mul_f32 v42, v42, v150
  v_lshlrev_b32 v151, 16, v151
  v_mul_f32 v43, v43, v151
  v_cvt_pk_bf16_f32 v14, v40, v41
  v_lshlrev_b32 v40, 16, v14
  v_and_b32 v41, 0xffff0000, v14
  v_cvt_pk_bf16_f32 v14, v42, v43
  v_lshlrev_b32 v42, 16, v14
  v_and_b32 v43, 0xffff0000, v14
  v_add_f32 v40, v40, v44
  v_add_f32 v41, v41, v45
  v_add_f32 v42, v42, v46
  v_add_f32 v43, v43, v47
  v_cvt_pk_bf16_f32 v14, v40, v41
  v_lshlrev_b32 v40, 16, v14
  v_and_b32 v41, 0xffff0000, v14
  v_cvt_pk_bf16_f32 v14, v42, v43
  v_lshlrev_b32 v42, 16, v14
  v_and_b32 v43, 0xffff0000, v14
  v_add_f32 v40, v40, v184
  v_add_f32 v41, v41, v185
  v_add_f32 v42, v42, v186
  v_add_f32 v43, v43, v187
  v_cvt_pk_bf16_f32 v184, v40, v41
  v_cvt_pk_bf16_f32 v185, v42, v43
  s_mul_i32 s29, s31, 288
  s_add_u32 s29, s29, 0
  buffer_store_dwordx2 v[184:185], v10, s[8:11], s29 offen
  s_waitcnt vmcnt(1)
  v_lshlrev_b32 v40, 16, v30
  v_and_b32 v41, 0xffff0000, v30
  v_lshlrev_b32 v42, 16, v31
  v_and_b32 v43, 0xffff0000, v31
  v_lshlrev_b32 v44, 16, v18
  v_and_b32 v45, 0xffff0000, v18
  v_lshlrev_b32 v46, 16, v19
  v_and_b32 v47, 0xffff0000, v19
  v_lshlrev_b32 v152, 16, v152
  v_mul_f32 v40, v40, v152
  v_lshlrev_b32 v153, 16, v153
  v_mul_f32 v41, v41, v153
  v_lshlrev_b32 v154, 16, v154
  v_mul_f32 v42, v42, v154
  v_lshlrev_b32 v155, 16, v155
  v_mul_f32 v43, v43, v155
  v_cvt_pk_bf16_f32 v14, v40, v41
  v_lshlrev_b32 v40, 16, v14
  v_and_b32 v41, 0xffff0000, v14
  v_cvt_pk_bf16_f32 v14, v42, v43
  v_lshlrev_b32 v42, 16, v14
  v_and_b32 v43, 0xffff0000, v14
  v_add_f32 v40, v40, v44
  v_add_f32 v41, v41, v45
  v_add_f32 v42, v42, v46
  v_add_f32 v43, v43, v47
  v_cvt_pk_bf16_f32 v14, v40, v41
  v_lshlrev_b32 v40, 16, v14
  v_and_b32 v41, 0xffff0000, v14
  v_cvt_pk_bf16_f32 v14, v42, v43
  v_lshlrev_b32 v42, 16, v14
  v_and_b32 v43, 0xffff0000, v14
  v_add_f32 v40, v40, v192
  v_add_f32 v41, v41, v193
  v_add_f32 v42, v42, v194
  v_add_f32 v43, v43, v195
  v_cvt_pk_bf16_f32 v192, v40, v41
  v_cvt_pk_bf16_f32 v193, v42, v43
  s_mul_i32 s29, s31, 288
  s_add_u32 s29, s29, 32
  buffer_store_dwordx2 v[192:193], v10, s[8:11], s29 offen
  s_endpgm
p4_fin0_1:
  s_mul_i32 s29, s31, 288
  s_add_u32 s29, s29, 64
  buffer_load_dwordx2 v[16:17], v10, s[4:7], s29 offen
  s_mul_i32 s27, s31, 9
  s_add_u32 s27, s27, 2
  s_lshr_b32 s29, s27, 1
  s_lshl_b32 s29, s29, 10
  s_and_b32 s27, s27, 1
  s_lshl_b32 s27, s27, 3
  s_add_u32 s29, s29, s27
  s_mul_i32 s27, s43, 18432
  s_add_u32 s29, s29, s27
  buffer_load_dwordx2 v[28:29], v15, s[12:15], s29 offen sc1
  s_mul_i32 s29, s31, 288
  s_add_u32 s29, s29, 96
  buffer_load_dwordx2 v[18:19], v10, s[4:7], s29 offen
  s_mul_i32 s27, s31, 9
  s_add_u32 s27, s27, 3
  s_lshr_b32 s29, s27, 1
  s_lshl_b32 s29, s29, 10
  s_and_b32 s27, s27, 1
  s_lshl_b32 s27, s27, 3
  s_add_u32 s29, s29, s27
  s_mul_i32 s27, s43, 18432
  s_add_u32 s29, s29, s27
  buffer_load_dwordx2 v[30:31], v15, s[12:15], s29 offen sc1
  v_lshlrev_b32 v11, 2, v2
  v_min_u32 v11, 124, v11
  s_mul_i32 s54, s31, 576
  s_add_u32 s54, s54, 41088
  s_mov_b32 s55, 0
p4_poll0_1:
  buffer_load_dword v35, v13, s[32:35], s52 offen sc0 sc1
  buffer_load_dword v36, v11, s[32:35], s54 offen sc0 sc1
  s_waitcnt vmcnt(0)
  v_xor_b32 v35, s85, v35
  v_xor_b32 v36, s85, v36
  v_or_b32 v35, v35, v36
  v_cmp_ne_u32 vcc, 0, v35
  s_cmp_eq_u64 vcc, 0
  s_cbranch_scc1 p4_poll0_1_done
  s_add_u32 s55, s55, 1
  s_cmp_ge_u32 s55, 200000
  s_cbranch_scc1 p4_poll0_1_done
  s_sleep 2
  s_branch p4_poll0_1
p4_poll0_1_done:
  s_add_u32 s29, s44, 1024
  buffer_load_dwordx4 v[40:43], v15, s[16:19], s29 offen sc0 sc1
  s_add_u32 s29, s44, 9438208
  buffer_load_dwordx4 v[44:47], v15, s[16:19], s29 offen sc0 sc1
  s_add_u32 s29, s44, 14156800
  buffer_load_dwordx4 v[48:51], v15, s[16:19], s29 offen sc0 sc1
  s_mul_i32 s27, s31, 589824
  s_add_u32 s29, s27, 131072
  buffer_load_ushort v148, v12, s[48:51], s29 offen sc0 sc1
  s_add_u32 s29, s27, 135168
  buffer_load_ushort v149, v12, s[48:51], s29 offen sc0 sc1
  s_add_u32 s29, s27, 139264
  buffer_load_ushort v150, v12, s[48:51], s29 offen sc0 sc1
  s_add_u32 s29, s27, 143360
  buffer_load_ushort v151, v12, s[48:51], s29 offen sc0 sc1
  s_mul_i32 s27, s31, 589824
  s_add_u32 s29, s27, 196608
  buffer_load_ushort v152, v12, s[48:51], s29 offen sc0 sc1
  s_add_u32 s29, s27, 200704
  buffer_load_ushort v153, v12, s[48:51], s29 offen sc0 sc1
  s_add_u32 s29, s27, 204800
  buffer_load_ushort v154, v12, s[48:51], s29 offen sc0 sc1
  s_add_u32 s29, s27, 208896
  buffer_load_ushort v155, v12, s[48:51], s29 offen sc0 sc1
  s_waitcnt vmcnt(8)
  v_lshlrev_b32 v64, 16, v40
  v_and_b32 v65, 0xffff0000, v40
  v_lshlrev_b32 v66, 16, v41
  v_and_b32 v67, 0xffff0000, v41
  v_add_f32 v200, v200, v64
  v_add_f32 v201, v201, v65
  v_add_f32 v202, v202, v66
  v_add_f32 v203, v203, v67
  v_lshlrev_b32 v64, 16, v44
  v_and_b32 v65, 0xffff0000, v44
  v_lshlrev_b32 v66, 16, v45
  v_and_b32 v67, 0xffff0000, v45
  v_add_f32 v200, v200, v64
  v_add_f32 v201, v201, v65
  v_add_f32 v202, v202, v66
  v_add_f32 v203, v203, v67
  v_lshlrev_b32 v64, 16, v48
  v_and_b32 v65, 0xffff0000, v48
  v_lshlrev_b32 v66, 16, v49
  v_and_b32 v67, 0xffff0000, v49
  v_add_f32 v200, v200, v64
  v_add_f32 v201, v201, v65
  v_add_f32 v202, v202, v66
  v_add_f32 v203, v203, v67
  v_cvt_pk_bf16_f32 v14, v200, v201
  v_lshlrev_b32 v200, 16, v14
  v_and_b32 v201, 0xffff0000, v14
  v_cvt_pk_bf16_f32 v14, v202, v203
  v_lshlrev_b32 v202, 16, v14
  v_and_b32 v203, 0xffff0000, v14
  s_waitcnt vmcnt(8)
  v_lshlrev_b32 v64, 16, v42
  v_and_b32 v65, 0xffff0000, v42
  v_lshlrev_b32 v66, 16, v43
  v_and_b32 v67, 0xffff0000, v43
  v_add_f32 v208, v208, v64
  v_add_f32 v209, v209, v65
  v_add_f32 v210, v210, v66
  v_add_f32 v211, v211, v67
  v_lshlrev_b32 v64, 16, v46
  v_and_b32 v65, 0xffff0000, v46
  v_lshlrev_b32 v66, 16, v47
  v_and_b32 v67, 0xffff0000, v47
  v_add_f32 v208, v208, v64
  v_add_f32 v209, v209, v65
  v_add_f32 v210, v210, v66
  v_add_f32 v211, v211, v67
  v_lshlrev_b32 v64, 16, v50
  v_and_b32 v65, 0xffff0000, v50
  v_lshlrev_b32 v66, 16, v51
  v_and_b32 v67, 0xffff0000, v51
  v_add_f32 v208, v208, v64
  v_add_f32 v209, v209, v65
  v_add_f32 v210, v210, v66
  v_add_f32 v211, v211, v67
  v_cvt_pk_bf16_f32 v14, v208, v209
  v_lshlrev_b32 v208, 16, v14
  v_and_b32 v209, 0xffff0000, v14
  v_cvt_pk_bf16_f32 v14, v210, v211
  v_lshlrev_b32 v210, 16, v14
  v_and_b32 v211, 0xffff0000, v14
  s_waitcnt vmcnt(4)
  v_lshlrev_b32 v40, 16, v28
  v_and_b32 v41, 0xffff0000, v28
  v_lshlrev_b32 v42, 16, v29
  v_and_b32 v43, 0xffff0000, v29
  v_lshlrev_b32 v44, 16, v16
  v_and_b32 v45, 0xffff0000, v16
  v_lshlrev_b32 v46, 16, v17
  v_and_b32 v47, 0xffff0000, v17
  v_lshlrev_b32 v148, 16, v148
  v_mul_f32 v40, v40, v148
  v_lshlrev_b32 v149, 16, v149
  v_mul_f32 v41, v41, v149
  v_lshlrev_b32 v150, 16, v150
  v_mul_f32 v42, v42, v150
  v_lshlrev_b32 v151, 16, v151
  v_mul_f32 v43, v43, v151
  v_cvt_pk_bf16_f32 v14, v40, v41
  v_lshlrev_b32 v40, 16, v14
  v_and_b32 v41, 0xffff0000, v14
  v_cvt_pk_bf16_f32 v14, v42, v43
  v_lshlrev_b32 v42, 16, v14
  v_and_b32 v43, 0xffff0000, v14
  v_add_f32 v40, v40, v44
  v_add_f32 v41, v41, v45
  v_add_f32 v42, v42, v46
  v_add_f32 v43, v43, v47
  v_cvt_pk_bf16_f32 v14, v40, v41
  v_lshlrev_b32 v40, 16, v14
  v_and_b32 v41, 0xffff0000, v14
  v_cvt_pk_bf16_f32 v14, v42, v43
  v_lshlrev_b32 v42, 16, v14
  v_and_b32 v43, 0xffff0000, v14
  v_add_f32 v40, v40, v200
  v_add_f32 v41, v41, v201
  v_add_f32 v42, v42, v202
  v_add_f32 v43, v43, v203
  v_cvt_pk_bf16_f32 v200, v40, v41
  v_cvt_pk_bf16_f32 v201, v42, v43
  s_mul_i32 s29, s31, 288
  s_add_u32 s29, s29, 64
  buffer_store_dwordx2 v[200:201], v10, s[8:11], s29 offen
  s_waitcnt vmcnt(1)
  v_lshlrev_b32 v40, 16, v30
  v_and_b32 v41, 0xffff0000, v30
  v_lshlrev_b32 v42, 16, v31
  v_and_b32 v43, 0xffff0000, v31
  v_lshlrev_b32 v44, 16, v18
  v_and_b32 v45, 0xffff0000, v18
  v_lshlrev_b32 v46, 16, v19
  v_and_b32 v47, 0xffff0000, v19
  v_lshlrev_b32 v152, 16, v152
  v_mul_f32 v40, v40, v152
  v_lshlrev_b32 v153, 16, v153
  v_mul_f32 v41, v41, v153
  v_lshlrev_b32 v154, 16, v154
  v_mul_f32 v42, v42, v154
  v_lshlrev_b32 v155, 16, v155
  v_mul_f32 v43, v43, v155
  v_cvt_pk_bf16_f32 v14, v40, v41
  v_lshlrev_b32 v40, 16, v14
  v_and_b32 v41, 0xffff0000, v14
  v_cvt_pk_bf16_f32 v14, v42, v43
  v_lshlrev_b32 v42, 16, v14
  v_and_b32 v43, 0xffff0000, v14
  v_add_f32 v40, v40, v44
  v_add_f32 v41, v41, v45
  v_add_f32 v42, v42, v46
  v_add_f32 v43, v43, v47
  v_cvt_pk_bf16_f32 v14, v40, v41
  v_lshlrev_b32 v40, 16, v14
  v_and_b32 v41, 0xffff0000, v14
  v_cvt_pk_bf16_f32 v14, v42, v43
  v_lshlrev_b32 v42, 16, v14
  v_and_b32 v43, 0xffff0000, v14
  v_add_f32 v40, v40, v208
  v_add_f32 v41, v41, v209
  v_add_f32 v42, v42, v210
  v_add_f32 v43, v43, v211
  v_cvt_pk_bf16_f32 v208, v40, v41
  v_cvt_pk_bf16_f32 v209, v42, v43
  s_mul_i32 s29, s31, 288
  s_add_u32 s29, s29, 96
  buffer_store_dwordx2 v[208:209], v10, s[8:11], s29 offen
  s_endpgm
p4_fin0_2:
  s_mul_i32 s29, s31, 288
  s_add_u32 s29, s29, 128
  buffer_load_dwordx2 v[16:17], v10, s[4:7], s29 offen
  s_mul_i32 s27, s31, 9
  s_add_u32 s27, s27, 4
  s_lshr_b32 s29, s27, 1
  s_lshl_b32 s29, s29, 10
  s_and_b32 s27, s27, 1
  s_lshl_b32 s27, s27, 3
  s_add_u32 s29, s29, s27
  s_mul_i32 s27, s43, 18432
  s_add_u32 s29, s29, s27
  buffer_load_dwordx2 v[28:29], v15, s[12:15], s29 offen sc1
  s_mul_i32 s29, s31, 288
  s_add_u32 s29, s29, 160
  buffer_load_dwordx2 v[18:19], v10, s[4:7], s29 offen
  s_mul_i32 s27, s31, 9
  s_add_u32 s27, s27, 5
  s_lshr_b32 s29, s27, 1
  s_lshl_b32 s29, s29, 10
  s_and_b32 s27, s27, 1
  s_lshl_b32 s27, s27, 3
  s_add_u32 s29, s29, s27
  s_mul_i32 s27, s43, 18432
  s_add_u32 s29, s29, s27
  buffer_load_dwordx2 v[30:31], v15, s[12:15], s29 offen sc1
  v_lshlrev_b32 v11, 2, v2
  v_min_u32 v11, 124, v11
  s_mul_i32 s54, s31, 576
  s_add_u32 s54, s54, 41216
  s_mov_b32 s55, 0
p4_poll0_2:
  buffer_load_dword v35, v13, s[32:35], s52 offen sc0 sc1
  buffer_load_dword v36, v11, s[32:35], s54 offen sc0 sc1
  s_waitcnt vmcnt(0)
  v_xor_b32 v35, s85, v35
  v_xor_b32 v36, s85, v36
  v_or_b32 v35, v35, v36
  v_cmp_ne_u32 vcc, 0, v35
  s_cmp_eq_u64 vcc, 0
  s_cbranch_scc1 p4_poll0_2_done
  s_add_u32 s55, s55, 1
  s_cmp_ge_u32 s55, 200000
  s_cbranch_scc1 p4_poll0_2_done
  s_sleep 2
  s_branch p4_poll0_2
p4_poll0_2_done:
  s_add_u32 s29, s44, 2048
  buffer_load_dwordx4 v[40:43], v15, s[16:19], s29 offen sc0 sc1
  s_add_u32 s29, s44, 4720640
  buffer_load_dwordx4 v[44:47], v15, s[16:19], s29 offen sc0 sc1
  s_add_u32 s29, s44, 14157824
  buffer_load_dwordx4 v[48:51], v15, s[16:19], s29 offen sc0 sc1
  s_mul_i32 s27, s31, 589824
  s_add_u32 s29, s27, 262144
  buffer_load_ushort v148, v12, s[48:51], s29 offen sc0 sc1
  s_add_u32 s29, s27, 266240
  buffer_load_ushort v149, v12, s[48:51], s29 offen sc0 sc1
  s_add_u32 s29, s27, 270336
  buffer_load_ushort v150, v12, s[48:51], s29 offen sc0 sc1
  s_add_u32 s29, s27, 274432
  buffer_load_ushort v151, v12, s[48:51], s29 offen sc0 sc1
  s_mul_i32 s27, s31, 589824
  s_add_u32 s29, s27, 327680
  buffer_load_ushort v152, v12, s[48:51], s29 offen sc0 sc1
  s_add_u32 s29, s27, 331776
  buffer_load_ushort v153, v12, s[48:51], s29 offen sc0 sc1
  s_add_u32 s29, s27, 335872
  buffer_load_ushort v154, v12, s[48:51], s29 offen sc0 sc1
  s_add_u32 s29, s27, 339968
  buffer_load_ushort v155, v12, s[48:51], s29 offen sc0 sc1
  s_waitcnt vmcnt(8)
  v_lshlrev_b32 v64, 16, v40
  v_and_b32 v65, 0xffff0000, v40
  v_lshlrev_b32 v66, 16, v41
  v_and_b32 v67, 0xffff0000, v41
  v_add_f32 v216, v216, v64
  v_add_f32 v217, v217, v65
  v_add_f32 v218, v218, v66
  v_add_f32 v219, v219, v67
  v_lshlrev_b32 v64, 16, v44
  v_and_b32 v65, 0xffff0000, v44
  v_lshlrev_b32 v66, 16, v45
  v_and_b32 v67, 0xffff0000, v45
  v_add_f32 v216, v216, v64
  v_add_f32 v217, v217, v65
  v_add_f32 v218, v218, v66
  v_add_f32 v219, v219, v67
  v_lshlrev_b32 v64, 16, v48
  v_and_b32 v65, 0xffff0000, v48
  v_lshlrev_b32 v66, 16, v49
  v_and_b32 v67, 0xffff0000, v49
  v_add_f32 v216, v216, v64
  v_add_f32 v217, v217, v65
  v_add_f32 v218, v218, v66
  v_add_f32 v219, v219, v67
  v_cvt_pk_bf16_f32 v14, v216, v217
  v_lshlrev_b32 v216, 16, v14
  v_and_b32 v217, 0xffff0000, v14
  v_cvt_pk_bf16_f32 v14, v218, v219
  v_lshlrev_b32 v218, 16, v14
  v_and_b32 v219, 0xffff0000, v14
  s_waitcnt vmcnt(8)
  v_lshlrev_b32 v64, 16, v42
  v_and_b32 v65, 0xffff0000, v42
  v_lshlrev_b32 v66, 16, v43
  v_and_b32 v67, 0xffff0000, v43
  v_add_f32 v224, v224, v64
  v_add_f32 v225, v225, v65
  v_add_f32 v226, v226, v66
  v_add_f32 v227, v227, v67
  v_lshlrev_b32 v64, 16, v46
  v_and_b32 v65, 0xffff0000, v46
  v_lshlrev_b32 v66, 16, v47
  v_and_b32 v67, 0xffff0000, v47
  v_add_f32 v224, v224, v64
  v_add_f32 v225, v225, v65
  v_add_f32 v226, v226, v66
  v_add_f32 v227, v227, v67
  v_lshlrev_b32 v64, 16, v50
  v_and_b32 v65, 0xffff0000, v50
  v_lshlrev_b32 v66, 16, v51
  v_and_b32 v67, 0xffff0000, v51
  v_add_f32 v224, v224, v64
  v_add_f32 v225, v225, v65
  v_add_f32 v226, v226, v66
  v_add_f32 v227, v227, v67
  v_cvt_pk_bf16_f32 v14, v224, v225
  v_lshlrev_b32 v224, 16, v14
  v_and_b32 v225, 0xffff0000, v14
  v_cvt_pk_bf16_f32 v14, v226, v227
  v_lshlrev_b32 v226, 16, v14
  v_and_b32 v227, 0xffff0000, v14
  s_waitcnt vmcnt(4)
  v_lshlrev_b32 v40, 16, v28
  v_and_b32 v41, 0xffff0000, v28
  v_lshlrev_b32 v42, 16, v29
  v_and_b32 v43, 0xffff0000, v29
  v_lshlrev_b32 v44, 16, v16
  v_and_b32 v45, 0xffff0000, v16
  v_lshlrev_b32 v46, 16, v17
  v_and_b32 v47, 0xffff0000, v17
  v_lshlrev_b32 v148, 16, v148
  v_mul_f32 v40, v40, v148
  v_lshlrev_b32 v149, 16, v149
  v_mul_f32 v41, v41, v149
  v_lshlrev_b32 v150, 16, v150
  v_mul_f32 v42, v42, v150
  v_lshlrev_b32 v151, 16, v151
  v_mul_f32 v43, v43, v151
  v_cvt_pk_bf16_f32 v14, v40, v41
  v_lshlrev_b32 v40, 16, v14
  v_and_b32 v41, 0xffff0000, v14
  v_cvt_pk_bf16_f32 v14, v42, v43
  v_lshlrev_b32 v42, 16, v14
  v_and_b32 v43, 0xffff0000, v14
  v_add_f32 v40, v40, v44
  v_add_f32 v41, v41, v45
  v_add_f32 v42, v42, v46
  v_add_f32 v43, v43, v47
  v_cvt_pk_bf16_f32 v14, v40, v41
  v_lshlrev_b32 v40, 16, v14
  v_and_b32 v41, 0xffff0000, v14
  v_cvt_pk_bf16_f32 v14, v42, v43
  v_lshlrev_b32 v42, 16, v14
  v_and_b32 v43, 0xffff0000, v14
  v_add_f32 v40, v40, v216
  v_add_f32 v41, v41, v217
  v_add_f32 v42, v42, v218
  v_add_f32 v43, v43, v219
  v_cvt_pk_bf16_f32 v216, v40, v41
  v_cvt_pk_bf16_f32 v217, v42, v43
  s_mul_i32 s29, s31, 288
  s_add_u32 s29, s29, 128
  buffer_store_dwordx2 v[216:217], v10, s[8:11], s29 offen
  s_waitcnt vmcnt(1)
  v_lshlrev_b32 v40, 16, v30
  v_and_b32 v41, 0xffff0000, v30
  v_lshlrev_b32 v42, 16, v31
  v_and_b32 v43, 0xffff0000, v31
  v_lshlrev_b32 v44, 16, v18
  v_and_b32 v45, 0xffff0000, v18
  v_lshlrev_b32 v46, 16, v19
  v_and_b32 v47, 0xffff0000, v19
  v_lshlrev_b32 v152, 16, v152
  v_mul_f32 v40, v40, v152
  v_lshlrev_b32 v153, 16, v153
  v_mul_f32 v41, v41, v153
  v_lshlrev_b32 v154, 16, v154
  v_mul_f32 v42, v42, v154
  v_lshlrev_b32 v155, 16, v155
  v_mul_f32 v43, v43, v155
  v_cvt_pk_bf16_f32 v14, v40, v41
  v_lshlrev_b32 v40, 16, v14
  v_and_b32 v41, 0xffff0000, v14
  v_cvt_pk_bf16_f32 v14, v42, v43
  v_lshlrev_b32 v42, 16, v14
  v_and_b32 v43, 0xffff0000, v14
  v_add_f32 v40, v40, v44
  v_add_f32 v41, v41, v45
  v_add_f32 v42, v42, v46
  v_add_f32 v43, v43, v47
  v_cvt_pk_bf16_f32 v14, v40, v41
  v_lshlrev_b32 v40, 16, v14
  v_and_b32 v41, 0xffff0000, v14
  v_cvt_pk_bf16_f32 v14, v42, v43
  v_lshlrev_b32 v42, 16, v14
  v_and_b32 v43, 0xffff0000, v14
  v_add_f32 v40, v40, v224
  v_add_f32 v41, v41, v225
  v_add_f32 v42, v42, v226
  v_add_f32 v43, v43, v227
  v_cvt_pk_bf16_f32 v224, v40, v41
  v_cvt_pk_bf16_f32 v225, v42, v43
  s_mul_i32 s29, s31, 288
  s_add_u32 s29, s29, 160
  buffer_store_dwordx2 v[224:225], v10, s[8:11], s29 offen
  s_endpgm
p4_fin0_3:
  s_mul_i32 s29, s31, 288
  s_add_u32 s29, s29, 192
  buffer_load_dwordx2 v[16:17], v10, s[4:7], s29 offen
  s_mul_i32 s27, s31, 9
  s_add_u32 s27, s27, 6
  s_lshr_b32 s29, s27, 1
  s_lshl_b32 s29, s29, 10
  s_and_b32 s27, s27, 1
  s_lshl_b32 s27, s27, 3
  s_add_u32 s29, s29, s27
  s_mul_i32 s27, s43, 18432
  s_add_u32 s29, s29, s27
  buffer_load_dwordx2 v[28:29], v15, s[12:15], s29 offen sc1
  s_mul_i32 s29, s31, 288
  s_add_u32 s29, s29, 224
  buffer_load_dwordx2 v[18:19], v10, s[4:7], s29 offen
  s_mul_i32 s27, s31, 9
  s_add_u32 s27, s27, 7
  s_lshr_b32 s29, s27, 1
  s_lshl_b32 s29, s29, 10
  s_and_b32 s27, s27, 1
  s_lshl_b32 s27, s27, 3
  s_add_u32 s29, s29, s27
  s_mul_i32 s27, s43, 18432
  s_add_u32 s29, s29, s27
  buffer_load_dwordx2 v[30:31], v15, s[12:15], s29 offen sc1
  s_mul_i32 s29, s31, 288
  s_add_u32 s29, s29, 256
  buffer_load_dwordx2 v[20:21], v10, s[4:7], s29 offen
  s_mul_i32 s27, s31, 9
  s_add_u32 s27, s27, 8
  s_lshr_b32 s29, s27, 1
  s_lshl_b32 s29, s29, 10
  s_and_b32 s27, s27, 1
  s_lshl_b32 s27, s27, 3
  s_add_u32 s29, s29, s27
  s_mul_i32 s27, s43, 18432
  s_add_u32 s29, s29, s27
  buffer_load_dwordx2 v[32:33], v15, s[12:15], s29 offen sc1
  v_lshlrev_b32 v11, 2, v2
  v_min_u32 v11, 188, v11
  s_mul_i32 s54, s31, 576
  s_add_u32 s54, s54, 41344
  s_mov_b32 s55, 0
p4_poll0_3:
  buffer_load_dword v35, v13, s[32:35], s52 offen sc0 sc1
  buffer_load_dword v36, v11, s[32:35], s54 offen sc0 sc1
  s_waitcnt vmcnt(0)
  v_xor_b32 v35, s85, v35
  v_xor_b32 v36, s85, v36
  v_or_b32 v35, v35, v36
  v_cmp_ne_u32 vcc, 0, v35
  s_cmp_eq_u64 vcc, 0
  s_cbranch_scc1 p4_poll0_3_done
  s_add_u32 s55, s55, 1
  s_cmp_ge_u32 s55, 200000
  s_cbranch_scc1 p4_poll0_3_done
  s_sleep 2
  s_branch p4_poll0_3
p4_poll0_3_done:
  s_add_u32 s29, s44, 3072
  buffer_load_dwordx4 v[40:43], v15, s[16:19], s29 offen sc0 sc1
  s_add_u32 s29, s44, 4721664
  buffer_load_dwordx4 v[44:47], v15, s[16:19], s29 offen sc0 sc1
  s_add_u32 s29, s44, 9440256
  buffer_load_dwordx4 v[48:51], v15, s[16:19], s29 offen sc0 sc1
  s_add_u32 s29, s44, 4096
  buffer_load_dwordx4 v[52:55], v15, s[16:19], s29 offen sc0 sc1
  s_add_u32 s29, s44, 4722688
  buffer_load_dwordx4 v[56:59], v15, s[16:19], s29 offen sc0 sc1
  s_add_u32 s29, s44, 9441280
  buffer_load_dwordx4 v[60:63], v15, s[16:19], s29 offen sc0 sc1
  s_mul_i32 s27, s31, 589824
  s_add_u32 s29, s27, 393216
  buffer_load_ushort v148, v12, s[48:51], s29 offen sc0 sc1
  s_add_u32 s29, s27, 397312
  buffer_load_ushort v149, v12, s[48:51], s29 offen sc0 sc1
  s_add_u32 s29, s27, 401408
  buffer_load_ushort v150, v12, s[48:51], s29 offen sc0 sc1
  s_add_u32 s29, s27, 405504
  buffer_load_ushort v151, v12, s[48:51], s29 offen sc0 sc1
  s_mul_i32 s27, s31, 589824
  s_add_u32 s29, s27, 458752
  buffer_load_ushort v152, v12, s[48:51], s29 offen sc0 sc1
  s_add_u32 s29, s27, 462848
  buffer_load_ushort v153, v12, s[48:51], s29 offen sc0 sc1
  s_add_u32 s29, s27, 466944
  buffer_load_ushort v154, v12, s[48:51], s29 offen sc0 sc1
  s_add_u32 s29, s27, 471040
  buffer_load_ushort v155, v12, s[48:51], s29 offen sc0 sc1
  s_mul_i32 s27, s31, 589824
  s_add_u32 s29, s27, 524288
  buffer_load_ushort v156, v12, s[48:51], s29 offen sc0 sc1
  s_add_u32 s29, s27, 528384
  buffer_load_ushort v157, v12, s[48:51], s29 offen sc0 sc1
  s_add_u32 s29, s27, 532480
  buffer_load_ushort v158, v12, s[48:51], s29 offen sc0 sc1
  s_add_u32 s29, s27, 536576
  buffer_load_ushort v159, v12, s[48:51], s29 offen sc0 sc1
  s_waitcnt vmcnt(15)
  v_lshlrev_b32 v64, 16, v40
  v_and_b32 v65, 0xffff0000, v40
  v_lshlrev_b32 v66, 16, v41
  v_and_b32 v67, 0xffff0000, v41
  v_add_f32 v232, v232, v64
  v_add_f32 v233, v233, v65
  v_add_f32 v234, v234, v66
  v_add_f32 v235, v235, v67
  v_lshlrev_b32 v64, 16, v44
  v_and_b32 v65, 0xffff0000, v44
  v_lshlrev_b32 v66, 16, v45
  v_and_b32 v67, 0xffff0000, v45
  v_add_f32 v232, v232, v64
  v_add_f32 v233, v233, v65
  v_add_f32 v234, v234, v66
  v_add_f32 v235, v235, v67
  v_lshlrev_b32 v64, 16, v48
  v_and_b32 v65, 0xffff0000, v48
  v_lshlrev_b32 v66, 16, v49
  v_and_b32 v67, 0xffff0000, v49
  v_add_f32 v232, v232, v64
  v_add_f32 v233, v233, v65
  v_add_f32 v234, v234, v66
  v_add_f32 v235, v235, v67
  v_cvt_pk_bf16_f32 v14, v232, v233
  v_lshlrev_b32 v232, 16, v14
  v_and_b32 v233, 0xffff0000, v14
  v_cvt_pk_bf16_f32 v14, v234, v235
  v_lshlrev_b32 v234, 16, v14
  v_and_b32 v235, 0xffff0000, v14
  s_waitcnt vmcnt(15)
  v_lshlrev_b32 v64, 16, v42
  v_and_b32 v65, 0xffff0000, v42
  v_lshlrev_b32 v66, 16, v43
  v_and_b32 v67, 0xffff0000, v43
  v_add_f32 v240, v240, v64
  v_add_f32 v241, v241, v65
  v_add_f32 v242, v242, v66
  v_add_f32 v243, v243, v67
  v_lshlrev_b32 v64, 16, v46
  v_and_b32 v65, 0xffff0000, v46
  v_lshlrev_b32 v66, 16, v47
  v_and_b32 v67, 0xffff0000, v47
  v_add_f32 v240, v240, v64
  v_add_f32 v241, v241, v65
  v_add_f32 v242, v242, v66
  v_add_f32 v243, v243, v67
  v_lshlrev_b32 v64, 16, v50
  v_and_b32 v65, 0xffff0000, v50
  v_lshlrev_b32 v66, 16, v51
  v_and_b32 v67, 0xffff0000, v51
  v_add_f32 v240, v240, v64
  v_add_f32 v241, v241, v65
  v_add_f32 v242, v242, v66
  v_add_f32 v243, v243, v67
  v_cvt_pk_bf16_f32 v14, v240, v241
  v_lshlrev_b32 v240, 16, v14
  v_and_b32 v241, 0xffff0000, v14
  v_cvt_pk_bf16_f32 v14, v242, v243
  v_lshlrev_b32 v242, 16, v14
  v_and_b32 v243, 0xffff0000, v14
  s_waitcnt vmcnt(12)
  v_lshlrev_b32 v64, 16, v52
  v_and_b32 v65, 0xffff0000, v52
  v_lshlrev_b32 v66, 16, v53
  v_and_b32 v67, 0xffff0000, v53
  v_add_f32 v248, v248, v64
  v_add_f32 v249, v249, v65
  v_add_f32 v250, v250, v66
  v_add_f32 v251, v251, v67
  v_lshlrev_b32 v64, 16, v56
  v_and_b32 v65, 0xffff0000, v56
  v_lshlrev_b32 v66, 16, v57
  v_and_b32 v67, 0xffff0000, v57
  v_add_f32 v248, v248, v64
  v_add_f32 v249, v249, v65
  v_add_f32 v250, v250, v66
  v_add_f32 v251, v251, v67
  v_lshlrev_b32 v64, 16, v60
  v_and_b32 v65, 0xffff0000, v60
  v_lshlrev_b32 v66, 16, v61
  v_and_b32 v67, 0xffff0000, v61
  v_add_f32 v248, v248, v64
  v_add_f32 v249, v249, v65
  v_add_f32 v250, v250, v66
  v_add_f32 v251, v251, v67
  v_cvt_pk_bf16_f32 v14, v248, v249
  v_lshlrev_b32 v248, 16, v14
  v_and_b32 v249, 0xffff0000, v14
  v_cvt_pk_bf16_f32 v14, v250, v251
  v_lshlrev_b32 v250, 16, v14
  v_and_b32 v251, 0xffff0000, v14
  s_waitcnt vmcnt(8)
  v_lshlrev_b32 v40, 16, v28
  v_and_b32 v41, 0xffff0000, v28
  v_lshlrev_b32 v42, 16, v29
  v_and_b32 v43, 0xffff0000, v29
  v_lshlrev_b32 v44, 16, v16
  v_and_b32 v45, 0xffff0000, v16
  v_lshlrev_b32 v46, 16, v17
  v_and_b32 v47, 0xffff0000, v17
  v_lshlrev_b32 v148, 16, v148
  v_mul_f32 v40, v40, v148
  v_lshlrev_b32 v149, 16, v149
  v_mul_f32 v41, v41, v149
  v_lshlrev_b32 v150, 16, v150
  v_mul_f32 v42, v42, v150
  v_lshlrev_b32 v151, 16, v151
  v_mul_f32 v43, v43, v151
  v_cvt_pk_bf16_f32 v14, v40, v41
  v_lshlrev_b32 v40, 16, v14
  v_and_b32 v41, 0xffff0000, v14
  v_cvt_pk_bf16_f32 v14, v42, v43
  v_lshlrev_b32 v42, 16, v14
  v_and_b32 v43, 0xffff0000, v14
  v_add_f32 v40, v40, v44
  v_add_f32 v41, v41, v45
  v_add_f32 v42, v42, v46
  v_add_f32 v43, v43, v47
  v_cvt_pk_bf16_f32 v14, v40, v41
  v_lshlrev_b32 v40, 16, v14
  v_and_b32 v41, 0xffff0000, v14
  v_cvt_pk_bf16_f32 v14, v42, v43
  v_lshlrev_b32 v42, 16, v14
  v_and_b32 v43, 0xffff0000, v14
  v_add_f32 v40, v40, v232
  v_add_f32 v41, v41, v233
  v_add_f32 v42, v42, v234
  v_add_f32 v43, v43, v235
  v_cvt_pk_bf16_f32 v232, v40, v41
  v_cvt_pk_bf16_f32 v233, v42, v43
  s_mul_i32 s29, s31, 288
  s_add_u32 s29, s29, 192
  buffer_store_dwordx2 v[232:233], v10, s[8:11], s29 offen
  s_waitcnt vmcnt(5)
  v_lshlrev_b32 v40, 16, v30
  v_and_b32 v41, 0xffff0000, v30
  v_lshlrev_b32 v42, 16, v31
  v_and_b32 v43, 0xffff0000, v31
  v_lshlrev_b32 v44, 16, v18
  v_and_b32 v45, 0xffff0000, v18
  v_lshlrev_b32 v46, 16, v19
  v_and_b32 v47, 0xffff0000, v19
  v_lshlrev_b32 v152, 16, v152
  v_mul_f32 v40, v40, v152
  v_lshlrev_b32 v153, 16, v153
  v_mul_f32 v41, v41, v153
  v_lshlrev_b32 v154, 16, v154
  v_mul_f32 v42, v42, v154
  v_lshlrev_b32 v155, 16, v155
  v_mul_f32 v43, v43, v155
  v_cvt_pk_bf16_f32 v14, v40, v41
  v_lshlrev_b32 v40, 16, v14
  v_and_b32 v41, 0xffff0000, v14
  v_cvt_pk_bf16_f32 v14, v42, v43
  v_lshlrev_b32 v42, 16, v14
  v_and_b32 v43, 0xffff0000, v14
  v_add_f32 v40, v40, v44
  v_add_f32 v41, v41, v45
  v_add_f32 v42, v42, v46
  v_add_f32 v43, v43, v47
  v_cvt_pk_bf16_f32 v14, v40, v41
  v_lshlrev_b32 v40, 16, v14
  v_and_b32 v41, 0xffff0000, v14
  v_cvt_pk_bf16_f32 v14, v42, v43
  v_lshlrev_b32 v42, 16, v14
  v_and_b32 v43, 0xffff0000, v14
  v_add_f32 v40, v40, v240
  v_add_f32 v41, v41, v241
  v_add_f32 v42, v42, v242
  v_add_f32 v43, v43, v243
  v_cvt_pk_bf16_f32 v240, v40, v41
  v_cvt_pk_bf16_f32 v241, v42, v43
  s_mul_i32 s29, s31, 288
  s_add_u32 s29, s29, 224
  buffer_store_dwordx2 v[240:241], v10, s[8:11], s29 offen
  s_waitcnt vmcnt(2)
  v_lshlrev_b32 v40, 16, v32
  v_and_b32 v41, 0xffff0000, v32
  v_lshlrev_b32 v42, 16, v33
  v_and_b32 v43, 0xffff0000, v33
  v_lshlrev_b32 v44, 16, v20
  v_and_b32 v45, 0xffff0000, v20
  v_lshlrev_b32 v46, 16, v21
  v_and_b32 v47, 0xffff0000, v21
  v_lshlrev_b32 v156, 16, v156
  v_mul_f32 v40, v40, v156
  v_lshlrev_b32 v157, 16, v157
  v_mul_f32 v41, v41, v157
  v_lshlrev_b32 v158, 16, v158
  v_mul_f32 v42, v42, v158
  v_lshlrev_b32 v159, 16, v159
  v_mul_f32 v43, v43, v159
  v_cvt_pk_bf16_f32 v14, v40, v41
  v_lshlrev_b32 v40, 16, v14
  v_and_b32 v41, 0xffff0000, v14
  v_cvt_pk_bf16_f32 v14, v42, v43
  v_lshlrev_b32 v42, 16, v14
  v_and_b32 v43, 0xffff0000, v14
  v_add_f32 v40, v40, v44
  v_add_f32 v41, v41, v45
  v_add_f32 v42, v42, v46
  v_add_f32 v43, v43, v47
  v_cvt_pk_bf16_f32 v14, v40, v41
  v_lshlrev_b32 v40, 16, v14
  v_and_b32 v41, 0xffff0000, v14
  v_cvt_pk_bf16_f32 v14, v42, v43
  v_lshlrev_b32 v42, 16, v14
  v_and_b32 v43, 0xffff0000, v14
  v_add_f32 v40, v40, v248
  v_add_f32 v41, v41, v249
  v_add_f32 v42, v42, v250
  v_add_f32 v43, v43, v251
  v_cvt_pk_bf16_f32 v248, v40, v41
  v_cvt_pk_bf16_f32 v249, v42, v43
  s_mul_i32 s29, s31, 288
  s_add_u32 s29, s29, 256
  buffer_store_dwordx2 v[248:249], v10, s[8:11], s29 offen
  s_endpgm
p4_kp1:
  ds_write_b128 v4, v[184:187] offset:0
  ds_write_b128 v4, v[192:195] offset:1024
  ds_write_b128 v4, v[200:203] offset:2048
  ds_write_b128 v4, v[208:211] offset:3072
  ds_write_b128 v4, v[216:219] offset:4096
  ds_write_b128 v4, v[224:227] offset:5120
  ds_write_b128 v4, v[232:235] offset:6144
  ds_write_b128 v4, v[240:243] offset:7168
  ds_write_b128 v4, v[248:251] offset:8192
  s_waitcnt lgkmcnt(0)
  s_barrier
  ds_read_b128 v[16:19], v5 offset:0
  ds_read_b128 v[20:23], v5 offset:1024
  ds_read_b128 v[24:27], v5 offset:2048
  ds_read_b128 v[28:31], v5 offset:3072
  ds_read_b128 v[32:35], v5 offset:4096
  ds_read_b128 v[36:39], v5 offset:5120
  ds_read_b128 v[40:43], v5 offset:6144
  ds_read_b128 v[44:47], v5 offset:7168
  ds_read_b128 v[48:51], v5 offset:8192
  s_waitcnt lgkmcnt(8)
  v_add_f32 v188, v188, v16
  v_add_f32 v189, v189, v17
  v_add_f32 v190, v190, v18
  v_add_f32 v191, v191, v19
  v_cvt_pk_bf16_f32 v60, v188, v189
  v_cvt_pk_bf16_f32 v61, v190, v191
  s_waitcnt lgkmcnt(7)
  v_add_f32 v196, v196, v20
  v_add_f32 v197, v197, v21
  v_add_f32 v198, v198, v22
  v_add_f32 v199, v199, v23
  v_cvt_pk_bf16_f32 v62, v196, v197
  v_cvt_pk_bf16_f32 v63, v198, v199
  s_cmp_eq_u32 s20, 0
  s_cbranch_scc1 p4_skip1_1
  s_add_u32 s29, s45, 0
  buffer_store_dwordx4 v[60:63], v15, s[16:19], s29 offen sc0 sc1
p4_skip1_1:
  s_waitcnt lgkmcnt(6)
  v_add_f32 v204, v204, v24
  v_add_f32 v205, v205, v25
  v_add_f32 v206, v206, v26
  v_add_f32 v207, v207, v27
  v_cvt_pk_bf16_f32 v64, v204, v205
  v_cvt_pk_bf16_f32 v65, v206, v207
  s_waitcnt lgkmcnt(5)
  v_add_f32 v212, v212, v28
  v_add_f32 v213, v213, v29
  v_add_f32 v214, v214, v30
  v_add_f32 v215, v215, v31
  v_cvt_pk_bf16_f32 v66, v212, v213
  v_cvt_pk_bf16_f32 v67, v214, v215
  s_cmp_eq_u32 s20, 1
  s_cbranch_scc1 p4_skip1_3
  s_add_u32 s29, s45, 1024
  buffer_store_dwordx4 v[64:67], v15, s[16:19], s29 offen sc0 sc1
p4_skip1_3:
  s_waitcnt lgkmcnt(4)
  v_add_f32 v220, v220, v32
  v_add_f32 v221, v221, v33
  v_add_f32 v222, v222, v34
  v_add_f32 v223, v223, v35
  v_cvt_pk_bf16_f32 v68, v220, v221
  v_cvt_pk_bf16_f32 v69, v222, v223
  s_waitcnt lgkmcnt(3)
  v_add_f32 v228, v228, v36
  v_add_f32 v229, v229, v37
  v_add_f32 v230, v230, v38
  v_add_f32 v231, v231, v39
  v_cvt_pk_bf16_f32 v70, v228, v229
  v_cvt_pk_bf16_f32 v71, v230, v231
  s_cmp_eq_u32 s20, 2
  s_cbranch_scc1 p4_skip1_5
  s_add_u32 s29, s45, 2048
  buffer_store_dwordx4 v[68:71], v15, s[16:19], s29 offen sc0 sc1
p4_skip1_5:
  s_waitcnt lgkmcnt(2)
  v_add_f32 v236, v236, v40
  v_add_f32 v237, v237, v41
  v_add_f32 v238, v238, v42
  v_add_f32 v239, v239, v43
  v_cvt_pk_bf16_f32 v72, v236, v237
  v_cvt_pk_bf16_f32 v73, v238, v239
  s_waitcnt lgkmcnt(1)
  v_add_f32 v244, v244, v44
  v_add_f32 v245, v245, v45
  v_add_f32 v246, v246, v46
  v_add_f32 v247, v247, v47
  v_cvt_pk_bf16_f32 v74, v244, v245
  v_cvt_pk_bf16_f32 v75, v246, v247
  s_cmp_eq_u32 s20, 3
  s_cbranch_scc1 p4_skip1_7
  s_add_u32 s29, s45, 3072
  buffer_store_dwordx4 v[72:75], v15, s[16:19], s29 offen sc0 sc1
p4_skip1_7:
  s_waitcnt lgkmcnt(0)
  v_add_f32 v252, v252, v48
  v_add_f32 v253, v253, v49
  v_add_f32 v254, v254, v50
  v_add_f32 v255, v255, v51
  v_cvt_pk_bf16_f32 v76, v252, v253
  v_cvt_pk_bf16_f32 v77, v254, v255
  s_cmp_eq_u32 s20, 3
  s_cbranch_scc1 p4_skip1_8
  s_add_u32 s29, s45, 4096
  buffer_store_dwordx4 v[76:79], v15, s[16:19], s29 offen sc0 sc1
p4_skip1_8:
  s_waitcnt vmcnt(0)
  v_mov_b32 v3, s85
  v_mov_b32 v6, s53
  s_mov_b64 exec, 1
  buffer_store_dword v3, v6, s[32:35], 0 offen sc0 sc1
  s_mov_b64 exec, -1
  s_cmp_eq_u32 s20, 0
  s_cbranch_scc1 p4_fin1_0
  s_cmp_eq_u32 s20, 1
  s_cbranch_scc1 p4_fin1_1
  s_cmp_eq_u32 s20, 2
  s_cbranch_scc1 p4_fin1_2
  s_cmp_eq_u32 s20, 3
  s_cbranch_scc1 p4_fin1_3
p4_fin1_0:
  s_mul_i32 s29, s31, 288
  s_add_u32 s29, s29, 0
  buffer_load_dwordx2 v[16:17], v10, s[4:7], s29 offen
  s_mul_i32 s27, s31, 9
  s_add_u32 s27, s27, 0
  s_lshr_b32 s29, s27, 1
  s_lshl_b32 s29, s29, 10
  s_and_b32 s27, s27, 1
  s_lshl_b32 s27, s27, 3
  s_add_u32 s29, s29, s27
  s_mul_i32 s27, s43, 18432
  s_add_u32 s29, s29, s27
  buffer_load_dwordx2 v[28:29], v15, s[12:15], s29 offen sc1
  s_mul_i32 s29, s31, 288
  s_add_u32 s29, s29, 32
  buffer_load_dwordx2 v[18:19], v10, s[4:7], s29 offen
  s_mul_i32 s27, s31, 9
  s_add_u32 s27, s27, 1
  s_lshr_b32 s29, s27, 1
  s_lshl_b32 s29, s29, 10
  s_and_b32 s27, s27, 1
  s_lshl_b32 s27, s27, 3
  s_add_u32 s29, s29, s27
  s_mul_i32 s27, s43, 18432
  s_add_u32 s29, s29, s27
  buffer_load_dwordx2 v[30:31], v15, s[12:15], s29 offen sc1
  v_lshlrev_b32 v11, 2, v2
  v_min_u32 v11, 124, v11
  s_mul_i32 s54, s31, 576
  s_add_u32 s54, s54, 40960
  s_mov_b32 s55, 0
p4_poll1_0:
  buffer_load_dword v35, v13, s[32:35], s52 offen sc0 sc1
  buffer_load_dword v36, v11, s[32:35], s54 offen sc0 sc1
  s_waitcnt vmcnt(0)
  v_xor_b32 v35, s85, v35
  v_xor_b32 v36, s85, v36
  v_or_b32 v35, v35, v36
  v_cmp_ne_u32 vcc, 0, v35
  s_cmp_eq_u64 vcc, 0
  s_cbranch_scc1 p4_poll1_0_done
  s_add_u32 s55, s55, 1
  s_cmp_ge_u32 s55, 200000
  s_cbranch_scc1 p4_poll1_0_done
  s_sleep 2
  s_branch p4_poll1_0
p4_poll1_0_done:
  s_add_u32 s29, s44, 4718592
  buffer_load_dwordx4 v[40:43], v15, s[16:19], s29 offen sc0 sc1
  s_add_u32 s29, s44, 9437184
  buffer_load_dwordx4 v[44:47], v15, s[16:19], s29 offen sc0 sc1
  s_add_u32 s29, s44, 14155776
  buffer_load_dwordx4 v[48:51], v15, s[16:19], s29 offen sc0 sc1
  s_mul_i32 s27, s31, 589824
  s_add_u32 s29, s27, 0
  buffer_load_ushort v148, v12, s[48:51], s29 offen sc0 sc1
  s_add_u32 s29, s27, 4096
  buffer_load_ushort v149, v12, s[48:51], s29 offen sc0 sc1
  s_add_u32 s29, s27, 8192
  buffer_load_ushort v150, v12, s[48:51], s29 offen sc0 sc1
  s_add_u32 s29, s27, 12288
  buffer_load_ushort v151, v12, s[48:51], s29 offen sc0 sc1
  s_mul_i32 s27, s31, 589824
  s_add_u32 s29, s27, 65536
  buffer_load_ushort v152, v12, s[48:51], s29 offen sc0 sc1
  s_add_u32 s29, s27, 69632
  buffer_load_ushort v153, v12, s[48:51], s29 offen sc0 sc1
  s_add_u32 s29, s27, 73728
  buffer_load_ushort v154, v12, s[48:51], s29 offen sc0 sc1
  s_add_u32 s29, s27, 77824
  buffer_load_ushort v155, v12, s[48:51], s29 offen sc0 sc1
  s_waitcnt vmcnt(8)
  v_lshlrev_b32 v64, 16, v40
  v_and_b32 v65, 0xffff0000, v40
  v_lshlrev_b32 v66, 16, v41
  v_and_b32 v67, 0xffff0000, v41
  v_add_f32 v188, v188, v64
  v_add_f32 v189, v189, v65
  v_add_f32 v190, v190, v66
  v_add_f32 v191, v191, v67
  v_lshlrev_b32 v64, 16, v44
  v_and_b32 v65, 0xffff0000, v44
  v_lshlrev_b32 v66, 16, v45
  v_and_b32 v67, 0xffff0000, v45
  v_add_f32 v188, v188, v64
  v_add_f32 v189, v189, v65
  v_add_f32 v190, v190, v66
  v_add_f32 v191, v191, v67
  v_lshlrev_b32 v64, 16, v48
  v_and_b32 v65, 0xffff0000, v48
  v_lshlrev_b32 v66, 16, v49
  v_and_b32 v67, 0xffff0000, v49
  v_add_f32 v188, v188, v64
  v_add_f32 v189, v189, v65
  v_add_f32 v190, v190, v66
  v_add_f32 v191, v191, v67
  v_cvt_pk_bf16_f32 v14, v188, v189
  v_lshlrev_b32 v188, 16, v14
  v_and_b32 v189, 0xffff0000, v14
  v_cvt_pk_bf16_f32 v14, v190, v191
  v_lshlrev_b32 v190, 16, v14
  v_and_b32 v191, 0xffff0000, v14
  s_waitcnt vmcnt(8)
  v_lshlrev_b32 v64, 16, v42
  v_and_b32 v65, 0xffff0000, v42
  v_lshlrev_b32 v66, 16, v43
  v_and_b32 v67, 0xffff0000, v43
  v_add_f32 v196, v196, v64
  v_add_f32 v197, v197, v65
  v_add_f32 v198, v198, v66
  v_add_f32 v199, v199, v67
  v_lshlrev_b32 v64, 16, v46
  v_and_b32 v65, 0xffff0000, v46
  v_lshlrev_b32 v66, 16, v47
  v_and_b32 v67, 0xffff0000, v47
  v_add_f32 v196, v196, v64
  v_add_f32 v197, v197, v65
  v_add_f32 v198, v198, v66
  v_add_f32 v199, v199, v67
  v_lshlrev_b32 v64, 16, v50
  v_and_b32 v65, 0xffff0000, v50
  v_lshlrev_b32 v66, 16, v51
  v_and_b32 v67, 0xffff0000, v51
  v_add_f32 v196, v196, v64
  v_add_f32 v197, v197, v65
  v_add_f32 v198, v198, v66
  v_add_f32 v199, v199, v67
  v_cvt_pk_bf16_f32 v14, v196, v197
  v_lshlrev_b32 v196, 16, v14
  v_and_b32 v197, 0xffff0000, v14
  v_cvt_pk_bf16_f32 v14, v198, v199
  v_lshlrev_b32 v198, 16, v14
  v_and_b32 v199, 0xffff0000, v14
  s_waitcnt vmcnt(4)
  v_lshlrev_b32 v40, 16, v28
  v_and_b32 v41, 0xffff0000, v28
  v_lshlrev_b32 v42, 16, v29
  v_and_b32 v43, 0xffff0000, v29
  v_lshlrev_b32 v44, 16, v16
  v_and_b32 v45, 0xffff0000, v16
  v_lshlrev_b32 v46, 16, v17
  v_and_b32 v47, 0xffff0000, v17
  v_lshlrev_b32 v148, 16, v148
  v_mul_f32 v40, v40, v148
  v_lshlrev_b32 v149, 16, v149
  v_mul_f32 v41, v41, v149
  v_lshlrev_b32 v150, 16, v150
  v_mul_f32 v42, v42, v150
  v_lshlrev_b32 v151, 16, v151
  v_mul_f32 v43, v43, v151
  v_cvt_pk_bf16_f32 v14, v40, v41
  v_lshlrev_b32 v40, 16, v14
  v_and_b32 v41, 0xffff0000, v14
  v_cvt_pk_bf16_f32 v14, v42, v43
  v_lshlrev_b32 v42, 16, v14
  v_and_b32 v43, 0xffff0000, v14
  v_add_f32 v40, v40, v44
  v_add_f32 v41, v41, v45
  v_add_f32 v42, v42, v46
  v_add_f32 v43, v43, v47
  v_cvt_pk_bf16_f32 v14, v40, v41
  v_lshlrev_b32 v40, 16, v14
  v_and_b32 v41, 0xffff0000, v14
  v_cvt_pk_bf16_f32 v14, v42, v43
  v_lshlrev_b32 v42, 16, v14
  v_and_b32 v43, 0xffff0000, v14
  v_add_f32 v40, v40, v188
  v_add_f32 v41, v41, v189
  v_add_f32 v42, v42, v190
  v_add_f32 v43, v43, v191
  v_cvt_pk_bf16_f32 v188, v40, v41
  v_cvt_pk_bf16_f32 v189, v42, v43
  s_mul_i32 s29, s31, 288
  s_add_u32 s29, s29, 0
  buffer_store_dwordx2 v[188:189], v10, s[8:11], s29 offen
  s_waitcnt vmcnt(1)
  v_lshlrev_b32 v40, 16, v30
  v_and_b32 v41, 0xffff0000, v30
  v_lshlrev_b32 v42, 16, v31
  v_and_b32 v43, 0xffff0000, v31
  v_lshlrev_b32 v44, 16, v18
  v_and_b32 v45, 0xffff0000, v18
  v_lshlrev_b32 v46, 16, v19
  v_and_b32 v47, 0xffff0000, v19
  v_lshlrev_b32 v152, 16, v152
  v_mul_f32 v40, v40, v152
  v_lshlrev_b32 v153, 16, v153
  v_mul_f32 v41, v41, v153
  v_lshlrev_b32 v154, 16, v154
  v_mul_f32 v42, v42, v154
  v_lshlrev_b32 v155, 16, v155
  v_mul_f32 v43, v43, v155
  v_cvt_pk_bf16_f32 v14, v40, v41
  v_lshlrev_b32 v40, 16, v14
  v_and_b32 v41, 0xffff0000, v14
  v_cvt_pk_bf16_f32 v14, v42, v43
  v_lshlrev_b32 v42, 16, v14
  v_and_b32 v43, 0xffff0000, v14
  v_add_f32 v40, v40, v44
  v_add_f32 v41, v41, v45
  v_add_f32 v42, v42, v46
  v_add_f32 v43, v43, v47
  v_cvt_pk_bf16_f32 v14, v40, v41
  v_lshlrev_b32 v40, 16, v14
  v_and_b32 v41, 0xffff0000, v14
  v_cvt_pk_bf16_f32 v14, v42, v43
  v_lshlrev_b32 v42, 16, v14
  v_and_b32 v43, 0xffff0000, v14
  v_add_f32 v40, v40, v196
  v_add_f32 v41, v41, v197
  v_add_f32 v42, v42, v198
  v_add_f32 v43, v43, v199
  v_cvt_pk_bf16_f32 v196, v40, v41
  v_cvt_pk_bf16_f32 v197, v42, v43
  s_mul_i32 s29, s31, 288
  s_add_u32 s29, s29, 32
  buffer_store_dwordx2 v[196:197], v10, s[8:11], s29 offen
  s_endpgm
p4_fin1_1:
  s_mul_i32 s29, s31, 288
  s_add_u32 s29, s29, 64
  buffer_load_dwordx2 v[16:17], v10, s[4:7], s29 offen
  s_mul_i32 s27, s31, 9
  s_add_u32 s27, s27, 2
  s_lshr_b32 s29, s27, 1
  s_lshl_b32 s29, s29, 10
  s_and_b32 s27, s27, 1
  s_lshl_b32 s27, s27, 3
  s_add_u32 s29, s29, s27
  s_mul_i32 s27, s43, 18432
  s_add_u32 s29, s29, s27
  buffer_load_dwordx2 v[28:29], v15, s[12:15], s29 offen sc1
  s_mul_i32 s29, s31, 288
  s_add_u32 s29, s29, 96
  buffer_load_dwordx2 v[18:19], v10, s[4:7], s29 offen
  s_mul_i32 s27, s31, 9
  s_add_u32 s27, s27, 3
  s_lshr_b32 s29, s27, 1
  s_lshl_b32 s29, s29, 10
  s_and_b32 s27, s27, 1
  s_lshl_b32 s27, s27, 3
  s_add_u32 s29, s29, s27
  s_mul_i32 s27, s43, 18432
  s_add_u32 s29, s29, s27
  buffer_load_dwordx2 v[30:31], v15, s[12:15], s29 offen sc1
  v_lshlrev_b32 v11, 2, v2
  v_min_u32 v11, 124, v11
  s_mul_i32 s54, s31, 576
  s_add_u32 s54, s54, 41088
  s_mov_b32 s55, 0
p4_poll1_1:
  buffer_load_dword v35, v13, s[32:35], s52 offen sc0 sc1
  buffer_load_dword v36, v11, s[32:35], s54 offen sc0 sc1
  s_waitcnt vmcnt(0)
  v_xor_b32 v35, s85, v35
  v_xor_b32 v36, s85, v36
  v_or_b32 v35, v35, v36
  v_cmp_ne_u32 vcc, 0, v35
  s_cmp_eq_u64 vcc, 0
  s_cbranch_scc1 p4_poll1_1_done
  s_add_u32 s55, s55, 1
  s_cmp_ge_u32 s55, 200000
  s_cbranch_scc1 p4_poll1_1_done
  s_sleep 2
  s_branch p4_poll1_1
p4_poll1_1_done:
  s_add_u32 s29, s44, 1024
  buffer_load_dwordx4 v[40:43], v15, s[16:19], s29 offen sc0 sc1
  s_add_u32 s29, s44, 9438208
  buffer_load_dwordx4 v[44:47], v15, s[16:19], s29 offen sc0 sc1
  s_add_u32 s29, s44, 14156800
  buffer_load_dwordx4 v[48:51], v15, s[16:19], s29 offen sc0 sc1
  s_mul_i32 s27, s31, 589824
  s_add_u32 s29, s27, 131072
  buffer_load_ushort v148, v12, s[48:51], s29 offen sc0 sc1
  s_add_u32 s29, s27, 135168
  buffer_load_ushort v149, v12, s[48:51], s29 offen sc0 sc1
  s_add_u32 s29, s27, 139264
  buffer_load_ushort v150, v12, s[48:51], s29 offen sc0 sc1
  s_add_u32 s29, s27, 143360
  buffer_load_ushort v151, v12, s[48:51], s29 offen sc0 sc1
  s_mul_i32 s27, s31, 589824
  s_add_u32 s29, s27, 196608
  buffer_load_ushort v152, v12, s[48:51], s29 offen sc0 sc1
  s_add_u32 s29, s27, 200704
  buffer_load_ushort v153, v12, s[48:51], s29 offen sc0 sc1
  s_add_u32 s29, s27, 204800
  buffer_load_ushort v154, v12, s[48:51], s29 offen sc0 sc1
  s_add_u32 s29, s27, 208896
  buffer_load_ushort v155, v12, s[48:51], s29 offen sc0 sc1
  s_waitcnt vmcnt(8)
  v_lshlrev_b32 v64, 16, v40
  v_and_b32 v65, 0xffff0000, v40
  v_lshlrev_b32 v66, 16, v41
  v_and_b32 v67, 0xffff0000, v41
  v_add_f32 v204, v204, v64
  v_add_f32 v205, v205, v65
  v_add_f32 v206, v206, v66
  v_add_f32 v207, v207, v67
  v_lshlrev_b32 v64, 16, v44
  v_and_b32 v65, 0xffff0000, v44
  v_lshlrev_b32 v66, 16, v45
  v_and_b32 v67, 0xffff0000, v45
  v_add_f32 v204, v204, v64
  v_add_f32 v205, v205, v65
  v_add_f32 v206, v206, v66
  v_add_f32 v207, v207, v67
  v_lshlrev_b32 v64, 16, v48
  v_and_b32 v65, 0xffff0000, v48
  v_lshlrev_b32 v66, 16, v49
  v_and_b32 v67, 0xffff0000, v49
  v_add_f32 v204, v204, v64
  v_add_f32 v205, v205, v65
  v_add_f32 v206, v206, v66
  v_add_f32 v207, v207, v67
  v_cvt_pk_bf16_f32 v14, v204, v205
  v_lshlrev_b32 v204, 16, v14
  v_and_b32 v205, 0xffff0000, v14
  v_cvt_pk_bf16_f32 v14, v206, v207
  v_lshlrev_b32 v206, 16, v14
  v_and_b32 v207, 0xffff0000, v14
  s_waitcnt vmcnt(8)
  v_lshlrev_b32 v64, 16, v42
  v_and_b32 v65, 0xffff0000, v42
  v_lshlrev_b32 v66, 16, v43
  v_and_b32 v67, 0xffff0000, v43
  v_add_f32 v212, v212, v64
  v_add_f32 v213, v213, v65
  v_add_f32 v214, v214, v66
  v_add_f32 v215, v215, v67
  v_lshlrev_b32 v64, 16, v46
  v_and_b32 v65, 0xffff0000, v46
  v_lshlrev_b32 v66, 16, v47
  v_and_b32 v67, 0xffff0000, v47
  v_add_f32 v212, v212, v64
  v_add_f32 v213, v213, v65
  v_add_f32 v214, v214, v66
  v_add_f32 v215, v215, v67
  v_lshlrev_b32 v64, 16, v50
  v_and_b32 v65, 0xffff0000, v50
  v_lshlrev_b32 v66, 16, v51
  v_and_b32 v67, 0xffff0000, v51
  v_add_f32 v212, v212, v64
  v_add_f32 v213, v213, v65
  v_add_f32 v214, v214, v66
  v_add_f32 v215, v215, v67
  v_cvt_pk_bf16_f32 v14, v212, v213
  v_lshlrev_b32 v212, 16, v14
  v_and_b32 v213, 0xffff0000, v14
  v_cvt_pk_bf16_f32 v14, v214, v215
  v_lshlrev_b32 v214, 16, v14
  v_and_b32 v215, 0xffff0000, v14
  s_waitcnt vmcnt(4)
  v_lshlrev_b32 v40, 16, v28
  v_and_b32 v41, 0xffff0000, v28
  v_lshlrev_b32 v42, 16, v29
  v_and_b32 v43, 0xffff0000, v29
  v_lshlrev_b32 v44, 16, v16
  v_and_b32 v45, 0xffff0000, v16
  v_lshlrev_b32 v46, 16, v17
  v_and_b32 v47, 0xffff0000, v17
  v_lshlrev_b32 v148, 16, v148
  v_mul_f32 v40, v40, v148
  v_lshlrev_b32 v149, 16, v149
  v_mul_f32 v41, v41, v149
  v_lshlrev_b32 v150, 16, v150
  v_mul_f32 v42, v42, v150
  v_lshlrev_b32 v151, 16, v151
  v_mul_f32 v43, v43, v151
  v_cvt_pk_bf16_f32 v14, v40, v41
  v_lshlrev_b32 v40, 16, v14
  v_and_b32 v41, 0xffff0000, v14
  v_cvt_pk_bf16_f32 v14, v42, v43
  v_lshlrev_b32 v42, 16, v14
  v_and_b32 v43, 0xffff0000, v14
  v_add_f32 v40, v40, v44
  v_add_f32 v41, v41, v45
  v_add_f32 v42, v42, v46
  v_add_f32 v43, v43, v47
  v_cvt_pk_bf16_f32 v14, v40, v41
  v_lshlrev_b32 v40, 16, v14
  v_and_b32 v41, 0xffff0000, v14
  v_cvt_pk_bf16_f32 v14, v42, v43
  v_lshlrev_b32 v42, 16, v14
  v_and_b32 v43, 0xffff0000, v14
  v_add_f32 v40, v40, v204
  v_add_f32 v41, v41, v205
  v_add_f32 v42, v42, v206
  v_add_f32 v43, v43, v207
  v_cvt_pk_bf16_f32 v204, v40, v41
  v_cvt_pk_bf16_f32 v205, v42, v43
  s_mul_i32 s29, s31, 288
  s_add_u32 s29, s29, 64
  buffer_store_dwordx2 v[204:205], v10, s[8:11], s29 offen
  s_waitcnt vmcnt(1)
  v_lshlrev_b32 v40, 16, v30
  v_and_b32 v41, 0xffff0000, v30
  v_lshlrev_b32 v42, 16, v31
  v_and_b32 v43, 0xffff0000, v31
  v_lshlrev_b32 v44, 16, v18
  v_and_b32 v45, 0xffff0000, v18
  v_lshlrev_b32 v46, 16, v19
  v_and_b32 v47, 0xffff0000, v19
  v_lshlrev_b32 v152, 16, v152
  v_mul_f32 v40, v40, v152
  v_lshlrev_b32 v153, 16, v153
  v_mul_f32 v41, v41, v153
  v_lshlrev_b32 v154, 16, v154
  v_mul_f32 v42, v42, v154
  v_lshlrev_b32 v155, 16, v155
  v_mul_f32 v43, v43, v155
  v_cvt_pk_bf16_f32 v14, v40, v41
  v_lshlrev_b32 v40, 16, v14
  v_and_b32 v41, 0xffff0000, v14
  v_cvt_pk_bf16_f32 v14, v42, v43
  v_lshlrev_b32 v42, 16, v14
  v_and_b32 v43, 0xffff0000, v14
  v_add_f32 v40, v40, v44
  v_add_f32 v41, v41, v45
  v_add_f32 v42, v42, v46
  v_add_f32 v43, v43, v47
  v_cvt_pk_bf16_f32 v14, v40, v41
  v_lshlrev_b32 v40, 16, v14
  v_and_b32 v41, 0xffff0000, v14
  v_cvt_pk_bf16_f32 v14, v42, v43
  v_lshlrev_b32 v42, 16, v14
  v_and_b32 v43, 0xffff0000, v14
  v_add_f32 v40, v40, v212
  v_add_f32 v41, v41, v213
  v_add_f32 v42, v42, v214
  v_add_f32 v43, v43, v215
  v_cvt_pk_bf16_f32 v212, v40, v41
  v_cvt_pk_bf16_f32 v213, v42, v43
  s_mul_i32 s29, s31, 288
  s_add_u32 s29, s29, 96
  buffer_store_dwordx2 v[212:213], v10, s[8:11], s29 offen
  s_endpgm
p4_fin1_2:
  s_mul_i32 s29, s31, 288
  s_add_u32 s29, s29, 128
  buffer_load_dwordx2 v[16:17], v10, s[4:7], s29 offen
  s_mul_i32 s27, s31, 9
  s_add_u32 s27, s27, 4
  s_lshr_b32 s29, s27, 1
  s_lshl_b32 s29, s29, 10
  s_and_b32 s27, s27, 1
  s_lshl_b32 s27, s27, 3
  s_add_u32 s29, s29, s27
  s_mul_i32 s27, s43, 18432
  s_add_u32 s29, s29, s27
  buffer_load_dwordx2 v[28:29], v15, s[12:15], s29 offen sc1
  s_mul_i32 s29, s31, 288
  s_add_u32 s29, s29, 160
  buffer_load_dwordx2 v[18:19], v10, s[4:7], s29 offen
  s_mul_i32 s27, s31, 9
  s_add_u32 s27, s27, 5
  s_lshr_b32 s29, s27, 1
  s_lshl_b32 s29, s29, 10
  s_and_b32 s27, s27, 1
  s_lshl_b32 s27, s27, 3
  s_add_u32 s29, s29, s27
  s_mul_i32 s27, s43, 18432
  s_add_u32 s29, s29, s27
  buffer_load_dwordx2 v[30:31], v15, s[12:15], s29 offen sc1
  v_lshlrev_b32 v11, 2, v2
  v_min_u32 v11, 124, v11
  s_mul_i32 s54, s31, 576
  s_add_u32 s54, s54, 41216
  s_mov_b32 s55, 0
p4_poll1_2:
  buffer_load_dword v35, v13, s[32:35], s52 offen sc0 sc1
  buffer_load_dword v36, v11, s[32:35], s54 offen sc0 sc1
  s_waitcnt vmcnt(0)
  v_xor_b32 v35, s85, v35
  v_xor_b32 v36, s85, v36
  v_or_b32 v35, v35, v36
  v_cmp_ne_u32 vcc, 0, v35
  s_cmp_eq_u64 vcc, 0
  s_cbranch_scc1 p4_poll1_2_done
  s_add_u32 s55, s55, 1
  s_cmp_ge_u32 s55, 200000
  s_cbranch_scc1 p4_poll1_2_done
  s_sleep 2
  s_branch p4_poll1_2
p4_poll1_2_done:
  s_add_u32 s29, s44, 2048
  buffer_load_dwordx4 v[40:43], v15, s[16:19], s29 offen sc0 sc1
  s_add_u32 s29, s44, 4720640
  buffer_load_dwordx4 v[44:47], v15, s[16:19], s29 offen sc0 sc1
  s_add_u32 s29, s44, 14157824
  buffer_load_dwordx4 v[48:51], v15, s[16:19], s29 offen sc0 sc1
  s_mul_i32 s27, s31, 589824
  s_add_u32 s29, s27, 262144
  buffer_load_ushort v148, v12, s[48:51], s29 offen sc0 sc1
  s_add_u32 s29, s27, 266240
  buffer_load_ushort v149, v12, s[48:51], s29 offen sc0 sc1
  s_add_u32 s29, s27, 270336
  buffer_load_ushort v150, v12, s[48:51], s29 offen sc0 sc1
  s_add_u32 s29, s27, 274432
  buffer_load_ushort v151, v12, s[48:51], s29 offen sc0 sc1
  s_mul_i32 s27, s31, 589824
  s_add_u32 s29, s27, 327680
  buffer_load_ushort v152, v12, s[48:51], s29 offen sc0 sc1
  s_add_u32 s29, s27, 331776
  buffer_load_ushort v153, v12, s[48:51], s29 offen sc0 sc1
  s_add_u32 s29, s27, 335872
  buffer_load_ushort v154, v12, s[48:51], s29 offen sc0 sc1
  s_add_u32 s29, s27, 339968
  buffer_load_ushort v155, v12, s[48:51], s29 offen sc0 sc1
  s_waitcnt vmcnt(8)
  v_lshlrev_b32 v64, 16, v40
  v_and_b32 v65, 0xffff0000, v40
  v_lshlrev_b32 v66, 16, v41
  v_and_b32 v67, 0xffff0000, v41
  v_add_f32 v220, v220, v64
  v_add_f32 v221, v221, v65
  v_add_f32 v222, v222, v66
  v_add_f32 v223, v223, v67
  v_lshlrev_b32 v64, 16, v44
  v_and_b32 v65, 0xffff0000, v44
  v_lshlrev_b32 v66, 16, v45
  v_and_b32 v67, 0xffff0000, v45
  v_add_f32 v220, v220, v64
  v_add_f32 v221, v221, v65
  v_add_f32 v222, v222, v66
  v_add_f32 v223, v223, v67
  v_lshlrev_b32 v64, 16, v48
  v_and_b32 v65, 0xffff0000, v48
  v_lshlrev_b32 v66, 16, v49
  v_and_b32 v67, 0xffff0000, v49
  v_add_f32 v220, v220, v64
  v_add_f32 v221, v221, v65
  v_add_f32 v222, v222, v66
  v_add_f32 v223, v223, v67
  v_cvt_pk_bf16_f32 v14, v220, v221
  v_lshlrev_b32 v220, 16, v14
  v_and_b32 v221, 0xffff0000, v14
  v_cvt_pk_bf16_f32 v14, v222, v223
  v_lshlrev_b32 v222, 16, v14
  v_and_b32 v223, 0xffff0000, v14
  s_waitcnt vmcnt(8)
  v_lshlrev_b32 v64, 16, v42
  v_and_b32 v65, 0xffff0000, v42
  v_lshlrev_b32 v66, 16, v43
  v_and_b32 v67, 0xffff0000, v43
  v_add_f32 v228, v228, v64
  v_add_f32 v229, v229, v65
  v_add_f32 v230, v230, v66
  v_add_f32 v231, v231, v67
  v_lshlrev_b32 v64, 16, v46
  v_and_b32 v65, 0xffff0000, v46
  v_lshlrev_b32 v66, 16, v47
  v_and_b32 v67, 0xffff0000, v47
  v_add_f32 v228, v228, v64
  v_add_f32 v229, v229, v65
  v_add_f32 v230, v230, v66
  v_add_f32 v231, v231, v67
  v_lshlrev_b32 v64, 16, v50
  v_and_b32 v65, 0xffff0000, v50
  v_lshlrev_b32 v66, 16, v51
  v_and_b32 v67, 0xffff0000, v51
  v_add_f32 v228, v228, v64
  v_add_f32 v229, v229, v65
  v_add_f32 v230, v230, v66
  v_add_f32 v231, v231, v67
  v_cvt_pk_bf16_f32 v14, v228, v229
  v_lshlrev_b32 v228, 16, v14
  v_and_b32 v229, 0xffff0000, v14
  v_cvt_pk_bf16_f32 v14, v230, v231
  v_lshlrev_b32 v230, 16, v14
  v_and_b32 v231, 0xffff0000, v14
  s_waitcnt vmcnt(4)
  v_lshlrev_b32 v40, 16, v28
  v_and_b32 v41, 0xffff0000, v28
  v_lshlrev_b32 v42, 16, v29
  v_and_b32 v43, 0xffff0000, v29
  v_lshlrev_b32 v44, 16, v16
  v_and_b32 v45, 0xffff0000, v16
  v_lshlrev_b32 v46, 16, v17
  v_and_b32 v47, 0xffff0000, v17
  v_lshlrev_b32 v148, 16, v148
  v_mul_f32 v40, v40, v148
  v_lshlrev_b32 v149, 16, v149
  v_mul_f32 v41, v41, v149
  v_lshlrev_b32 v150, 16, v150
  v_mul_f32 v42, v42, v150
  v_lshlrev_b32 v151, 16, v151
  v_mul_f32 v43, v43, v151
  v_cvt_pk_bf16_f32 v14, v40, v41
  v_lshlrev_b32 v40, 16, v14
  v_and_b32 v41, 0xffff0000, v14
  v_cvt_pk_bf16_f32 v14, v42, v43
  v_lshlrev_b32 v42, 16, v14
  v_and_b32 v43, 0xffff0000, v14
  v_add_f32 v40, v40, v44
  v_add_f32 v41, v41, v45
  v_add_f32 v42, v42, v46
  v_add_f32 v43, v43, v47
  v_cvt_pk_bf16_f32 v14, v40, v41
  v_lshlrev_b32 v40, 16, v14
  v_and_b32 v41, 0xffff0000, v14
  v_cvt_pk_bf16_f32 v14, v42, v43
  v_lshlrev_b32 v42, 16, v14
  v_and_b32 v43, 0xffff0000, v14
  v_add_f32 v40, v40, v220
  v_add_f32 v41, v41, v221
  v_add_f32 v42, v42, v222
  v_add_f32 v43, v43, v223
  v_cvt_pk_bf16_f32 v220, v40, v41
  v_cvt_pk_bf16_f32 v221, v42, v43
  s_mul_i32 s29, s31, 288
  s_add_u32 s29, s29, 128
  buffer_store_dwordx2 v[220:221], v10, s[8:11], s29 offen
  s_waitcnt vmcnt(1)
  v_lshlrev_b32 v40, 16, v30
  v_and_b32 v41, 0xffff0000, v30
  v_lshlrev_b32 v42, 16, v31
  v_and_b32 v43, 0xffff0000, v31
  v_lshlrev_b32 v44, 16, v18
  v_and_b32 v45, 0xffff0000, v18
  v_lshlrev_b32 v46, 16, v19
  v_and_b32 v47, 0xffff0000, v19
  v_lshlrev_b32 v152, 16, v152
  v_mul_f32 v40, v40, v152
  v_lshlrev_b32 v153, 16, v153
  v_mul_f32 v41, v41, v153
  v_lshlrev_b32 v154, 16, v154
  v_mul_f32 v42, v42, v154
  v_lshlrev_b32 v155, 16, v155
  v_mul_f32 v43, v43, v155
  v_cvt_pk_bf16_f32 v14, v40, v41
  v_lshlrev_b32 v40, 16, v14
  v_and_b32 v41, 0xffff0000, v14
  v_cvt_pk_bf16_f32 v14, v42, v43
  v_lshlrev_b32 v42, 16, v14
  v_and_b32 v43, 0xffff0000, v14
  v_add_f32 v40, v40, v44
  v_add_f32 v41, v41, v45
  v_add_f32 v42, v42, v46
  v_add_f32 v43, v43, v47
  v_cvt_pk_bf16_f32 v14, v40, v41
  v_lshlrev_b32 v40, 16, v14
  v_and_b32 v41, 0xffff0000, v14
  v_cvt_pk_bf16_f32 v14, v42, v43
  v_lshlrev_b32 v42, 16, v14
  v_and_b32 v43, 0xffff0000, v14
  v_add_f32 v40, v40, v228
  v_add_f32 v41, v41, v229
  v_add_f32 v42, v42, v230
  v_add_f32 v43, v43, v231
  v_cvt_pk_bf16_f32 v228, v40, v41
  v_cvt_pk_bf16_f32 v229, v42, v43
  s_mul_i32 s29, s31, 288
  s_add_u32 s29, s29, 160
  buffer_store_dwordx2 v[228:229], v10, s[8:11], s29 offen
  s_endpgm
p4_fin1_3:
  s_mul_i32 s29, s31, 288
  s_add_u32 s29, s29, 192
  buffer_load_dwordx2 v[16:17], v10, s[4:7], s29 offen
  s_mul_i32 s27, s31, 9
  s_add_u32 s27, s27, 6
  s_lshr_b32 s29, s27, 1
  s_lshl_b32 s29, s29, 10
  s_and_b32 s27, s27, 1
  s_lshl_b32 s27, s27, 3
  s_add_u32 s29, s29, s27
  s_mul_i32 s27, s43, 18432
  s_add_u32 s29, s29, s27
  buffer_load_dwordx2 v[28:29], v15, s[12:15], s29 offen sc1
  s_mul_i32 s29, s31, 288
  s_add_u32 s29, s29, 224
  buffer_load_dwordx2 v[18:19], v10, s[4:7], s29 offen
  s_mul_i32 s27, s31, 9
  s_add_u32 s27, s27, 7
  s_lshr_b32 s29, s27, 1
  s_lshl_b32 s29, s29, 10
  s_and_b32 s27, s27, 1
  s_lshl_b32 s27, s27, 3
  s_add_u32 s29, s29, s27
  s_mul_i32 s27, s43, 18432
  s_add_u32 s29, s29, s27
  buffer_load_dwordx2 v[30:31], v15, s[12:15], s29 offen sc1
  s_mul_i32 s29, s31, 288
  s_add_u32 s29, s29, 256
  buffer_load_dwordx2 v[20:21], v10, s[4:7], s29 offen
  s_mul_i32 s27, s31, 9
  s_add_u32 s27, s27, 8
  s_lshr_b32 s29, s27, 1
  s_lshl_b32 s29, s29, 10
  s_and_b32 s27, s27, 1
  s_lshl_b32 s27, s27, 3
  s_add_u32 s29, s29, s27
  s_mul_i32 s27, s43, 18432
  s_add_u32 s29, s29, s27
  buffer_load_dwordx2 v[32:33], v15, s[12:15], s29 offen sc1
  v_lshlrev_b32 v11, 2, v2
  v_min_u32 v11, 188, v11
  s_mul_i32 s54, s31, 576
  s_add_u32 s54, s54, 41344
  s_mov_b32 s55, 0
p4_poll1_3:
  buffer_load_dword v35, v13, s[32:35], s52 offen sc0 sc1
  buffer_load_dword v36, v11, s[32:35], s54 offen sc0 sc1
  s_waitcnt vmcnt(0)
  v_xor_b32 v35, s85, v35
  v_xor_b32 v36, s85, v36
  v_or_b32 v35, v35, v36
  v_cmp_ne_u32 vcc, 0, v35
  s_cmp_eq_u64 vcc, 0
  s_cbranch_scc1 p4_poll1_3_done
  s_add_u32 s55, s55, 1
  s_cmp_ge_u32 s55, 200000
  s_cbranch_scc1 p4_poll1_3_done
  s_sleep 2
  s_branch p4_poll1_3
p4_poll1_3_done:
  s_add_u32 s29, s44, 3072
  buffer_load_dwordx4 v[40:43], v15, s[16:19], s29 offen sc0 sc1
  s_add_u32 s29, s44, 4721664
  buffer_load_dwordx4 v[44:47], v15, s[16:19], s29 offen sc0 sc1
  s_add_u32 s29, s44, 9440256
  buffer_load_dwordx4 v[48:51], v15, s[16:19], s29 offen sc0 sc1
  s_add_u32 s29, s44, 4096
  buffer_load_dwordx4 v[52:55], v15, s[16:19], s29 offen sc0 sc1
  s_add_u32 s29, s44, 4722688
  buffer_load_dwordx4 v[56:59], v15, s[16:19], s29 offen sc0 sc1
  s_add_u32 s29, s44, 9441280
  buffer_load_dwordx4 v[60:63], v15, s[16:19], s29 offen sc0 sc1
  s_mul_i32 s27, s31, 589824
  s_add_u32 s29, s27, 393216
  buffer_load_ushort v148, v12, s[48:51], s29 offen sc0 sc1
  s_add_u32 s29, s27, 397312
  buffer_load_ushort v149, v12, s[48:51], s29 offen sc0 sc1
  s_add_u32 s29, s27, 401408
  buffer_load_ushort v150, v12, s[48:51], s29 offen sc0 sc1
  s_add_u32 s29, s27, 405504
  buffer_load_ushort v151, v12, s[48:51], s29 offen sc0 sc1
  s_mul_i32 s27, s31, 589824
  s_add_u32 s29, s27, 458752
  buffer_load_ushort v152, v12, s[48:51], s29 offen sc0 sc1
  s_add_u32 s29, s27, 462848
  buffer_load_ushort v153, v12, s[48:51], s29 offen sc0 sc1
  s_add_u32 s29, s27, 466944
  buffer_load_ushort v154, v12, s[48:51], s29 offen sc0 sc1
  s_add_u32 s29, s27, 471040
  buffer_load_ushort v155, v12, s[48:51], s29 offen sc0 sc1
  s_mul_i32 s27, s31, 589824
  s_add_u32 s29, s27, 524288
  buffer_load_ushort v156, v12, s[48:51], s29 offen sc0 sc1
  s_add_u32 s29, s27, 528384
  buffer_load_ushort v157, v12, s[48:51], s29 offen sc0 sc1
  s_add_u32 s29, s27, 532480
  buffer_load_ushort v158, v12, s[48:51], s29 offen sc0 sc1
  s_add_u32 s29, s27, 536576
  buffer_load_ushort v159, v12, s[48:51], s29 offen sc0 sc1
  s_waitcnt vmcnt(15)
  v_lshlrev_b32 v64, 16, v40
  v_and_b32 v65, 0xffff0000, v40
  v_lshlrev_b32 v66, 16, v41
  v_and_b32 v67, 0xffff0000, v41
  v_add_f32 v236, v236, v64
  v_add_f32 v237, v237, v65
  v_add_f32 v238, v238, v66
  v_add_f32 v239, v239, v67
  v_lshlrev_b32 v64, 16, v44
  v_and_b32 v65, 0xffff0000, v44
  v_lshlrev_b32 v66, 16, v45
  v_and_b32 v67, 0xffff0000, v45
  v_add_f32 v236, v236, v64
  v_add_f32 v237, v237, v65
  v_add_f32 v238, v238, v66
  v_add_f32 v239, v239, v67
  v_lshlrev_b32 v64, 16, v48
  v_and_b32 v65, 0xffff0000, v48
  v_lshlrev_b32 v66, 16, v49
  v_and_b32 v67, 0xffff0000, v49
  v_add_f32 v236, v236, v64
  v_add_f32 v237, v237, v65
  v_add_f32 v238, v238, v66
  v_add_f32 v239, v239, v67
  v_cvt_pk_bf16_f32 v14, v236, v237
  v_lshlrev_b32 v236, 16, v14
  v_and_b32 v237, 0xffff0000, v14
  v_cvt_pk_bf16_f32 v14, v238, v239
  v_lshlrev_b32 v238, 16, v14
  v_and_b32 v239, 0xffff0000, v14
  s_waitcnt vmcnt(15)
  v_lshlrev_b32 v64, 16, v42
  v_and_b32 v65, 0xffff0000, v42
  v_lshlrev_b32 v66, 16, v43
  v_and_b32 v67, 0xffff0000, v43
  v_add_f32 v244, v244, v64
  v_add_f32 v245, v245, v65
  v_add_f32 v246, v246, v66
  v_add_f32 v247, v247, v67
  v_lshlrev_b32 v64, 16, v46
  v_and_b32 v65, 0xffff0000, v46
  v_lshlrev_b32 v66, 16, v47
  v_and_b32 v67, 0xffff0000, v47
  v_add_f32 v244, v244, v64
  v_add_f32 v245, v245, v65
  v_add_f32 v246, v246, v66
  v_add_f32 v247, v247, v67
  v_lshlrev_b32 v64, 16, v50
  v_and_b32 v65, 0xffff0000, v50
  v_lshlrev_b32 v66, 16, v51
  v_and_b32 v67, 0xffff0000, v51
  v_add_f32 v244, v244, v64
  v_add_f32 v245, v245, v65
  v_add_f32 v246, v246, v66
  v_add_f32 v247, v247, v67
  v_cvt_pk_bf16_f32 v14, v244, v245
  v_lshlrev_b32 v244, 16, v14
  v_and_b32 v245, 0xffff0000, v14
  v_cvt_pk_bf16_f32 v14, v246, v247
  v_lshlrev_b32 v246, 16, v14
  v_and_b32 v247, 0xffff0000, v14
  s_waitcnt vmcnt(12)
  v_lshlrev_b32 v64, 16, v52
  v_and_b32 v65, 0xffff0000, v52
  v_lshlrev_b32 v66, 16, v53
  v_and_b32 v67, 0xffff0000, v53
  v_add_f32 v252, v252, v64
  v_add_f32 v253, v253, v65
  v_add_f32 v254, v254, v66
  v_add_f32 v255, v255, v67
  v_lshlrev_b32 v64, 16, v56
  v_and_b32 v65, 0xffff0000, v56
  v_lshlrev_b32 v66, 16, v57
  v_and_b32 v67, 0xffff0000, v57
  v_add_f32 v252, v252, v64
  v_add_f32 v253, v253, v65
  v_add_f32 v254, v254, v66
  v_add_f32 v255, v255, v67
  v_lshlrev_b32 v64, 16, v60
  v_and_b32 v65, 0xffff0000, v60
  v_lshlrev_b32 v66, 16, v61
  v_and_b32 v67, 0xffff0000, v61
  v_add_f32 v252, v252, v64
  v_add_f32 v253, v253, v65
  v_add_f32 v254, v254, v66
  v_add_f32 v255, v255, v67
  v_cvt_pk_bf16_f32 v14, v252, v253
  v_lshlrev_b32 v252, 16, v14
  v_and_b32 v253, 0xffff0000, v14
  v_cvt_pk_bf16_f32 v14, v254, v255
  v_lshlrev_b32 v254, 16, v14
  v_and_b32 v255, 0xffff0000, v14
  s_waitcnt vmcnt(8)
  v_lshlrev_b32 v40, 16, v28
  v_and_b32 v41, 0xffff0000, v28
  v_lshlrev_b32 v42, 16, v29
  v_and_b32 v43, 0xffff0000, v29
  v_lshlrev_b32 v44, 16, v16
  v_and_b32 v45, 0xffff0000, v16
  v_lshlrev_b32 v46, 16, v17
  v_and_b32 v47, 0xffff0000, v17
  v_lshlrev_b32 v148, 16, v148
  v_mul_f32 v40, v40, v148
  v_lshlrev_b32 v149, 16, v149
  v_mul_f32 v41, v41, v149
  v_lshlrev_b32 v150, 16, v150
  v_mul_f32 v42, v42, v150
  v_lshlrev_b32 v151, 16, v151
  v_mul_f32 v43, v43, v151
  v_cvt_pk_bf16_f32 v14, v40, v41
  v_lshlrev_b32 v40, 16, v14
  v_and_b32 v41, 0xffff0000, v14
  v_cvt_pk_bf16_f32 v14, v42, v43
  v_lshlrev_b32 v42, 16, v14
  v_and_b32 v43, 0xffff0000, v14
  v_add_f32 v40, v40, v44
  v_add_f32 v41, v41, v45
  v_add_f32 v42, v42, v46
  v_add_f32 v43, v43, v47
  v_cvt_pk_bf16_f32 v14, v40, v41
  v_lshlrev_b32 v40, 16, v14
  v_and_b32 v41, 0xffff0000, v14
  v_cvt_pk_bf16_f32 v14, v42, v43
  v_lshlrev_b32 v42, 16, v14
  v_and_b32 v43, 0xffff0000, v14
  v_add_f32 v40, v40, v236
  v_add_f32 v41, v41, v237
  v_add_f32 v42, v42, v238
  v_add_f32 v43, v43, v239
  v_cvt_pk_bf16_f32 v236, v40, v41
  v_cvt_pk_bf16_f32 v237, v42, v43
  s_mul_i32 s29, s31, 288
  s_add_u32 s29, s29, 192
  buffer_store_dwordx2 v[236:237], v10, s[8:11], s29 offen
  s_waitcnt vmcnt(5)
  v_lshlrev_b32 v40, 16, v30
  v_and_b32 v41, 0xffff0000, v30
  v_lshlrev_b32 v42, 16, v31
  v_and_b32 v43, 0xffff0000, v31
  v_lshlrev_b32 v44, 16, v18
  v_and_b32 v45, 0xffff0000, v18
  v_lshlrev_b32 v46, 16, v19
  v_and_b32 v47, 0xffff0000, v19
  v_lshlrev_b32 v152, 16, v152
  v_mul_f32 v40, v40, v152
  v_lshlrev_b32 v153, 16, v153
  v_mul_f32 v41, v41, v153
  v_lshlrev_b32 v154, 16, v154
  v_mul_f32 v42, v42, v154
  v_lshlrev_b32 v155, 16, v155
  v_mul_f32 v43, v43, v155
  v_cvt_pk_bf16_f32 v14, v40, v41
  v_lshlrev_b32 v40, 16, v14
  v_and_b32 v41, 0xffff0000, v14
  v_cvt_pk_bf16_f32 v14, v42, v43
  v_lshlrev_b32 v42, 16, v14
  v_and_b32 v43, 0xffff0000, v14
  v_add_f32 v40, v40, v44
  v_add_f32 v41, v41, v45
  v_add_f32 v42, v42, v46
  v_add_f32 v43, v43, v47
  v_cvt_pk_bf16_f32 v14, v40, v41
  v_lshlrev_b32 v40, 16, v14
  v_and_b32 v41, 0xffff0000, v14
  v_cvt_pk_bf16_f32 v14, v42, v43
  v_lshlrev_b32 v42, 16, v14
  v_and_b32 v43, 0xffff0000, v14
  v_add_f32 v40, v40, v244
  v_add_f32 v41, v41, v245
  v_add_f32 v42, v42, v246
  v_add_f32 v43, v43, v247
  v_cvt_pk_bf16_f32 v244, v40, v41
  v_cvt_pk_bf16_f32 v245, v42, v43
  s_mul_i32 s29, s31, 288
  s_add_u32 s29, s29, 224
  buffer_store_dwordx2 v[244:245], v10, s[8:11], s29 offen
  s_waitcnt vmcnt(2)
  v_lshlrev_b32 v40, 16, v32
  v_and_b32 v41, 0xffff0000, v32
  v_lshlrev_b32 v42, 16, v33
  v_and_b32 v43, 0xffff0000, v33
  v_lshlrev_b32 v44, 16, v20
  v_and_b32 v45, 0xffff0000, v20
  v_lshlrev_b32 v46, 16, v21
  v_and_b32 v47, 0xffff0000, v21
  v_lshlrev_b32 v156, 16, v156
  v_mul_f32 v40, v40, v156
  v_lshlrev_b32 v157, 16, v157
  v_mul_f32 v41, v41, v157
  v_lshlrev_b32 v158, 16, v158
  v_mul_f32 v42, v42, v158
  v_lshlrev_b32 v159, 16, v159
  v_mul_f32 v43, v43, v159
  v_cvt_pk_bf16_f32 v14, v40, v41
  v_lshlrev_b32 v40, 16, v14
  v_and_b32 v41, 0xffff0000, v14
  v_cvt_pk_bf16_f32 v14, v42, v43
  v_lshlrev_b32 v42, 16, v14
  v_and_b32 v43, 0xffff0000, v14
  v_add_f32 v40, v40, v44
  v_add_f32 v41, v41, v45
  v_add_f32 v42, v42, v46
  v_add_f32 v43, v43, v47
  v_cvt_pk_bf16_f32 v14, v40, v41
  v_lshlrev_b32 v40, 16, v14
  v_and_b32 v41, 0xffff0000, v14
  v_cvt_pk_bf16_f32 v14, v42, v43
  v_lshlrev_b32 v42, 16, v14
  v_and_b32 v43, 0xffff0000, v14
  v_add_f32 v40, v40, v252
  v_add_f32 v41, v41, v253
  v_add_f32 v42, v42, v254
  v_add_f32 v43, v43, v255
  v_cvt_pk_bf16_f32 v252, v40, v41
  v_cvt_pk_bf16_f32 v253, v42, v43
  s_mul_i32 s29, s31, 288
  s_add_u32 s29, s29, 256
  buffer_store_dwordx2 v[252:253], v10, s[8:11], s29 offen
  s_endpgm
k_end:
  s_endpgm
.section .rodata,"a"
.p2align 6
.amdhsa_kernel parallel_sum__ssm_conv_h3__glu_gated_swiglu__prompt_kernel
  .amdhsa_next_free_vgpr 256
  .amdhsa_next_free_sgpr 102
  .amdhsa_accum_offset 256
  .amdhsa_group_segment_fixed_size 0
  .amdhsa_kernarg_size 104
  .amdhsa_user_sgpr_count 2
  .amdhsa_user_sgpr_kernarg_segment_ptr 1
  .amdhsa_system_sgpr_workgroup_id_x 1
.end_amdhsa_kernel
```
